```python
import torch

def _softmax(x, axis=-1):
    return torch.softmax(x, dim=axis)

def _gelu(x):
    return torch.nn.functional.gelu(x, approximate='tanh')

def _silu(x):
    return torch.nn.functional.silu(x)

def _sigmoid(x):
    return torch.sigmoid(x)

def _layernorm(x, axis=-1, eps=1e-05):
    m = x.mean(dim=axis, keepdim=True)
    v = x.var(dim=axis, keepdim=True, unbiased=False)
    return (x - m) / torch.sqrt(v + eps)

def _scatter_add(tgt, idx, src, axis=0):
    return tgt.clone().index_add_(axis, idx, src)

def _segment_sum(src, seg, n):
    out = torch.zeros((n,) + src.shape[1:], dtype=src.dtype)
    return out.index_add_(0, seg, src)

def _pad(x, pw):
    flat = tuple((v for pair in reversed(pw) for v in pair))
    return torch.nn.functional.pad(x, flat)
kernel_name = 'adaLN_cond__sliding_local_dilated__glu_gated_swiglu__prompt'

def setup_inputs():

    _w = lambda a: (lambda t: t.to(torch.bfloat16) if t.is_floating_point() else t)(torch.as_tensor(a))

    def _A_setup():
        B, S, D = (1, 2048, 576)
        return {'x': _w((lambda *s: torch.randn(*s, dtype=torch.bfloat16) * 0.05)(B, S, D)), 'wqkv': _w((lambda *s: torch.randn(*s, dtype=torch.bfloat16) * 0.05)(D, 3 * D)), 'wo': _w((lambda *s: torch.randn(*s, dtype=torch.bfloat16) * 0.05)(D, D))}
    _A_in = _A_setup()

    def _B_setup():
        B, S, D, F = (1, 2048, 576, 4608)
        return {'x': _w((lambda *s: torch.randn(*s, dtype=torch.bfloat16) * 0.05)(B, S, D)), 'w1': _w((lambda *s: torch.randn(*s, dtype=torch.bfloat16) * 0.8)(D, F) * (2.0 / D) ** 0.5), 'w3': _w((lambda *s: torch.randn(*s, dtype=torch.bfloat16) * 0.8)(D, F) * (2.0 / D) ** 0.5), 'w2': _w((lambda *s: torch.randn(*s, dtype=torch.bfloat16) * 0.8)(F, D) * (2.0 / F) ** 0.5)}
    _B_in = _B_setup()
    return {'A_x': _A_in['x'], 'A_wqkv': _A_in['wqkv'], 'A_wo': _A_in['wo'], 'B_x': _B_in['x'], 'B_w1': _B_in['w1'], 'B_w3': _B_in['w3'], 'B_w2': _B_in['w2'], 'c': _w((lambda *s: torch.randn(*s, dtype=torch.bfloat16) * 0.1)(1, 576) * 8.0), 'w_mod': _w((lambda *s: torch.randn(*s, dtype=torch.bfloat16) * 0.1)(576, 6 * 576) * 576 ** (-0.5) * 8.0)}

def reference(A_x, A_wqkv, A_wo, B_x, B_w1, B_w3, B_w2, c, w_mod):

    def _A_ref(x, wqkv, wo):
        B, S, D = x.shape
        H = 32
        Dh = D // H
        W, dil = (8, 2)
        qkv = (lambda x, *d: x.permute(*d))((x @ wqkv).reshape(B, S, 3, H, Dh), 2, 0, 3, 1, 4)
        q, k, v = (qkv[0], qkv[1], qkv[2])
        scale = Dh ** (-0.5)
        pos = torch.arange(S)
        off = torch.arange(W) * dil
        idx = pos[:, None] - off[None, :]
        mask = idx >= 0
        idx_c = torch.where(mask, idx, 0).reshape(-1)
        kg = k[:, :, idx_c, :].reshape(B, H, S, W, Dh)
        vg = v[:, :, idx_c, :].reshape(B, H, S, W, Dh)
        logits = torch.einsum('bhsd,bhswd->bhsw', q, kg) * scale
        logits = torch.where(mask[None, None, :, :], logits, -1000000000.0)
        attn = _softmax(logits, axis=-1)
        o = torch.einsum('bhsw,bhswd->bhsd', attn, vg)
        return (lambda x, *d: x.permute(*d))(o, 0, 2, 1, 3).reshape(B, S, D) @ wo

    def _B_ref(x, w1, w3, w2):
        gate = torch.einsum('bsd,df->bsf', x, w1)
        up = torch.einsum('bsd,df->bsf', x, w3)
        h = _silu(gate) * up
        out = torch.einsum('bsf,fd->bsd', h, w2)
        return out
    x = A_x
    mod = (_silu(c) @ w_mod).reshape(c.shape[0], 6, 1, -1)
    sa, ca, ga, sb, cb, gb = (mod[:, 0].clone(), mod[:, 1].clone(), mod[:, 2].clone(), mod[:, 3].clone(), mod[:, 4].clone(), mod[:, 5].clone())
    h = _layernorm(x, axis=-1) * (1 + ca) + sa
    x = x + ga * _A_ref(h, A_wqkv, A_wo)
    h = _layernorm(x, axis=-1) * (1 + cb) + sb
    x = x + gb * _B_ref(h, B_w1, B_w3, B_w2)
    return x
```

```asm
; @launch kernel=pmega_kernel grid=(256,1,1) block=(512,1,1) lds=163840
.amdgcn_target "amdgcn-amd-amdhsa--gfx950"
.text
.globl pmega_kernel
.p2align 8
.type pmega_kernel,@function
pmega_kernel:
    s_getpc_b64 s[76:77]
MEGA_PC:
    v_lshlrev_b32 v2, 7, v0
    s_sub_u32 s76, s76, MEGA_PC-pmega_kernel
    s_subb_u32 s77, s77, 0
    v_min_u32 v2, MEGA_END-pmega_kernel, v2
    global_load_dword v255, v2, s[76:77]
    s_cmp_ge_u32 s2, 256
    s_cbranch_scc1 MEGA_END
    s_load_dwordx4 s[36:39], s[0:1], 0
    s_load_dwordx4 s[40:43], s[0:1], 32
    s_load_dwordx2 s[44:45], s[0:1], 48
    s_load_dwordx2 s[46:47], s[0:1], 72
    s_load_dwordx2 s[48:49], s[0:1], 88
    s_load_dwordx2 s[50:51], s[0:1], 16
    s_load_dwordx4 s[52:55], s[0:1], 56
    s_load_dwordx2 s[56:57], s[0:1], 80
    v_lshrrev_b32 v1, 6, v0
    v_and_b32 v0, 63, v0
    v_readfirstlane_b32 s24, v1
    s_waitcnt lgkmcnt(0)
    s_mov_b32 s4, s36
    s_and_b32 s5, s37, 0xffff
    s_mov_b32 s6, 2359296
    s_mov_b32 s7, 0x00020000
    s_mov_b32 s8, s38
    s_and_b32 s9, s39, 0xffff
    s_mov_b32 s10, 1990656
    s_mov_b32 s11, 0x00020000
    s_cmp_lt_u32 s24, 4
    s_cselect_b32 s12, s40, s42
    s_cselect_b32 s13, s41, s43
    s_and_b32 s13, s13, 0xffff
    s_mov_b32 s14, 5308416
    s_mov_b32 s15, 0x00020000
    s_mov_b32 s16, s44
    s_and_b32 s17, s45, 0xffff
    s_mov_b32 s18, 5308416
    s_mov_b32 s19, 0x00020000
    s_mov_b32 s20, s46
    s_and_b32 s21, s47, 0xffff
    s_mov_b32 s22, 2359296
    s_mov_b32 s23, 0x00020000
    s_mov_b32 s28, s48
    s_and_b32 s29, s49, 0xffff
    s_mov_b32 s30, 56623104
    s_mov_b32 s31, 0x00020000
    s_mov_b32 s60, s54
    s_and_b32 s61, s55, 0xffff
    s_mov_b32 s62, 3981312
    s_mov_b32 s63, 0x00020000
    s_mov_b32 s64, s52
    s_and_b32 s65, s53, 0xffff
    s_mov_b32 s66, 1152
    s_mov_b32 s67, 0x00020000
    s_mov_b32 s68, s50
    s_and_b32 s69, s51, 0xffff
    s_mov_b32 s70, 663552
    s_mov_b32 s71, 0x00020000
    s_mov_b32 s72, s56
    s_and_b32 s73, s57, 0xffff
    s_mov_b32 s74, 256
    s_mov_b32 s75, 0x00020000
    s_and_b32 s36, s2, 3
    s_bfe_u32 s37, s2, 0x10002
    s_lshl_b32 s37, s37, 5
    s_lshr_b32 s38, s2, 3
    s_add_u32 s37, s37, s38
    s_lshr_b32 s76, s2, 5
    s_lshl_b32 s76, s76, 3
    s_and_b32 s77, s2, 7
    s_add_u32 s76, s76, s77
    s_lshl_b32 s76, s76, 2
    s_bfe_u32 s77, s2, 0x20003
    s_add_u32 s80, s76, s77
    s_lshl_b32 s76, s24, 6
    v_add_u32 v52, s76, v0
    v_and_b32 v53, 1, v52
    v_lshrrev_b32 v54, 1, v52
    v_mul_u32_u24 v55, 6912, v54
    v_lshl_add_u32 v55, v53, 4, v55
    s_lshl_b32 s76, s80, 5
    s_cmp_ge_u32 s80, 216
    s_cselect_b32 s76, 0x7f000000, s76
    v_add_u32 v55, s76, v55
    v_lshlrev_b32 v56, 1, v54
    s_mov_b32 s77, 1769472
    s_mov_b32 s78, 3538944
    buffer_load_dwordx4 v[60:63], v55, s[60:63], 0 offen
    buffer_load_ushort v72, v56, s[64:67], 0 offen offset:0
    buffer_load_dwordx4 v[64:67], v55, s[60:63], s77 offen
    buffer_load_ushort v73, v56, s[64:67], 0 offen offset:512
    buffer_load_dwordx4 v[68:71], v55, s[60:63], s78 offen
    buffer_load_ushort v74, v56, s[64:67], 0 offen offset:1024
    s_lshl_b32 s45, s37, 5
    s_sub_u32 s45, s45, 16
    v_and_b32 v1, 15, v0
    v_add_u32 v1, s45, v1
    s_mov_b32 s46, 1152
    v_mul_lo_u32 v1, v1, s46
    v_lshrrev_b32 v2, 4, v0
    v_lshl_add_u32 v148, v2, 4, v1
    s_lshl_b32 s46, s24, 6
    s_add_u32 s47, s46, 576
    s_mul_i32 s48, s24, 576
    s_add_u32 s48, s48, 512
    s_cmp_ge_u32 s24, 2
    s_cselect_b32 s48, 0x7f000000, s48
    v_add_u32 v8, s46, v148
    buffer_load_dwordx4 v[16:19], v8, s[4:7], 0 offen
    v_add_u32 v8, s46, v148
    v_add_u32 v8, 18432, v8
    buffer_load_dwordx4 v[20:23], v8, s[4:7], 0 offen
    v_add_u32 v8, s46, v148
    v_add_u32 v8, 36864, v8
    buffer_load_dwordx4 v[24:27], v8, s[4:7], 0 offen
    v_add_u32 v8, s47, v148
    buffer_load_dwordx4 v[28:31], v8, s[4:7], 0 offen
    v_add_u32 v8, s47, v148
    v_add_u32 v8, 18432, v8
    buffer_load_dwordx4 v[32:35], v8, s[4:7], 0 offen
    v_add_u32 v8, s47, v148
    v_add_u32 v8, 36864, v8
    buffer_load_dwordx4 v[36:39], v8, s[4:7], 0 offen
    v_add_u32 v8, s48, v148
    buffer_load_dwordx4 v[40:43], v8, s[4:7], 0 offen
    v_add_u32 v8, s48, v148
    v_add_u32 v8, 18432, v8
    buffer_load_dwordx4 v[44:47], v8, s[4:7], 0 offen
    v_add_u32 v8, s48, v148
    v_add_u32 v8, 36864, v8
    buffer_load_dwordx4 v[48:51], v8, s[4:7], 0 offen
    v_mov_b32 v14, 83712
    v_mov_b32 v156, 0x7f000000
    v_lshlrev_b32 v13, 4, v0
    s_mul_i32 s39, s24, 12
    v_add_u32 v1, 0, v0
    v_mul_u32_u24 v2, 3641, v1
    v_lshrrev_b32 v2, 16, v2
    v_mul_u32_u24 v3, 18, v2
    v_sub_u32 v1, v1, v3
    v_add_u32 v2, s39, v2
    v_lshrrev_b32 v3, 5, v2
    v_bfe_u32 v4, v2, 2, 2
    v_bfe_u32 v5, v2, 4, 1
    v_and_b32 v2, 3, v2
    v_lshl_add_u32 v2, v4, 3, v2
    v_lshl_add_u32 v2, v5, 2, v2
    v_mul_u32_u24 v2, 3456, v2
    v_mul_u32_u24 v3, 1152, v3
    v_add_u32 v2, v2, v3
    v_lshl_add_u32 v9, v1, 4, v2
    v_add_u32 v1, 64, v0
    v_mul_u32_u24 v2, 3641, v1
    v_lshrrev_b32 v2, 16, v2
    v_mul_u32_u24 v3, 18, v2
    v_sub_u32 v1, v1, v3
    v_add_u32 v2, s39, v2
    v_lshrrev_b32 v3, 5, v2
    v_bfe_u32 v4, v2, 2, 2
    v_bfe_u32 v5, v2, 4, 1
    v_and_b32 v2, 3, v2
    v_lshl_add_u32 v2, v4, 3, v2
    v_lshl_add_u32 v2, v5, 2, v2
    v_mul_u32_u24 v2, 3456, v2
    v_mul_u32_u24 v3, 1152, v3
    v_add_u32 v2, v2, v3
    v_lshl_add_u32 v10, v1, 4, v2
    v_add_u32 v1, 128, v0
    v_mul_u32_u24 v2, 3641, v1
    v_lshrrev_b32 v2, 16, v2
    v_mul_u32_u24 v3, 18, v2
    v_sub_u32 v1, v1, v3
    v_add_u32 v2, s39, v2
    v_lshrrev_b32 v3, 5, v2
    v_bfe_u32 v4, v2, 2, 2
    v_bfe_u32 v5, v2, 4, 1
    v_and_b32 v2, 3, v2
    v_lshl_add_u32 v2, v4, 3, v2
    v_lshl_add_u32 v2, v5, 2, v2
    v_mul_u32_u24 v2, 3456, v2
    v_mul_u32_u24 v3, 1152, v3
    v_add_u32 v2, v2, v3
    v_lshl_add_u32 v11, v1, 4, v2
    v_add_u32 v1, 192, v0
    v_mul_u32_u24 v2, 3641, v1
    v_lshrrev_b32 v2, 16, v2
    v_mul_u32_u24 v3, 18, v2
    v_sub_u32 v1, v1, v3
    v_add_u32 v2, s39, v2
    v_lshrrev_b32 v3, 5, v2
    v_bfe_u32 v4, v2, 2, 2
    v_bfe_u32 v5, v2, 4, 1
    v_and_b32 v2, 3, v2
    v_lshl_add_u32 v2, v4, 3, v2
    v_lshl_add_u32 v2, v5, 2, v2
    v_mul_u32_u24 v2, 3456, v2
    v_mul_u32_u24 v3, 1152, v3
    v_add_u32 v2, v2, v3
    v_lshl_add_u32 v12, v1, 4, v2
    s_mul_i32 s40, s24, 3456
    s_mul_i32 s41, s36, 288
    s_mul_i32 s42, s38, 57
    s_lshr_b32 s42, s42, 9
    s_mul_i32 s42, s42, 9
    s_sub_u32 s42, s38, s42
    s_mov_b32 s43, s42
    s_waitcnt vmcnt(9)
    v_lshlrev_b32 v72, 16, v72
    v_mul_f32 v1, 3216550459, v72
    v_exp_f32 v1, v1
    s_nop 0
    v_add_f32 v1, 1.0, v1
    v_rcp_f32 v1, v1
    s_nop 0
    v_mul_f32 v72, v72, v1
    v_cvt_pk_bf16_f32 v72, v72, v72
    v_lshlrev_b32 v72, 16, v72
    v_lshlrev_b32 v1, 16, v60
    v_and_b32 v2, 0xffff0000, v60
    v_mul_f32 v96, v72, v1
    v_mul_f32 v97, v72, v2
    v_lshlrev_b32 v1, 16, v61
    v_and_b32 v2, 0xffff0000, v61
    v_mul_f32 v98, v72, v1
    v_mul_f32 v99, v72, v2
    v_lshlrev_b32 v1, 16, v62
    v_and_b32 v2, 0xffff0000, v62
    v_mul_f32 v100, v72, v1
    v_mul_f32 v101, v72, v2
    v_lshlrev_b32 v1, 16, v63
    v_and_b32 v2, 0xffff0000, v63
    v_mul_f32 v102, v72, v1
    v_mul_f32 v103, v72, v2
    v_lshlrev_b32 v73, 16, v73
    v_mul_f32 v1, 3216550459, v73
    v_exp_f32 v1, v1
    s_nop 0
    v_add_f32 v1, 1.0, v1
    v_rcp_f32 v1, v1
    s_nop 0
    v_mul_f32 v73, v73, v1
    v_cvt_pk_bf16_f32 v73, v73, v73
    v_lshlrev_b32 v73, 16, v73
    v_lshlrev_b32 v1, 16, v64
    v_and_b32 v2, 0xffff0000, v64
    v_fmac_f32 v96, v73, v1
    v_fmac_f32 v97, v73, v2
    v_lshlrev_b32 v1, 16, v65
    v_and_b32 v2, 0xffff0000, v65
    v_fmac_f32 v98, v73, v1
    v_fmac_f32 v99, v73, v2
    v_lshlrev_b32 v1, 16, v66
    v_and_b32 v2, 0xffff0000, v66
    v_fmac_f32 v100, v73, v1
    v_fmac_f32 v101, v73, v2
    v_lshlrev_b32 v1, 16, v67
    v_and_b32 v2, 0xffff0000, v67
    v_fmac_f32 v102, v73, v1
    v_fmac_f32 v103, v73, v2
    v_lshlrev_b32 v74, 16, v74
    v_mul_f32 v1, 3216550459, v74
    v_exp_f32 v1, v1
    s_nop 0
    v_add_f32 v1, 1.0, v1
    v_rcp_f32 v1, v1
    s_nop 0
    v_mul_f32 v74, v74, v1
    v_cvt_pk_bf16_f32 v74, v74, v74
    v_lshlrev_b32 v74, 16, v74
    v_lshlrev_b32 v1, 16, v68
    v_and_b32 v2, 0xffff0000, v68
    v_fmac_f32 v96, v74, v1
    v_fmac_f32 v97, v74, v2
    v_lshlrev_b32 v1, 16, v69
    v_and_b32 v2, 0xffff0000, v69
    v_fmac_f32 v98, v74, v1
    v_fmac_f32 v99, v74, v2
    v_lshlrev_b32 v1, 16, v70
    v_and_b32 v2, 0xffff0000, v70
    v_fmac_f32 v100, v74, v1
    v_fmac_f32 v101, v74, v2
    v_lshlrev_b32 v1, 16, v71
    v_and_b32 v2, 0xffff0000, v71
    v_fmac_f32 v102, v74, v1
    v_fmac_f32 v103, v74, v2
    v_add_f32_dpp v96, v96, v96 row_ror:2 row_mask:0xf bank_mask:0xf
    v_add_f32_dpp v97, v97, v97 row_ror:2 row_mask:0xf bank_mask:0xf
    v_add_f32_dpp v98, v98, v98 row_ror:2 row_mask:0xf bank_mask:0xf
    v_add_f32_dpp v99, v99, v99 row_ror:2 row_mask:0xf bank_mask:0xf
    v_add_f32_dpp v100, v100, v100 row_ror:2 row_mask:0xf bank_mask:0xf
    v_add_f32_dpp v101, v101, v101 row_ror:2 row_mask:0xf bank_mask:0xf
    v_add_f32_dpp v102, v102, v102 row_ror:2 row_mask:0xf bank_mask:0xf
    v_add_f32_dpp v103, v103, v103 row_ror:2 row_mask:0xf bank_mask:0xf
    v_add_f32_dpp v96, v96, v96 row_ror:4 row_mask:0xf bank_mask:0xf
    v_add_f32_dpp v97, v97, v97 row_ror:4 row_mask:0xf bank_mask:0xf
    v_add_f32_dpp v98, v98, v98 row_ror:4 row_mask:0xf bank_mask:0xf
    v_add_f32_dpp v99, v99, v99 row_ror:4 row_mask:0xf bank_mask:0xf
    v_add_f32_dpp v100, v100, v100 row_ror:4 row_mask:0xf bank_mask:0xf
    v_add_f32_dpp v101, v101, v101 row_ror:4 row_mask:0xf bank_mask:0xf
    v_add_f32_dpp v102, v102, v102 row_ror:4 row_mask:0xf bank_mask:0xf
    v_add_f32_dpp v103, v103, v103 row_ror:4 row_mask:0xf bank_mask:0xf
    v_add_f32_dpp v96, v96, v96 row_ror:8 row_mask:0xf bank_mask:0xf
    v_add_f32_dpp v97, v97, v97 row_ror:8 row_mask:0xf bank_mask:0xf
    v_add_f32_dpp v98, v98, v98 row_ror:8 row_mask:0xf bank_mask:0xf
    v_add_f32_dpp v99, v99, v99 row_ror:8 row_mask:0xf bank_mask:0xf
    v_add_f32_dpp v100, v100, v100 row_ror:8 row_mask:0xf bank_mask:0xf
    v_add_f32_dpp v101, v101, v101 row_ror:8 row_mask:0xf bank_mask:0xf
    v_add_f32_dpp v102, v102, v102 row_ror:8 row_mask:0xf bank_mask:0xf
    v_add_f32_dpp v103, v103, v103 row_ror:8 row_mask:0xf bank_mask:0xf
    v_lshrrev_b32 v1, 4, v52
    v_lshlrev_b32 v1, 6, v1
    v_lshl_add_u32 v1, v53, 5, v1
    v_add_u32 v1, 138240, v1
    ds_write_b128 v1, v[96:99]
    ds_write_b128 v1, v[100:103] offset:16
    s_waitcnt lgkmcnt(0)
    s_barrier
    s_cmp_lg_u32 s24, 0
    s_cbranch_scc1 P0_WO_2
    v_and_b32 v1, 15, v0
    v_lshrrev_b32 v2, 4, v0
    v_lshlrev_b32 v2, 9, v2
    v_lshl_add_u32 v2, v1, 2, v2
    v_add_u32 v2, 138240, v2
    ds_read_b32 v96, v2 offset:0
    ds_read_b32 v97, v2 offset:64
    ds_read_b32 v98, v2 offset:128
    ds_read_b32 v99, v2 offset:192
    ds_read_b32 v100, v2 offset:256
    ds_read_b32 v101, v2 offset:320
    ds_read_b32 v102, v2 offset:384
    ds_read_b32 v103, v2 offset:448
    s_waitcnt lgkmcnt(0)
    v_add_f32 v96, v96, v97
    v_add_f32 v96, v96, v98
    v_add_f32 v96, v96, v99
    v_add_f32 v96, v96, v100
    v_add_f32 v96, v96, v101
    v_add_f32 v96, v96, v102
    v_add_f32 v96, v96, v103
    v_mov_b32 v2, v96
    s_nop 1
    v_permlane16_swap_b32 v96, v2
    v_add_f32 v96, v96, v2
    v_mov_b32 v2, v96
    s_nop 1
    v_permlane32_swap_b32 v96, v2
    v_add_f32 v96, v96, v2
    v_cvt_pk_bf16_f32 v96, v96, v96
    v_lshlrev_b32 v96, 16, v96
    s_mul_i32 s76, s80, 1821
    s_lshr_b32 s76, s76, 16
    s_mov_b32 s77, 0
    s_cmp_eq_u32 s76, 1
    s_cselect_b32 s77, 1.0, s77
    s_cmp_eq_u32 s76, 4
    s_cselect_b32 s77, 1.0, s77
    v_add_f32 v96, s77, v96
    v_cvt_pk_bf16_f32 v96, v96, v96
    v_lshlrev_b32 v96, 16, v96
    v_lshlrev_b32 v2, 2, v1
    v_lshlrev_b32 v1, 1, v1
    v_lshrrev_b32 v97, 16, v96
    s_lshl_b32 s76, s80, 6
    s_add_u32 s76, s76, 16384
    s_lshl_b32 s77, s80, 5
    s_add_u32 s77, s77, 40960
    s_cmp_ge_u32 s80, 216
    s_cselect_b32 s76, 0x7f000000, s76
    s_cselect_b32 s77, 0x7f000000, s77
    v_mov_b32 v98, 0
    s_lshl_b32 s78, s2, 6
    s_mov_b64 exec, 0xffff
    buffer_store_short v97, v1, s[28:31], s77 offen sc1
    buffer_store_dword v96, v2, s[28:31], s76 offen sc1
    buffer_store_dword v98, v2, s[28:31], s78 offen sc1
    s_mov_b64 exec, -1
    s_branch P0_FIN_1
P0_WO_2:
P0_FIN_1:
    v_mov_b32 v1, 0x3f803f80
    s_waitcnt vmcnt(3)
    s_cmp_eq_u32 s24, 0
    s_cbranch_scc1 P12_XW_3
    s_waitcnt vmcnt(0)
P12_XW_3:
    v_dot2_f32_bf16 v149, v16, v1, 0
    v_dot2_f32_bf16 v149, v17, v1, v149
    v_dot2_f32_bf16 v149, v18, v1, v149
    v_dot2_f32_bf16 v149, v19, v1, v149
    v_dot2_f32_bf16 v149, v28, v1, v149
    v_dot2_f32_bf16 v149, v29, v1, v149
    v_dot2_f32_bf16 v149, v30, v1, v149
    v_dot2_f32_bf16 v149, v31, v1, v149
    v_dot2_f32_bf16 v149, v40, v1, v149
    v_dot2_f32_bf16 v149, v41, v1, v149
    v_dot2_f32_bf16 v149, v42, v1, v149
    s_mul_i32 s44, s42, 110592
    s_add_u32 s44, s44, s41
    s_add_u32 s42, s42, 1
    s_cmp_ge_u32 s42, 9
    s_cselect_b32 s42, 0, s42
    s_add_u32 m0, s40, 0
    s_nop 0
    buffer_load_dwordx4 v9, s[8:11], s44 offen lds
    v_dot2_f32_bf16 v149, v43, v1, v149
    v_dot2_f32_bf16 v150, v20, v1, 0
    v_dot2_f32_bf16 v150, v21, v1, v150
    v_dot2_f32_bf16 v150, v22, v1, v150
    v_dot2_f32_bf16 v150, v23, v1, v150
    v_dot2_f32_bf16 v150, v32, v1, v150
    v_dot2_f32_bf16 v150, v33, v1, v150
    v_dot2_f32_bf16 v150, v34, v1, v150
    v_dot2_f32_bf16 v150, v35, v1, v150
    v_dot2_f32_bf16 v150, v44, v1, v150
    v_dot2_f32_bf16 v150, v45, v1, v150
    v_dot2_f32_bf16 v150, v46, v1, v150
    s_add_u32 m0, s40, 1024
    s_nop 0
    buffer_load_dwordx4 v10, s[8:11], s44 offen lds
    v_dot2_f32_bf16 v150, v47, v1, v150
    v_dot2_f32_bf16 v151, v24, v1, 0
    v_dot2_f32_bf16 v151, v25, v1, v151
    v_dot2_f32_bf16 v151, v26, v1, v151
    v_dot2_f32_bf16 v151, v27, v1, v151
    v_dot2_f32_bf16 v151, v36, v1, v151
    v_dot2_f32_bf16 v151, v37, v1, v151
    v_dot2_f32_bf16 v151, v38, v1, v151
    v_dot2_f32_bf16 v151, v39, v1, v151
    v_dot2_f32_bf16 v151, v48, v1, v151
    v_dot2_f32_bf16 v151, v49, v1, v151
    v_dot2_f32_bf16 v151, v50, v1, v151
    s_add_u32 m0, s40, 2048
    s_nop 0
    buffer_load_dwordx4 v11, s[8:11], s44 offen lds
    v_dot2_f32_bf16 v151, v51, v1, v151
    s_nop 2
    v_mov_b32 v2, v149
    v_mov_b32 v3, v150
    v_mov_b32 v4, v151
    s_nop 1
    v_permlane16_swap_b32 v149, v2
    v_permlane16_swap_b32 v150, v3
    v_permlane16_swap_b32 v151, v4
    v_add_f32 v149, v149, v2
    v_add_f32 v150, v150, v3
    v_add_f32 v151, v151, v4
    v_mov_b32 v2, v149
    s_add_u32 m0, s40, 3072
    s_mov_b64 exec, 0xffffff
    buffer_load_dwordx4 v12, s[8:11], s44 offen lds
    s_mov_b64 exec, -1
    v_mov_b32 v3, v150
    v_mov_b32 v4, v151
    s_nop 1
    v_permlane32_swap_b32 v149, v2
    v_permlane32_swap_b32 v150, v3
    v_permlane32_swap_b32 v151, v4
    v_add_f32 v149, v149, v2
    v_add_f32 v150, v150, v3
    v_add_f32 v151, v151, v4
    v_and_b32 v1, 15, v0
    v_lshlrev_b32 v1, 5, v1
    v_add_u32 v1, 142336, v1
    s_mul_i32 s44, s42, 110592
    s_add_u32 s44, s44, s41
    s_add_u32 s42, s42, 1
    s_cmp_ge_u32 s42, 9
    s_cselect_b32 s42, 0, s42
    s_add_u32 m0, s40, 27648
    s_nop 0
    buffer_load_dwordx4 v9, s[8:11], s44 offen lds
    s_lshl_b32 s45, s24, 2
    v_add_u32 v2, s45, v1
    s_cmp_lg_u32 s24, 0
    s_cbranch_scc1 P0_ARR_4
    v_mov_b32 v4, 1
    s_and_b32 s76, s2, 1
    s_lshl_b32 s76, s76, 6
    s_cmp_ge_u32 s80, 72
    s_cselect_b32 s76, 0x7f000000, s76
    s_mov_b64 exec, 1
    s_waitcnt vmcnt(5)
    buffer_atomic_add v4, off, s[72:75], s76 sc1
    s_mov_b64 exec, -1
P0_ARR_4:
    ds_write_b32 v2, v149 offset:0
    ds_write_b32 v2, v150 offset:512
    ds_write_b32 v2, v151 offset:1024
    s_waitcnt lgkmcnt(0)
    s_barrier
    ds_read_b128 v[124:127], v1 offset:0
    ds_read_b128 v[128:131], v1 offset:16
    ds_read_b128 v[132:135], v1 offset:512
    ds_read_b128 v[136:139], v1 offset:528
    ds_read_b128 v[140:143], v1 offset:1024
    s_add_u32 m0, s40, 28672
    s_nop 0
    buffer_load_dwordx4 v10, s[8:11], s44 offen lds
    ds_read_b128 v[144:147], v1 offset:1040
    s_waitcnt lgkmcnt(0)
    v_add_f32 v124, v124, v128
    v_add_f32 v125, v125, v129
    v_add_f32 v126, v126, v130
    v_add_f32 v127, v127, v131
    v_add_f32 v124, v124, v125
    v_add_f32 v126, v126, v127
    v_add_f32 v149, v124, v126
    v_add_f32 v132, v132, v136
    v_add_f32 v133, v133, v137
    v_add_f32 v134, v134, v138
    s_add_u32 m0, s40, 29696
    s_nop 0
    buffer_load_dwordx4 v11, s[8:11], s44 offen lds
    v_add_f32 v135, v135, v139
    v_add_f32 v132, v132, v133
    v_add_f32 v134, v134, v135
    v_add_f32 v150, v132, v134
    v_add_f32 v140, v140, v144
    v_add_f32 v141, v141, v145
    v_add_f32 v142, v142, v146
    v_add_f32 v143, v143, v147
    v_add_f32 v140, v140, v141
    v_add_f32 v142, v142, v143
    v_add_f32 v151, v140, v142
    v_mul_f32 v152, 0x3ae38e39, v149
    s_add_u32 m0, s40, 30720
    s_mov_b64 exec, 0xffffff
    buffer_load_dwordx4 v12, s[8:11], s44 offen lds
    s_mov_b64 exec, -1
    v_mov_b32 v149, 0
    v_mul_f32 v153, 0x3ae38e39, v150
    v_mov_b32 v150, 0
    v_mul_f32 v154, 0x3ae38e39, v151
    v_mov_b32 v151, 0
    v_lshlrev_b32 v52, 16, v16
    v_and_b32 v53, 0xffff0000, v16
    v_sub_f32 v52, v52, v152
    v_sub_f32 v53, v53, v152
    v_fmac_f32 v149, v52, v52
    v_fmac_f32 v149, v53, v53
    v_lshlrev_b32 v54, 16, v17
    s_mul_i32 s44, s42, 110592
    s_add_u32 s44, s44, s41
    s_add_u32 s42, s42, 1
    s_cmp_ge_u32 s42, 9
    s_cselect_b32 s42, 0, s42
    s_add_u32 m0, s40, 55296
    s_nop 0
    buffer_load_dwordx4 v9, s[8:11], s44 offen lds
    v_and_b32 v55, 0xffff0000, v17
    v_sub_f32 v54, v54, v152
    v_sub_f32 v55, v55, v152
    v_fmac_f32 v149, v54, v54
    v_fmac_f32 v149, v55, v55
    v_lshlrev_b32 v56, 16, v18
    v_and_b32 v57, 0xffff0000, v18
    v_sub_f32 v56, v56, v152
    v_sub_f32 v57, v57, v152
    v_fmac_f32 v149, v56, v56
    v_fmac_f32 v149, v57, v57
    v_lshlrev_b32 v58, 16, v19
    s_add_u32 m0, s40, 56320
    s_nop 0
    buffer_load_dwordx4 v10, s[8:11], s44 offen lds
    v_and_b32 v59, 0xffff0000, v19
    v_sub_f32 v58, v58, v152
    v_sub_f32 v59, v59, v152
    v_fmac_f32 v149, v58, v58
    v_fmac_f32 v149, v59, v59
    v_lshlrev_b32 v60, 16, v20
    v_and_b32 v61, 0xffff0000, v20
    v_sub_f32 v60, v60, v153
    v_sub_f32 v61, v61, v153
    v_fmac_f32 v150, v60, v60
    v_fmac_f32 v150, v61, v61
    v_lshlrev_b32 v62, 16, v21
    s_add_u32 m0, s40, 57344
    s_nop 0
    buffer_load_dwordx4 v11, s[8:11], s44 offen lds
    v_and_b32 v63, 0xffff0000, v21
    v_sub_f32 v62, v62, v153
    v_sub_f32 v63, v63, v153
    v_fmac_f32 v150, v62, v62
    v_fmac_f32 v150, v63, v63
    v_lshlrev_b32 v64, 16, v22
    v_and_b32 v65, 0xffff0000, v22
    v_sub_f32 v64, v64, v153
    v_sub_f32 v65, v65, v153
    v_fmac_f32 v150, v64, v64
    v_fmac_f32 v150, v65, v65
    v_lshlrev_b32 v66, 16, v23
    s_add_u32 m0, s40, 58368
    s_mov_b64 exec, 0xffffff
    buffer_load_dwordx4 v12, s[8:11], s44 offen lds
    s_mov_b64 exec, -1
    v_and_b32 v67, 0xffff0000, v23
    v_sub_f32 v66, v66, v153
    v_sub_f32 v67, v67, v153
    v_fmac_f32 v150, v66, v66
    v_fmac_f32 v150, v67, v67
    v_lshlrev_b32 v68, 16, v24
    v_and_b32 v69, 0xffff0000, v24
    v_sub_f32 v68, v68, v154
    v_sub_f32 v69, v69, v154
    v_fmac_f32 v151, v68, v68
    v_fmac_f32 v151, v69, v69
    v_lshlrev_b32 v70, 16, v25
    s_mul_i32 s44, s42, 110592
    s_add_u32 s44, s44, s41
    s_add_u32 s42, s42, 1
    s_cmp_ge_u32 s42, 9
    s_cselect_b32 s42, 0, s42
    s_add_u32 m0, s40, 82944
    s_nop 0
    buffer_load_dwordx4 v9, s[8:11], s44 offen lds
    v_and_b32 v71, 0xffff0000, v25
    v_sub_f32 v70, v70, v154
    v_sub_f32 v71, v71, v154
    v_fmac_f32 v151, v70, v70
    v_fmac_f32 v151, v71, v71
    v_lshlrev_b32 v72, 16, v26
    v_and_b32 v73, 0xffff0000, v26
    v_sub_f32 v72, v72, v154
    v_sub_f32 v73, v73, v154
    v_fmac_f32 v151, v72, v72
    v_fmac_f32 v151, v73, v73
    v_lshlrev_b32 v74, 16, v27
    s_add_u32 m0, s40, 83968
    s_nop 0
    buffer_load_dwordx4 v10, s[8:11], s44 offen lds
    v_and_b32 v75, 0xffff0000, v27
    v_sub_f32 v74, v74, v154
    v_sub_f32 v75, v75, v154
    v_fmac_f32 v151, v74, v74
    v_fmac_f32 v151, v75, v75
    v_lshlrev_b32 v76, 16, v28
    v_and_b32 v77, 0xffff0000, v28
    v_sub_f32 v76, v76, v152
    v_sub_f32 v77, v77, v152
    v_fmac_f32 v149, v76, v76
    v_fmac_f32 v149, v77, v77
    v_lshlrev_b32 v78, 16, v29
    s_add_u32 m0, s40, 84992
    s_nop 0
    buffer_load_dwordx4 v11, s[8:11], s44 offen lds
    v_and_b32 v79, 0xffff0000, v29
    v_sub_f32 v78, v78, v152
    v_sub_f32 v79, v79, v152
    v_fmac_f32 v149, v78, v78
    v_fmac_f32 v149, v79, v79
    v_lshlrev_b32 v80, 16, v30
    v_and_b32 v81, 0xffff0000, v30
    v_sub_f32 v80, v80, v152
    v_sub_f32 v81, v81, v152
    v_fmac_f32 v149, v80, v80
    v_fmac_f32 v149, v81, v81
    v_lshlrev_b32 v82, 16, v31
    s_add_u32 m0, s40, 86016
    s_mov_b64 exec, 0xffffff
    buffer_load_dwordx4 v12, s[8:11], s44 offen lds
    s_mov_b64 exec, -1
    v_and_b32 v83, 0xffff0000, v31
    v_sub_f32 v82, v82, v152
    v_sub_f32 v83, v83, v152
    v_fmac_f32 v149, v82, v82
    v_fmac_f32 v149, v83, v83
    v_lshlrev_b32 v84, 16, v32
    v_and_b32 v85, 0xffff0000, v32
    v_sub_f32 v84, v84, v153
    v_sub_f32 v85, v85, v153
    v_fmac_f32 v150, v84, v84
    v_fmac_f32 v150, v85, v85
    v_lshlrev_b32 v86, 16, v33
    v_and_b32 v87, 0xffff0000, v33
    v_sub_f32 v86, v86, v153
    v_sub_f32 v87, v87, v153
    v_fmac_f32 v150, v86, v86
    v_fmac_f32 v150, v87, v87
    v_lshlrev_b32 v88, 16, v34
    v_and_b32 v89, 0xffff0000, v34
    v_sub_f32 v88, v88, v153
    v_sub_f32 v89, v89, v153
    v_fmac_f32 v150, v88, v88
    v_fmac_f32 v150, v89, v89
    v_lshlrev_b32 v90, 16, v35
    v_and_b32 v91, 0xffff0000, v35
    v_sub_f32 v90, v90, v153
    v_sub_f32 v91, v91, v153
    v_fmac_f32 v150, v90, v90
    v_fmac_f32 v150, v91, v91
    v_lshlrev_b32 v92, 16, v36
    v_and_b32 v93, 0xffff0000, v36
    v_sub_f32 v92, v92, v154
    v_sub_f32 v93, v93, v154
    v_fmac_f32 v151, v92, v92
    v_fmac_f32 v151, v93, v93
    v_lshlrev_b32 v94, 16, v37
    v_and_b32 v95, 0xffff0000, v37
    v_sub_f32 v94, v94, v154
    v_sub_f32 v95, v95, v154
    v_fmac_f32 v151, v94, v94
    v_fmac_f32 v151, v95, v95
    v_lshlrev_b32 v96, 16, v38
    v_and_b32 v97, 0xffff0000, v38
    v_sub_f32 v96, v96, v154
    v_sub_f32 v97, v97, v154
    v_fmac_f32 v151, v96, v96
    v_fmac_f32 v151, v97, v97
    v_lshlrev_b32 v98, 16, v39
    v_and_b32 v99, 0xffff0000, v39
    v_sub_f32 v98, v98, v154
    v_sub_f32 v99, v99, v154
    v_fmac_f32 v151, v98, v98
    v_fmac_f32 v151, v99, v99
    s_cmp_ge_u32 s24, 2
    s_cbranch_scc1 P12_Q2_5
    v_lshlrev_b32 v100, 16, v40
    v_and_b32 v101, 0xffff0000, v40
    v_sub_f32 v100, v100, v152
    v_sub_f32 v101, v101, v152
    v_fmac_f32 v149, v100, v100
    v_fmac_f32 v149, v101, v101
    v_lshlrev_b32 v102, 16, v41
    v_and_b32 v103, 0xffff0000, v41
    v_sub_f32 v102, v102, v152
    v_sub_f32 v103, v103, v152
    v_fmac_f32 v149, v102, v102
    v_fmac_f32 v149, v103, v103
    v_lshlrev_b32 v104, 16, v42
    v_and_b32 v105, 0xffff0000, v42
    v_sub_f32 v104, v104, v152
    v_sub_f32 v105, v105, v152
    v_fmac_f32 v149, v104, v104
    v_fmac_f32 v149, v105, v105
    v_lshlrev_b32 v106, 16, v43
    v_and_b32 v107, 0xffff0000, v43
    v_sub_f32 v106, v106, v152
    v_sub_f32 v107, v107, v152
    v_fmac_f32 v149, v106, v106
    v_fmac_f32 v149, v107, v107
    v_lshlrev_b32 v108, 16, v44
    v_and_b32 v109, 0xffff0000, v44
    v_sub_f32 v108, v108, v153
    v_sub_f32 v109, v109, v153
    v_fmac_f32 v150, v108, v108
    v_fmac_f32 v150, v109, v109
    v_lshlrev_b32 v110, 16, v45
    v_and_b32 v111, 0xffff0000, v45
    v_sub_f32 v110, v110, v153
    v_sub_f32 v111, v111, v153
    v_fmac_f32 v150, v110, v110
    v_fmac_f32 v150, v111, v111
    v_lshlrev_b32 v112, 16, v46
    v_and_b32 v113, 0xffff0000, v46
    v_sub_f32 v112, v112, v153
    v_sub_f32 v113, v113, v153
    v_fmac_f32 v150, v112, v112
    v_fmac_f32 v150, v113, v113
    v_lshlrev_b32 v114, 16, v47
    v_and_b32 v115, 0xffff0000, v47
    v_sub_f32 v114, v114, v153
    v_sub_f32 v115, v115, v153
    v_fmac_f32 v150, v114, v114
    v_fmac_f32 v150, v115, v115
    v_lshlrev_b32 v116, 16, v48
    v_and_b32 v117, 0xffff0000, v48
    v_sub_f32 v116, v116, v154
    v_sub_f32 v117, v117, v154
    v_fmac_f32 v151, v116, v116
    v_fmac_f32 v151, v117, v117
    v_lshlrev_b32 v118, 16, v49
    v_and_b32 v119, 0xffff0000, v49
    v_sub_f32 v118, v118, v154
    v_sub_f32 v119, v119, v154
    v_fmac_f32 v151, v118, v118
    v_fmac_f32 v151, v119, v119
    v_lshlrev_b32 v120, 16, v50
    v_and_b32 v121, 0xffff0000, v50
    v_sub_f32 v120, v120, v154
    v_sub_f32 v121, v121, v154
    v_fmac_f32 v151, v120, v120
    v_fmac_f32 v151, v121, v121
    v_lshlrev_b32 v122, 16, v51
    v_and_b32 v123, 0xffff0000, v51
    v_sub_f32 v122, v122, v154
    v_sub_f32 v123, v123, v154
    v_fmac_f32 v151, v122, v122
    v_fmac_f32 v151, v123, v123
P12_Q2_5:
    v_mov_b32 v3, v149
    v_mov_b32 v4, v150
    v_mov_b32 v5, v151
    s_nop 1
    v_permlane16_swap_b32 v149, v3
    v_permlane16_swap_b32 v150, v4
    v_permlane16_swap_b32 v151, v5
    v_add_f32 v149, v149, v3
    v_add_f32 v150, v150, v4
    v_add_f32 v151, v151, v5
    v_mov_b32 v3, v149
    v_mov_b32 v4, v150
    v_mov_b32 v5, v151
    s_nop 1
    v_permlane32_swap_b32 v149, v3
    v_permlane32_swap_b32 v150, v4
    v_permlane32_swap_b32 v151, v5
    v_add_f32 v149, v149, v3
    v_add_f32 v150, v150, v4
    v_add_f32 v151, v151, v5
    ds_write_b32 v2, v149 offset:2048
    ds_write_b32 v2, v150 offset:2560
    ds_write_b32 v2, v151 offset:3072
    s_waitcnt lgkmcnt(0)
    s_barrier
    ds_read_b128 v[124:127], v1 offset:2048
    ds_read_b128 v[128:131], v1 offset:2064
    ds_read_b128 v[132:135], v1 offset:2560
    ds_read_b128 v[136:139], v1 offset:2576
    ds_read_b128 v[140:143], v1 offset:3072
    ds_read_b128 v[144:147], v1 offset:3088
    s_waitcnt lgkmcnt(0)
    v_add_f32 v124, v124, v128
    v_add_f32 v125, v125, v129
    v_add_f32 v126, v126, v130
    v_add_f32 v127, v127, v131
    v_add_f32 v124, v124, v125
    v_add_f32 v126, v126, v127
    v_add_f32 v149, v124, v126
    v_add_f32 v132, v132, v136
    v_add_f32 v133, v133, v137
    v_add_f32 v134, v134, v138
    v_add_f32 v135, v135, v139
    v_add_f32 v132, v132, v133
    v_add_f32 v134, v134, v135
    v_add_f32 v150, v132, v134
    v_add_f32 v140, v140, v144
    v_add_f32 v141, v141, v145
    v_add_f32 v142, v142, v146
    v_add_f32 v143, v143, v147
    v_add_f32 v140, v140, v141
    v_add_f32 v142, v142, v143
    v_add_f32 v151, v140, v142
    v_mul_f32 v149, 0x3ae38e39, v149
    v_cvt_pk_bf16_f32 v149, v149, v149
    v_lshlrev_b32 v149, 16, v149
    v_add_f32 v149, 0x3727c5ac, v149
    v_cvt_pk_bf16_f32 v149, v149, v149
    v_lshlrev_b32 v149, 16, v149
    v_sqrt_f32 v149, v149
    s_nop 0
    v_cvt_pk_bf16_f32 v149, v149, v149
    v_lshlrev_b32 v149, 16, v149
    v_rcp_f32 v149, v149
    v_cvt_pk_bf16_f32 v3, v152, v152
    v_lshlrev_b32 v3, 16, v3
    v_sub_f32 v152, v152, v3
    v_mul_f32 v152, v152, v149
    v_mul_f32 v150, 0x3ae38e39, v150
    v_cvt_pk_bf16_f32 v150, v150, v150
    v_lshlrev_b32 v150, 16, v150
    v_add_f32 v150, 0x3727c5ac, v150
    v_cvt_pk_bf16_f32 v150, v150, v150
    v_lshlrev_b32 v150, 16, v150
    v_sqrt_f32 v150, v150
    s_nop 0
    v_cvt_pk_bf16_f32 v150, v150, v150
    v_lshlrev_b32 v150, 16, v150
    v_rcp_f32 v150, v150
    v_cvt_pk_bf16_f32 v3, v153, v153
    v_lshlrev_b32 v3, 16, v3
    v_sub_f32 v153, v153, v3
    v_mul_f32 v153, v153, v150
    v_mul_f32 v151, 0x3ae38e39, v151
    v_cvt_pk_bf16_f32 v151, v151, v151
    v_lshlrev_b32 v151, 16, v151
    v_add_f32 v151, 0x3727c5ac, v151
    v_cvt_pk_bf16_f32 v151, v151, v151
    v_lshlrev_b32 v151, 16, v151
    v_sqrt_f32 v151, v151
    s_nop 0
    v_cvt_pk_bf16_f32 v151, v151, v151
    v_lshlrev_b32 v151, 16, v151
    v_rcp_f32 v151, v151
    v_cvt_pk_bf16_f32 v3, v154, v154
    v_lshlrev_b32 v3, 16, v3
    v_sub_f32 v154, v154, v3
    v_mul_f32 v154, v154, v151
    v_fma_f32 v52, v52, v149, v152
    v_fma_f32 v53, v53, v149, v152
    v_fma_f32 v54, v54, v149, v152
    v_fma_f32 v55, v55, v149, v152
    v_fma_f32 v56, v56, v149, v152
    v_fma_f32 v57, v57, v149, v152
    v_fma_f32 v58, v58, v149, v152
    v_fma_f32 v59, v59, v149, v152
    v_fma_f32 v60, v60, v150, v153
    v_fma_f32 v61, v61, v150, v153
    v_fma_f32 v62, v62, v150, v153
    v_fma_f32 v63, v63, v150, v153
    v_fma_f32 v64, v64, v150, v153
    v_fma_f32 v65, v65, v150, v153
    v_fma_f32 v66, v66, v150, v153
    v_fma_f32 v67, v67, v150, v153
    v_fma_f32 v68, v68, v151, v154
    v_fma_f32 v69, v69, v151, v154
    v_fma_f32 v70, v70, v151, v154
    v_fma_f32 v71, v71, v151, v154
    v_fma_f32 v72, v72, v151, v154
    v_fma_f32 v73, v73, v151, v154
    v_fma_f32 v74, v74, v151, v154
    v_fma_f32 v75, v75, v151, v154
    v_fma_f32 v76, v76, v149, v152
    v_fma_f32 v77, v77, v149, v152
    v_fma_f32 v78, v78, v149, v152
    v_fma_f32 v79, v79, v149, v152
    v_fma_f32 v80, v80, v149, v152
    v_fma_f32 v81, v81, v149, v152
    v_fma_f32 v82, v82, v149, v152
    v_fma_f32 v83, v83, v149, v152
    v_fma_f32 v84, v84, v150, v153
    v_fma_f32 v85, v85, v150, v153
    v_fma_f32 v86, v86, v150, v153
    v_fma_f32 v87, v87, v150, v153
    v_fma_f32 v88, v88, v150, v153
    v_fma_f32 v89, v89, v150, v153
    v_fma_f32 v90, v90, v150, v153
    v_fma_f32 v91, v91, v150, v153
    v_fma_f32 v92, v92, v151, v154
    v_fma_f32 v93, v93, v151, v154
    v_fma_f32 v94, v94, v151, v154
    v_fma_f32 v95, v95, v151, v154
    v_fma_f32 v96, v96, v151, v154
    v_fma_f32 v97, v97, v151, v154
    v_fma_f32 v98, v98, v151, v154
    v_fma_f32 v99, v99, v151, v154
    v_fma_f32 v100, v100, v149, v152
    v_fma_f32 v101, v101, v149, v152
    v_fma_f32 v102, v102, v149, v152
    v_fma_f32 v103, v103, v149, v152
    v_fma_f32 v104, v104, v149, v152
    v_fma_f32 v105, v105, v149, v152
    v_fma_f32 v106, v106, v149, v152
    v_fma_f32 v107, v107, v149, v152
    v_fma_f32 v108, v108, v150, v153
    v_fma_f32 v109, v109, v150, v153
    v_fma_f32 v110, v110, v150, v153
    v_fma_f32 v111, v111, v150, v153
    v_fma_f32 v112, v112, v150, v153
    v_fma_f32 v113, v113, v150, v153
    v_fma_f32 v114, v114, v150, v153
    v_fma_f32 v115, v115, v150, v153
    v_fma_f32 v116, v116, v151, v154
    v_fma_f32 v117, v117, v151, v154
    v_fma_f32 v118, v118, v151, v154
    v_fma_f32 v119, v119, v151, v154
    v_fma_f32 v120, v120, v151, v154
    v_fma_f32 v121, v121, v151, v154
    v_fma_f32 v122, v122, v151, v154
    v_fma_f32 v123, v123, v151, v154
    s_lshl_b32 s76, s24, 6
    v_add_u32 v162, s76, v0
    s_cmp_lt_u32 s24, 5
    s_cbranch_scc1 P0_W1_6
    s_mul_i32 s76, s2, 162
    s_sub_u32 s76, s76, 320
    v_add_u32 v156, s76, v162
    v_lshrrev_b32 v157, 6, v156
    v_mul_u32_u24 v158, 3641, v157
    v_lshrrev_b32 v158, 16, v158
    v_mul_u32_u24 v159, 18, v158
    v_sub_u32 v159, v157, v159
    v_and_b32 v160, 15, v156
    v_lshl_add_u32 v160, v158, 4, v160
    v_bfe_u32 v161, v156, 4, 2
    v_lshlrev_b32 v161, 3, v161
    v_lshl_add_u32 v161, v159, 5, v161
    v_mul_u32_u24 v161, 1152, v161
    v_lshl_add_u32 v161, v160, 1, v161
    v_lshlrev_b32 v156, 4, v156
    v_cmp_gt_u32 vcc, 482, v162
    v_mov_b32 v157, 0x7f000000
    s_nop 0
    v_cndmask_b32 v156, v157, v156, vcc
    v_cndmask_b32 v161, v157, v161, vcc
    s_mov_b32 s77, 4608
    buffer_load_ushort v164, v161, s[68:71], 0 offen offset:0
    buffer_load_ushort v165, v161, s[68:71], 0 offen offset:1152
    buffer_load_ushort v166, v161, s[68:71], 0 offen offset:2304
    buffer_load_ushort v167, v161, s[68:71], 0 offen offset:3456
    buffer_load_ushort v168, v161, s[68:71], s77 offen offset:0
    buffer_load_ushort v169, v161, s[68:71], s77 offen offset:1152
    buffer_load_ushort v170, v161, s[68:71], s77 offen offset:2304
    buffer_load_ushort v171, v161, s[68:71], s77 offen offset:3456
P0_W1_6:
    v_mov_b32 v132, -1
    v_mov_b32 v133, -1
    v_mov_b32 v134, -1
    v_mov_b32 v135, -1
    s_mul_i32 s76, s37, 36864
    s_add_u32 s77, s76, 5242880
    s_add_u32 s78, s76, 11534336
    s_mul_i32 s79, s36, 18
    s_lshl_b32 s76, s24, 6
    v_add_u32 v124, s76, v0
    v_and_b32 v125, 31, v124
    v_lshrrev_b32 v126, 5, v124
    v_add_u32 v126, s79, v126
    v_lshrrev_b32 v127, 4, v125
    v_mul_u32_u24 v127, 1152, v127
    v_lshl_add_u32 v127, v126, 4, v127
    v_and_b32 v128, 15, v125
    v_add_u32 v127, v127, v128
    v_lshlrev_b32 v127, 4, v127
    buffer_store_dwordx4 v[132:135], v127, s[28:31], s77 offen sc1
    s_cmp_lg_u32 s24, 1
    s_cbranch_scc1 PF_7
    v_add_u32 v124, 512, v0
    v_and_b32 v125, 31, v124
    v_lshrrev_b32 v126, 5, v124
    v_add_u32 v126, s79, v126
    v_lshrrev_b32 v127, 4, v125
    v_mul_u32_u24 v127, 1152, v127
    v_lshl_add_u32 v127, v126, 4, v127
    v_and_b32 v128, 15, v125
    v_add_u32 v127, v127, v128
    v_lshlrev_b32 v127, 4, v127
    buffer_store_dwordx4 v[132:135], v127, s[28:31], s77 offen sc1
    s_lshl_b32 s76, s37, 10
    s_lshl_b32 s77, s36, 8
    s_add_u32 s76, s76, s77
    s_add_u32 s76, s76, 65536
    v_lshlrev_b32 v125, 4, v0
    s_mov_b64 exec, 0xffff
    buffer_store_dwordx4 v[132:135], v125, s[28:31], s76 offen sc1
    s_mov_b64 exec, -1
PF_7:
    s_cmp_lg_u32 s24, 0
    s_cbranch_scc1 W0DONE_8
    s_mov_b32 s56, 0
    v_and_b32 v4, 1, v0
    v_lshlrev_b32 v4, 6, v4
W0LOOP_9:
    buffer_load_dword v3, v4, s[72:75], 0 offen offset:0 sc1
    s_waitcnt vmcnt(0)
    v_readlane_b32 s76, v3, 0
    v_readlane_b32 s77, v3, 1
    s_add_u32 s56, s56, 1
    s_add_u32 s76, s76, s77
    s_cmp_ge_u32 s76, 72
    s_cbranch_scc1 W0DONE_8
    s_cmp_gt_u32 s56, 0x400000
    s_cbranch_scc1 W0DONE_8
    s_sleep 4
    s_branch W0LOOP_9
W0DONE_8:
    s_barrier
    v_lshrrev_b32 v1, 4, v0
    v_lshlrev_b32 v1, 4, v1
    s_add_u32 s45, s46, 40960
    buffer_load_dwordx4 v[124:127], v1, s[28:31], s45 offen offset:1152 sc1
    buffer_load_dwordx4 v[128:131], v1, s[28:31], s45 offen sc1
    s_add_u32 s45, s47, 40960
    buffer_load_dwordx4 v[132:135], v1, s[28:31], s45 offen offset:1152 sc1
    buffer_load_dwordx4 v[136:139], v1, s[28:31], s45 offen sc1
    s_add_u32 s45, s48, 40960
    buffer_load_dwordx4 v[140:143], v1, s[28:31], s45 offen offset:1152 sc1
    buffer_load_dwordx4 v[144:147], v1, s[28:31], s45 offen sc1
    s_waitcnt vmcnt(4)
    v_lshlrev_b32 v1, 16, v124
    v_and_b32 v2, 0xffff0000, v124
    v_lshlrev_b32 v3, 16, v128
    v_and_b32 v4, 0xffff0000, v128
    v_fma_f32 v52, v52, v1, v3
    v_fma_f32 v53, v53, v2, v4
    v_cvt_pk_bf16_f32 v16, v52, v53
    v_fma_f32 v60, v60, v1, v3
    v_fma_f32 v61, v61, v2, v4
    v_cvt_pk_bf16_f32 v20, v60, v61
    v_fma_f32 v68, v68, v1, v3
    v_fma_f32 v69, v69, v2, v4
    v_cvt_pk_bf16_f32 v24, v68, v69
    v_lshlrev_b32 v1, 16, v125
    v_and_b32 v2, 0xffff0000, v125
    v_lshlrev_b32 v3, 16, v129
    v_and_b32 v4, 0xffff0000, v129
    v_fma_f32 v54, v54, v1, v3
    v_fma_f32 v55, v55, v2, v4
    v_cvt_pk_bf16_f32 v17, v54, v55
    v_fma_f32 v62, v62, v1, v3
    v_fma_f32 v63, v63, v2, v4
    v_cvt_pk_bf16_f32 v21, v62, v63
    v_fma_f32 v70, v70, v1, v3
    v_fma_f32 v71, v71, v2, v4
    v_cvt_pk_bf16_f32 v25, v70, v71
    v_lshlrev_b32 v1, 16, v126
    v_and_b32 v2, 0xffff0000, v126
    v_lshlrev_b32 v3, 16, v130
    v_and_b32 v4, 0xffff0000, v130
    v_fma_f32 v56, v56, v1, v3
    v_fma_f32 v57, v57, v2, v4
    v_cvt_pk_bf16_f32 v18, v56, v57
    v_fma_f32 v64, v64, v1, v3
    v_fma_f32 v65, v65, v2, v4
    v_cvt_pk_bf16_f32 v22, v64, v65
    v_fma_f32 v72, v72, v1, v3
    v_fma_f32 v73, v73, v2, v4
    v_cvt_pk_bf16_f32 v26, v72, v73
    v_lshlrev_b32 v1, 16, v127
    v_and_b32 v2, 0xffff0000, v127
    v_lshlrev_b32 v3, 16, v131
    v_and_b32 v4, 0xffff0000, v131
    v_fma_f32 v58, v58, v1, v3
    v_fma_f32 v59, v59, v2, v4
    v_cvt_pk_bf16_f32 v19, v58, v59
    v_fma_f32 v66, v66, v1, v3
    v_fma_f32 v67, v67, v2, v4
    v_cvt_pk_bf16_f32 v23, v66, v67
    v_fma_f32 v74, v74, v1, v3
    v_fma_f32 v75, v75, v2, v4
    v_cvt_pk_bf16_f32 v27, v74, v75
    s_waitcnt vmcnt(2)
    v_lshlrev_b32 v1, 16, v132
    v_and_b32 v2, 0xffff0000, v132
    v_lshlrev_b32 v3, 16, v136
    v_and_b32 v4, 0xffff0000, v136
    v_fma_f32 v76, v76, v1, v3
    v_fma_f32 v77, v77, v2, v4
    v_cvt_pk_bf16_f32 v28, v76, v77
    v_fma_f32 v84, v84, v1, v3
    v_fma_f32 v85, v85, v2, v4
    v_cvt_pk_bf16_f32 v32, v84, v85
    v_fma_f32 v92, v92, v1, v3
    v_fma_f32 v93, v93, v2, v4
    v_cvt_pk_bf16_f32 v36, v92, v93
    v_lshlrev_b32 v1, 16, v133
    v_and_b32 v2, 0xffff0000, v133
    v_lshlrev_b32 v3, 16, v137
    v_and_b32 v4, 0xffff0000, v137
    v_fma_f32 v78, v78, v1, v3
    v_fma_f32 v79, v79, v2, v4
    v_cvt_pk_bf16_f32 v29, v78, v79
    v_fma_f32 v86, v86, v1, v3
    v_fma_f32 v87, v87, v2, v4
    v_cvt_pk_bf16_f32 v33, v86, v87
    v_fma_f32 v94, v94, v1, v3
    v_fma_f32 v95, v95, v2, v4
    v_cvt_pk_bf16_f32 v37, v94, v95
    v_lshlrev_b32 v1, 16, v134
    v_and_b32 v2, 0xffff0000, v134
    v_lshlrev_b32 v3, 16, v138
    v_and_b32 v4, 0xffff0000, v138
    v_fma_f32 v80, v80, v1, v3
    v_fma_f32 v81, v81, v2, v4
    v_cvt_pk_bf16_f32 v30, v80, v81
    v_fma_f32 v88, v88, v1, v3
    v_fma_f32 v89, v89, v2, v4
    v_cvt_pk_bf16_f32 v34, v88, v89
    v_fma_f32 v96, v96, v1, v3
    v_fma_f32 v97, v97, v2, v4
    v_cvt_pk_bf16_f32 v38, v96, v97
    v_lshlrev_b32 v1, 16, v135
    v_and_b32 v2, 0xffff0000, v135
    v_lshlrev_b32 v3, 16, v139
    v_and_b32 v4, 0xffff0000, v139
    v_fma_f32 v82, v82, v1, v3
    v_fma_f32 v83, v83, v2, v4
    v_cvt_pk_bf16_f32 v31, v82, v83
    v_fma_f32 v90, v90, v1, v3
    v_fma_f32 v91, v91, v2, v4
    v_cvt_pk_bf16_f32 v35, v90, v91
    v_fma_f32 v98, v98, v1, v3
    v_fma_f32 v99, v99, v2, v4
    v_cvt_pk_bf16_f32 v39, v98, v99
    s_waitcnt vmcnt(0)
    v_lshlrev_b32 v1, 16, v140
    v_and_b32 v2, 0xffff0000, v140
    v_lshlrev_b32 v3, 16, v144
    v_and_b32 v4, 0xffff0000, v144
    v_fma_f32 v100, v100, v1, v3
    v_fma_f32 v101, v101, v2, v4
    v_cvt_pk_bf16_f32 v40, v100, v101
    v_fma_f32 v108, v108, v1, v3
    v_fma_f32 v109, v109, v2, v4
    v_cvt_pk_bf16_f32 v44, v108, v109
    v_fma_f32 v116, v116, v1, v3
    v_fma_f32 v117, v117, v2, v4
    v_cvt_pk_bf16_f32 v48, v116, v117
    v_lshlrev_b32 v1, 16, v141
    v_and_b32 v2, 0xffff0000, v141
    v_lshlrev_b32 v3, 16, v145
    v_and_b32 v4, 0xffff0000, v145
    v_fma_f32 v102, v102, v1, v3
    v_fma_f32 v103, v103, v2, v4
    v_cvt_pk_bf16_f32 v41, v102, v103
    v_fma_f32 v110, v110, v1, v3
    v_fma_f32 v111, v111, v2, v4
    v_cvt_pk_bf16_f32 v45, v110, v111
    v_fma_f32 v118, v118, v1, v3
    v_fma_f32 v119, v119, v2, v4
    v_cvt_pk_bf16_f32 v49, v118, v119
    v_lshlrev_b32 v1, 16, v142
    v_and_b32 v2, 0xffff0000, v142
    v_lshlrev_b32 v3, 16, v146
    v_and_b32 v4, 0xffff0000, v146
    v_fma_f32 v104, v104, v1, v3
    v_fma_f32 v105, v105, v2, v4
    v_cvt_pk_bf16_f32 v42, v104, v105
    v_fma_f32 v112, v112, v1, v3
    v_fma_f32 v113, v113, v2, v4
    v_cvt_pk_bf16_f32 v46, v112, v113
    v_fma_f32 v120, v120, v1, v3
    v_fma_f32 v121, v121, v2, v4
    v_cvt_pk_bf16_f32 v50, v120, v121
    v_lshlrev_b32 v1, 16, v143
    v_and_b32 v2, 0xffff0000, v143
    v_lshlrev_b32 v3, 16, v147
    v_and_b32 v4, 0xffff0000, v147
    v_fma_f32 v106, v106, v1, v3
    v_fma_f32 v107, v107, v2, v4
    v_cvt_pk_bf16_f32 v43, v106, v107
    v_fma_f32 v114, v114, v1, v3
    v_fma_f32 v115, v115, v2, v4
    v_cvt_pk_bf16_f32 v47, v114, v115
    v_fma_f32 v122, v122, v1, v3
    v_fma_f32 v123, v123, v2, v4
    v_cvt_pk_bf16_f32 v51, v122, v123
    v_add_u32 v153, s40, v13
    v_add_u32 v154, 55296, v153
    s_mul_i32 s45, s24, 3072
    v_add_u32 v151, 110592, v13
    v_add_u32 v152, s45, v151
    ds_write_b128 v152, v[16:19] offset:0
    ds_write_b128 v152, v[20:23] offset:1024
    ds_write_b128 v152, v[24:27] offset:2048
    s_cmp_lg_u32 s24, 0
    s_cbranch_scc1 P12_H1_10
    ds_write_b128 v151, v[40:43] offset:24576
    ds_write_b128 v151, v[44:47] offset:25600
    ds_write_b128 v151, v[48:51] offset:26624
P12_H1_10:
    s_waitcnt lgkmcnt(0)
    s_cmp_lt_u32 s24, 5
    s_cbranch_scc1 P0_W2_11
    s_waitcnt vmcnt(0)
    v_lshl_or_b32 v172, v165, 16, v164
    v_lshl_or_b32 v173, v167, 16, v166
    v_lshl_or_b32 v174, v169, 16, v168
    v_lshl_or_b32 v175, v171, 16, v170
    s_mov_b32 s77, 1048576
    buffer_store_dwordx4 v[172:175], v156, s[28:31], s77 offen sc1
P0_W2_11:
    v_lshrrev_b32 v1, 2, v0
    v_mul_u32_u24 v1, 288, v1
    v_and_b32 v2, 3, v0
    v_lshl_add_u32 v1, v2, 3, v1
    s_cmp_ge_u32 s24, 3
    s_cselect_b32 s49, 2, 1
    s_cselect_b32 s50, 3, 0
    s_sub_u32 s50, s24, s50
    s_mul_i32 s50, s50, 3
    s_sub_u32 s45, s24, 6
    s_mul_i32 s45, s45, 5
    s_cmp_ge_u32 s24, 6
    s_cselect_b32 s49, 0, s49
    s_cselect_b32 s50, s45, s50
    s_mul_i32 s45, s49, 9216
    s_lshl_b32 s46, s50, 5
    s_add_u32 s45, s45, s46
    v_add_u32 v148, s45, v1
    v_add_u32 v149, 55296, v148
    s_cmp_ge_u32 s24, 6
    s_cbranch_scc1 P12_GB_12
    s_waitcnt vmcnt(18)
    s_barrier
    s_mul_i32 s45, s43, 3072
    s_add_u32 s43, s43, 1
    s_cmp_ge_u32 s43, 9
    s_cselect_b32 s43, 0, s43
    v_add_u32 v150, s45, v151
    ds_read_b128 v[124:127], v150 offset:0
    ds_read_b128 v[128:131], v150 offset:1024
    ds_read_b128 v[132:135], v150 offset:2048
    ds_read_b64_tr_b16 v[92:93], v148 offset:0
    ds_read_b64_tr_b16 v[94:95], v148 offset:4608
    ds_read_b64_tr_b16 v[96:97], v148 offset:32
    ds_read_b64_tr_b16 v[98:99], v148 offset:4640
    ds_read_b64_tr_b16 v[100:101], v148 offset:64
    ds_read_b64_tr_b16 v[102:103], v148 offset:4672
    s_waitcnt vmcnt(14)
    s_barrier
    s_mul_i32 s45, s43, 3072
    s_add_u32 s43, s43, 1
    s_cmp_ge_u32 s43, 9
    s_cselect_b32 s43, 0, s43
    v_add_u32 v150, s45, v151
    ds_read_b128 v[136:139], v150 offset:0
    ds_read_b128 v[140:143], v150 offset:1024
    ds_read_b128 v[144:147], v150 offset:2048
    ds_read_b64_tr_b16 v[104:105], v148 offset:27648
    ds_read_b64_tr_b16 v[106:107], v148 offset:32256
    s_waitcnt lgkmcnt(9)
    v_mfma_f32_16x16x32_bf16 v[52:55], v[92:95], v[124:127], 0
    v_mfma_f32_16x16x32_bf16 v[56:59], v[92:95], v[128:131], 0
    v_mfma_f32_16x16x32_bf16 v[60:63], v[92:95], v[132:135], 0
    ds_read_b64_tr_b16 v[108:109], v148 offset:27680
    ds_read_b64_tr_b16 v[110:111], v148 offset:32288
    s_waitcnt lgkmcnt(9)
    v_mfma_f32_16x16x32_bf16 v[64:67], v[96:99], v[124:127], 0
    v_mfma_f32_16x16x32_bf16 v[68:71], v[96:99], v[128:131], 0
    v_mfma_f32_16x16x32_bf16 v[72:75], v[96:99], v[132:135], 0
    ds_read_b64_tr_b16 v[112:113], v148 offset:27712
    ds_read_b64_tr_b16 v[114:115], v148 offset:32320
    s_waitcnt lgkmcnt(9)
    v_mfma_f32_16x16x32_bf16 v[76:79], v[100:103], v[124:127], 0
    v_mfma_f32_16x16x32_bf16 v[80:83], v[100:103], v[128:131], 0
    v_mfma_f32_16x16x32_bf16 v[84:87], v[100:103], v[132:135], 0
    s_waitcnt vmcnt(10)
    s_barrier
    s_mul_i32 s45, s43, 3072
    s_add_u32 s43, s43, 1
    s_cmp_ge_u32 s43, 9
    s_cselect_b32 s43, 0, s43
    v_add_u32 v150, s45, v151
    ds_read_b128 v[124:127], v150 offset:0
    ds_read_b128 v[128:131], v150 offset:1024
    ds_read_b128 v[132:135], v150 offset:2048
    ds_read_b64_tr_b16 v[116:117], v149 offset:0
    ds_read_b64_tr_b16 v[118:119], v149 offset:4608
    s_waitcnt lgkmcnt(9)
    v_mfma_f32_16x16x32_bf16 v[52:55], v[104:107], v[136:139], v[52:55]
    v_mfma_f32_16x16x32_bf16 v[56:59], v[104:107], v[140:143], v[56:59]
    v_mfma_f32_16x16x32_bf16 v[60:63], v[104:107], v[144:147], v[60:63]
    s_mul_i32 s44, s42, 110592
    s_add_u32 s44, s44, s41
    s_add_u32 s42, s42, 1
    s_cmp_ge_u32 s42, 9
    s_cselect_b32 s42, 0, s42
    s_add_u32 m0, s40, 0
    s_nop 0
    buffer_load_dwordx4 v9, s[8:11], s44 offen lds
    s_add_u32 m0, s40, 1024
    s_nop 0
    buffer_load_dwordx4 v10, s[8:11], s44 offen lds
    ds_read_b64_tr_b16 v[120:121], v149 offset:32
    ds_read_b64_tr_b16 v[122:123], v149 offset:4640
    s_waitcnt lgkmcnt(9)
    v_mfma_f32_16x16x32_bf16 v[64:67], v[108:111], v[136:139], v[64:67]
    v_mfma_f32_16x16x32_bf16 v[68:71], v[108:111], v[140:143], v[68:71]
    v_mfma_f32_16x16x32_bf16 v[72:75], v[108:111], v[144:147], v[72:75]
    s_add_u32 m0, s40, 2048
    s_nop 0
    buffer_load_dwordx4 v11, s[8:11], s44 offen lds
    s_add_u32 m0, s40, 3072
    s_mov_b64 exec, 0xffffff
    buffer_load_dwordx4 v12, s[8:11], s44 offen lds
    s_mov_b64 exec, -1
    ds_read_b64_tr_b16 v[92:93], v149 offset:64
    ds_read_b64_tr_b16 v[94:95], v149 offset:4672
    s_waitcnt lgkmcnt(9)
    v_mfma_f32_16x16x32_bf16 v[76:79], v[112:115], v[136:139], v[76:79]
    v_mfma_f32_16x16x32_bf16 v[80:83], v[112:115], v[140:143], v[80:83]
    v_mfma_f32_16x16x32_bf16 v[84:87], v[112:115], v[144:147], v[84:87]
    s_waitcnt vmcnt(10)
    s_barrier
    s_mul_i32 s45, s43, 3072
    s_add_u32 s43, s43, 1
    s_cmp_ge_u32 s43, 9
    s_cselect_b32 s43, 0, s43
    v_add_u32 v150, s45, v151
    ds_read_b128 v[136:139], v150 offset:0
    ds_read_b128 v[140:143], v150 offset:1024
    ds_read_b128 v[144:147], v150 offset:2048
    ds_read_b64_tr_b16 v[96:97], v149 offset:27648
    ds_read_b64_tr_b16 v[98:99], v149 offset:32256
    s_waitcnt lgkmcnt(9)
    v_mfma_f32_16x16x32_bf16 v[52:55], v[116:119], v[124:127], v[52:55]
    v_mfma_f32_16x16x32_bf16 v[56:59], v[116:119], v[128:131], v[56:59]
    v_mfma_f32_16x16x32_bf16 v[60:63], v[116:119], v[132:135], v[60:63]
    s_mul_i32 s44, s42, 110592
    s_add_u32 s44, s44, s41
    s_add_u32 s42, s42, 1
    s_cmp_ge_u32 s42, 9
    s_cselect_b32 s42, 0, s42
    s_add_u32 m0, s40, 27648
    s_nop 0
    buffer_load_dwordx4 v9, s[8:11], s44 offen lds
    s_add_u32 m0, s40, 28672
    s_nop 0
    buffer_load_dwordx4 v10, s[8:11], s44 offen lds
    ds_read_b64_tr_b16 v[100:101], v149 offset:27680
    ds_read_b64_tr_b16 v[102:103], v149 offset:32288
    s_waitcnt lgkmcnt(9)
    v_mfma_f32_16x16x32_bf16 v[64:67], v[120:123], v[124:127], v[64:67]
    v_mfma_f32_16x16x32_bf16 v[68:71], v[120:123], v[128:131], v[68:71]
    v_mfma_f32_16x16x32_bf16 v[72:75], v[120:123], v[132:135], v[72:75]
    s_add_u32 m0, s40, 29696
    s_nop 0
    buffer_load_dwordx4 v11, s[8:11], s44 offen lds
    s_add_u32 m0, s40, 30720
    s_mov_b64 exec, 0xffffff
    buffer_load_dwordx4 v12, s[8:11], s44 offen lds
    s_mov_b64 exec, -1
    ds_read_b64_tr_b16 v[104:105], v149 offset:27712
    ds_read_b64_tr_b16 v[106:107], v149 offset:32320
    s_waitcnt lgkmcnt(9)
    v_mfma_f32_16x16x32_bf16 v[76:79], v[92:95], v[124:127], v[76:79]
    v_mfma_f32_16x16x32_bf16 v[80:83], v[92:95], v[128:131], v[80:83]
    v_mfma_f32_16x16x32_bf16 v[84:87], v[92:95], v[132:135], v[84:87]
    s_waitcnt vmcnt(4)
    s_barrier
    s_mul_i32 s45, s43, 3072
    s_add_u32 s43, s43, 1
    s_cmp_ge_u32 s43, 9
    s_cselect_b32 s43, 0, s43
    v_add_u32 v150, s45, v151
    ds_read_b128 v[124:127], v150 offset:0
    ds_read_b128 v[128:131], v150 offset:1024
    ds_read_b128 v[132:135], v150 offset:2048
    ds_read_b64_tr_b16 v[108:109], v148 offset:0
    ds_read_b64_tr_b16 v[110:111], v148 offset:4608
    s_waitcnt lgkmcnt(9)
    v_mfma_f32_16x16x32_bf16 v[52:55], v[96:99], v[136:139], v[52:55]
    v_mfma_f32_16x16x32_bf16 v[56:59], v[96:99], v[140:143], v[56:59]
    v_mfma_f32_16x16x32_bf16 v[60:63], v[96:99], v[144:147], v[60:63]
    s_mul_i32 s44, s42, 110592
    s_add_u32 s44, s44, s41
    s_add_u32 s42, s42, 1
    s_cmp_ge_u32 s42, 9
    s_cselect_b32 s42, 0, s42
    s_add_u32 m0, s40, 55296
    s_nop 0
    buffer_load_dwordx4 v9, s[8:11], s44 offen lds
    s_add_u32 m0, s40, 56320
    s_nop 0
    buffer_load_dwordx4 v10, s[8:11], s44 offen lds
    ds_read_b64_tr_b16 v[112:113], v148 offset:32
    ds_read_b64_tr_b16 v[114:115], v148 offset:4640
    s_waitcnt lgkmcnt(9)
    v_mfma_f32_16x16x32_bf16 v[64:67], v[100:103], v[136:139], v[64:67]
    v_mfma_f32_16x16x32_bf16 v[68:71], v[100:103], v[140:143], v[68:71]
    v_mfma_f32_16x16x32_bf16 v[72:75], v[100:103], v[144:147], v[72:75]
    s_add_u32 m0, s40, 57344
    s_nop 0
    buffer_load_dwordx4 v11, s[8:11], s44 offen lds
    s_add_u32 m0, s40, 58368
    s_mov_b64 exec, 0xffffff
    buffer_load_dwordx4 v12, s[8:11], s44 offen lds
    s_mov_b64 exec, -1
    ds_read_b64_tr_b16 v[116:117], v148 offset:64
    ds_read_b64_tr_b16 v[118:119], v148 offset:4672
    s_waitcnt lgkmcnt(9)
    v_mfma_f32_16x16x32_bf16 v[76:79], v[104:107], v[136:139], v[76:79]
    v_mfma_f32_16x16x32_bf16 v[80:83], v[104:107], v[140:143], v[80:83]
    v_mfma_f32_16x16x32_bf16 v[84:87], v[104:107], v[144:147], v[84:87]
    s_waitcnt vmcnt(4)
    s_barrier
    s_cmp_lg_u32 s24, 0
    s_cbranch_scc1 P12_ARR2_14
    v_mov_b32 v1, 1
    s_and_b32 s76, s2, 1
    s_lshl_b32 s76, s76, 6
    s_add_u32 s76, s76, 128
    s_mov_b64 exec, 1
    buffer_atomic_add v1, off, s[72:75], s76 sc1
    s_mov_b64 exec, -1
P12_ARR2_14:
    s_mul_i32 s45, s43, 3072
    s_add_u32 s43, s43, 1
    s_cmp_ge_u32 s43, 9
    s_cselect_b32 s43, 0, s43
    v_add_u32 v150, s45, v151
    ds_read_b128 v[136:139], v150 offset:0
    ds_read_b128 v[140:143], v150 offset:1024
    ds_read_b128 v[144:147], v150 offset:2048
    ds_read_b64_tr_b16 v[120:121], v148 offset:27648
    ds_read_b64_tr_b16 v[122:123], v148 offset:32256
    s_waitcnt lgkmcnt(9)
    v_mfma_f32_16x16x32_bf16 v[52:55], v[108:111], v[124:127], v[52:55]
    v_mfma_f32_16x16x32_bf16 v[56:59], v[108:111], v[128:131], v[56:59]
    v_mfma_f32_16x16x32_bf16 v[60:63], v[108:111], v[132:135], v[60:63]
    s_mul_i32 s44, s42, 110592
    s_add_u32 s44, s44, s41
    s_add_u32 s42, s42, 1
    s_cmp_ge_u32 s42, 9
    s_cselect_b32 s42, 0, s42
    s_add_u32 m0, s40, 82944
    s_nop 0
    buffer_load_dwordx4 v9, s[8:11], s44 offen lds
    s_add_u32 m0, s40, 83968
    s_nop 0
    buffer_load_dwordx4 v10, s[8:11], s44 offen lds
    ds_read_b64_tr_b16 v[92:93], v148 offset:27680
    ds_read_b64_tr_b16 v[94:95], v148 offset:32288
    s_waitcnt lgkmcnt(9)
    v_mfma_f32_16x16x32_bf16 v[64:67], v[112:115], v[124:127], v[64:67]
    v_mfma_f32_16x16x32_bf16 v[68:71], v[112:115], v[128:131], v[68:71]
    v_mfma_f32_16x16x32_bf16 v[72:75], v[112:115], v[132:135], v[72:75]
    s_add_u32 m0, s40, 84992
    s_nop 0
    buffer_load_dwordx4 v11, s[8:11], s44 offen lds
    s_add_u32 m0, s40, 86016
    s_mov_b64 exec, 0xffffff
    buffer_load_dwordx4 v12, s[8:11], s44 offen lds
    s_mov_b64 exec, -1
    ds_read_b64_tr_b16 v[96:97], v148 offset:27712
    ds_read_b64_tr_b16 v[98:99], v148 offset:32320
    s_waitcnt lgkmcnt(9)
    v_mfma_f32_16x16x32_bf16 v[76:79], v[116:119], v[124:127], v[76:79]
    v_mfma_f32_16x16x32_bf16 v[80:83], v[116:119], v[128:131], v[80:83]
    v_mfma_f32_16x16x32_bf16 v[84:87], v[116:119], v[132:135], v[84:87]
    s_waitcnt vmcnt(4)
    s_barrier
    s_mul_i32 s45, s43, 3072
    s_add_u32 s43, s43, 1
    s_cmp_ge_u32 s43, 9
    s_cselect_b32 s43, 0, s43
    v_add_u32 v150, s45, v151
    ds_read_b128 v[124:127], v150 offset:0
    ds_read_b128 v[128:131], v150 offset:1024
    ds_read_b128 v[132:135], v150 offset:2048
    ds_read_b64_tr_b16 v[100:101], v149 offset:0
    ds_read_b64_tr_b16 v[102:103], v149 offset:4608
    s_waitcnt lgkmcnt(9)
    v_mfma_f32_16x16x32_bf16 v[52:55], v[120:123], v[136:139], v[52:55]
    v_mfma_f32_16x16x32_bf16 v[56:59], v[120:123], v[140:143], v[56:59]
    v_mfma_f32_16x16x32_bf16 v[60:63], v[120:123], v[144:147], v[60:63]
    s_mul_i32 s44, s42, 110592
    s_add_u32 s44, s44, s41
    s_add_u32 s42, s42, 1
    s_cmp_ge_u32 s42, 9
    s_cselect_b32 s42, 0, s42
    s_add_u32 m0, s40, 0
    s_nop 0
    buffer_load_dwordx4 v9, s[8:11], s44 offen lds
    s_add_u32 m0, s40, 1024
    s_nop 0
    buffer_load_dwordx4 v10, s[8:11], s44 offen lds
    ds_read_b64_tr_b16 v[104:105], v149 offset:32
    ds_read_b64_tr_b16 v[106:107], v149 offset:4640
    s_waitcnt lgkmcnt(9)
    v_mfma_f32_16x16x32_bf16 v[64:67], v[92:95], v[136:139], v[64:67]
    v_mfma_f32_16x16x32_bf16 v[68:71], v[92:95], v[140:143], v[68:71]
    v_mfma_f32_16x16x32_bf16 v[72:75], v[92:95], v[144:147], v[72:75]
    s_add_u32 m0, s40, 2048
    s_nop 0
    buffer_load_dwordx4 v11, s[8:11], s44 offen lds
    s_add_u32 m0, s40, 3072
    s_mov_b64 exec, 0xffffff
    buffer_load_dwordx4 v12, s[8:11], s44 offen lds
    s_mov_b64 exec, -1
    ds_read_b64_tr_b16 v[108:109], v149 offset:64
    ds_read_b64_tr_b16 v[110:111], v149 offset:4672
    s_waitcnt lgkmcnt(9)
    v_mfma_f32_16x16x32_bf16 v[76:79], v[96:99], v[136:139], v[76:79]
    v_mfma_f32_16x16x32_bf16 v[80:83], v[96:99], v[140:143], v[80:83]
    v_mfma_f32_16x16x32_bf16 v[84:87], v[96:99], v[144:147], v[84:87]
    s_waitcnt vmcnt(4)
    s_barrier
    s_mul_i32 s45, s43, 3072
    s_add_u32 s43, s43, 1
    s_cmp_ge_u32 s43, 9
    s_cselect_b32 s43, 0, s43
    v_add_u32 v150, s45, v151
    ds_read_b128 v[136:139], v150 offset:0
    ds_read_b128 v[140:143], v150 offset:1024
    ds_read_b128 v[144:147], v150 offset:2048
    ds_read_b64_tr_b16 v[112:113], v149 offset:27648
    ds_read_b64_tr_b16 v[114:115], v149 offset:32256
    s_waitcnt lgkmcnt(9)
    v_mfma_f32_16x16x32_bf16 v[52:55], v[100:103], v[124:127], v[52:55]
    v_mfma_f32_16x16x32_bf16 v[56:59], v[100:103], v[128:131], v[56:59]
    v_mfma_f32_16x16x32_bf16 v[60:63], v[100:103], v[132:135], v[60:63]
    s_mul_i32 s44, s42, 110592
    s_add_u32 s44, s44, s41
    s_add_u32 s44, s44, 995328
    s_add_u32 s42, s42, 1
    s_cmp_ge_u32 s42, 9
    s_cselect_b32 s42, 0, s42
    s_add_u32 m0, s40, 27648
    s_nop 0
    buffer_load_dwordx4 v9, s[8:11], s44 offen lds
    s_add_u32 m0, s40, 28672
    s_nop 0
    buffer_load_dwordx4 v10, s[8:11], s44 offen lds
    ds_read_b64_tr_b16 v[116:117], v149 offset:27680
    ds_read_b64_tr_b16 v[118:119], v149 offset:32288
    s_waitcnt lgkmcnt(9)
    v_mfma_f32_16x16x32_bf16 v[64:67], v[104:107], v[124:127], v[64:67]
    v_mfma_f32_16x16x32_bf16 v[68:71], v[104:107], v[128:131], v[68:71]
    v_mfma_f32_16x16x32_bf16 v[72:75], v[104:107], v[132:135], v[72:75]
    s_add_u32 m0, s40, 29696
    s_nop 0
    buffer_load_dwordx4 v11, s[8:11], s44 offen lds
    s_add_u32 m0, s40, 30720
    s_mov_b64 exec, 0xffffff
    buffer_load_dwordx4 v12, s[8:11], s44 offen lds
    s_mov_b64 exec, -1
    ds_read_b64_tr_b16 v[120:121], v149 offset:27712
    ds_read_b64_tr_b16 v[122:123], v149 offset:32320
    s_waitcnt lgkmcnt(9)
    v_mfma_f32_16x16x32_bf16 v[76:79], v[108:111], v[124:127], v[76:79]
    v_mfma_f32_16x16x32_bf16 v[80:83], v[108:111], v[128:131], v[80:83]
    v_mfma_f32_16x16x32_bf16 v[84:87], v[108:111], v[132:135], v[84:87]
    s_waitcnt vmcnt(4)
    s_barrier
    s_mul_i32 s45, s43, 3072
    s_add_u32 s43, s43, 1
    s_cmp_ge_u32 s43, 9
    s_cselect_b32 s43, 0, s43
    v_add_u32 v150, s45, v151
    ds_read_b128 v[124:127], v150 offset:0
    ds_read_b128 v[128:131], v150 offset:1024
    ds_read_b128 v[132:135], v150 offset:2048
    ds_read_b64_tr_b16 v[92:93], v148 offset:0
    ds_read_b64_tr_b16 v[94:95], v148 offset:4608
    s_waitcnt lgkmcnt(9)
    v_mfma_f32_16x16x32_bf16 v[52:55], v[112:115], v[136:139], v[52:55]
    v_mfma_f32_16x16x32_bf16 v[56:59], v[112:115], v[140:143], v[56:59]
    v_mfma_f32_16x16x32_bf16 v[60:63], v[112:115], v[144:147], v[60:63]
    s_mul_i32 s44, s42, 110592
    s_add_u32 s44, s44, s41
    s_add_u32 s44, s44, 995328
    s_add_u32 s42, s42, 1
    s_cmp_ge_u32 s42, 9
    s_cselect_b32 s42, 0, s42
    s_add_u32 m0, s40, 55296
    s_nop 0
    buffer_load_dwordx4 v9, s[8:11], s44 offen lds
    s_add_u32 m0, s40, 56320
    s_nop 0
    buffer_load_dwordx4 v10, s[8:11], s44 offen lds
    ds_read_b64_tr_b16 v[96:97], v148 offset:32
    ds_read_b64_tr_b16 v[98:99], v148 offset:4640
    s_waitcnt lgkmcnt(9)
    v_mfma_f32_16x16x32_bf16 v[64:67], v[116:119], v[136:139], v[64:67]
    v_mfma_f32_16x16x32_bf16 v[68:71], v[116:119], v[140:143], v[68:71]
    v_mfma_f32_16x16x32_bf16 v[72:75], v[116:119], v[144:147], v[72:75]
    s_add_u32 m0, s40, 57344
    s_nop 0
    buffer_load_dwordx4 v11, s[8:11], s44 offen lds
    s_add_u32 m0, s40, 58368
    s_mov_b64 exec, 0xffffff
    buffer_load_dwordx4 v12, s[8:11], s44 offen lds
    s_mov_b64 exec, -1
    ds_read_b64_tr_b16 v[100:101], v148 offset:64
    ds_read_b64_tr_b16 v[102:103], v148 offset:4672
    s_waitcnt lgkmcnt(9)
    v_mfma_f32_16x16x32_bf16 v[76:79], v[120:123], v[136:139], v[76:79]
    v_mfma_f32_16x16x32_bf16 v[80:83], v[120:123], v[140:143], v[80:83]
    v_mfma_f32_16x16x32_bf16 v[84:87], v[120:123], v[144:147], v[84:87]
    s_waitcnt lgkmcnt(4)
    v_mfma_f32_16x16x32_bf16 v[52:55], v[92:95], v[124:127], v[52:55]
    v_mfma_f32_16x16x32_bf16 v[56:59], v[92:95], v[128:131], v[56:59]
    v_mfma_f32_16x16x32_bf16 v[60:63], v[92:95], v[132:135], v[60:63]
    s_waitcnt lgkmcnt(2)
    v_mfma_f32_16x16x32_bf16 v[64:67], v[96:99], v[124:127], v[64:67]
    v_mfma_f32_16x16x32_bf16 v[68:71], v[96:99], v[128:131], v[68:71]
    v_mfma_f32_16x16x32_bf16 v[72:75], v[96:99], v[132:135], v[72:75]
    s_waitcnt lgkmcnt(0)
    v_mfma_f32_16x16x32_bf16 v[76:79], v[100:103], v[124:127], v[76:79]
    v_mfma_f32_16x16x32_bf16 v[80:83], v[100:103], v[128:131], v[80:83]
    v_mfma_f32_16x16x32_bf16 v[84:87], v[100:103], v[132:135], v[84:87]
    s_barrier
    ds_write_b128 v152, v[28:31] offset:0
    ds_write_b128 v152, v[32:35] offset:1024
    ds_write_b128 v152, v[36:39] offset:2048
    s_cmp_lg_u32 s24, 1
    s_cbranch_scc1 P12_H1_15
    ds_write_b128 v151, v[40:43] offset:24576
    ds_write_b128 v151, v[44:47] offset:25600
    ds_write_b128 v151, v[48:51] offset:26624
P12_H1_15:
    s_waitcnt lgkmcnt(0)
    s_waitcnt vmcnt(4)
    s_barrier
    s_mul_i32 s45, s43, 3072
    s_add_u32 s43, s43, 1
    s_cmp_ge_u32 s43, 9
    s_cselect_b32 s43, 0, s43
    v_add_u32 v150, s45, v151
    ds_read_b128 v[136:139], v150 offset:0
    ds_read_b128 v[140:143], v150 offset:1024
    ds_read_b128 v[144:147], v150 offset:2048
    ds_read_b64_tr_b16 v[104:105], v148 offset:27648
    ds_read_b64_tr_b16 v[106:107], v148 offset:32256
    ds_read_b64_tr_b16 v[108:109], v148 offset:27680
    ds_read_b64_tr_b16 v[110:111], v148 offset:32288
    ds_read_b64_tr_b16 v[112:113], v148 offset:27712
    ds_read_b64_tr_b16 v[114:115], v148 offset:32320
    s_waitcnt vmcnt(0)
    s_barrier
    s_mul_i32 s45, s43, 3072
    s_add_u32 s43, s43, 1
    s_cmp_ge_u32 s43, 9
    s_cselect_b32 s43, 0, s43
    v_add_u32 v150, s45, v151
    ds_read_b128 v[124:127], v150 offset:0
    ds_read_b128 v[128:131], v150 offset:1024
    ds_read_b128 v[132:135], v150 offset:2048
    ds_read_b64_tr_b16 v[116:117], v149 offset:0
    ds_read_b64_tr_b16 v[118:119], v149 offset:4608
    s_waitcnt lgkmcnt(9)
    v_mfma_f32_16x16x32_bf16 v[52:55], v[104:107], v[136:139], v[52:55]
    v_mfma_f32_16x16x32_bf16 v[56:59], v[104:107], v[140:143], v[56:59]
    v_mfma_f32_16x16x32_bf16 v[60:63], v[104:107], v[144:147], v[60:63]
    s_mul_i32 s44, s42, 110592
    s_add_u32 s44, s44, s41
    s_add_u32 s44, s44, 995328
    s_add_u32 s42, s42, 1
    s_cmp_ge_u32 s42, 9
    s_cselect_b32 s42, 0, s42
    s_add_u32 m0, s40, 82944
    s_nop 0
    buffer_load_dwordx4 v9, s[8:11], s44 offen lds
    s_add_u32 m0, s40, 83968
    s_nop 0
    buffer_load_dwordx4 v10, s[8:11], s44 offen lds
    ds_read_b64_tr_b16 v[120:121], v149 offset:32
    ds_read_b64_tr_b16 v[122:123], v149 offset:4640
    s_waitcnt lgkmcnt(9)
    v_mfma_f32_16x16x32_bf16 v[64:67], v[108:111], v[136:139], v[64:67]
    v_mfma_f32_16x16x32_bf16 v[68:71], v[108:111], v[140:143], v[68:71]
    v_mfma_f32_16x16x32_bf16 v[72:75], v[108:111], v[144:147], v[72:75]
    s_add_u32 m0, s40, 84992
    s_nop 0
    buffer_load_dwordx4 v11, s[8:11], s44 offen lds
    s_add_u32 m0, s40, 86016
    s_mov_b64 exec, 0xffffff
    buffer_load_dwordx4 v12, s[8:11], s44 offen lds
    s_mov_b64 exec, -1
    ds_read_b64_tr_b16 v[92:93], v149 offset:64
    ds_read_b64_tr_b16 v[94:95], v149 offset:4672
    s_waitcnt lgkmcnt(9)
    v_mfma_f32_16x16x32_bf16 v[76:79], v[112:115], v[136:139], v[76:79]
    v_mfma_f32_16x16x32_bf16 v[80:83], v[112:115], v[140:143], v[80:83]
    v_mfma_f32_16x16x32_bf16 v[84:87], v[112:115], v[144:147], v[84:87]
    s_mul_i32 s44, s42, 110592
    s_add_u32 s44, s44, s41
    s_add_u32 s44, s44, 995328
    s_add_u32 s42, s42, 1
    s_cmp_ge_u32 s42, 9
    s_cselect_b32 s42, 0, s42
    s_add_u32 m0, s40, 0
    s_nop 0
    buffer_load_dwordx4 v9, s[8:11], s44 offen lds
    s_add_u32 m0, s40, 1024
    s_nop 0
    buffer_load_dwordx4 v10, s[8:11], s44 offen lds
    s_waitcnt vmcnt(2)
    s_barrier
    s_mul_i32 s45, s43, 3072
    s_add_u32 s43, s43, 1
    s_cmp_ge_u32 s43, 9
    s_cselect_b32 s43, 0, s43
    v_add_u32 v150, s45, v151
    ds_read_b128 v[136:139], v150 offset:0
    ds_read_b128 v[140:143], v150 offset:1024
    ds_read_b128 v[144:147], v150 offset:2048
    ds_read_b64_tr_b16 v[96:97], v149 offset:27648
    ds_read_b64_tr_b16 v[98:99], v149 offset:32256
    s_waitcnt lgkmcnt(9)
    v_mfma_f32_16x16x32_bf16 v[52:55], v[116:119], v[124:127], v[52:55]
    v_mfma_f32_16x16x32_bf16 v[56:59], v[116:119], v[128:131], v[56:59]
    v_mfma_f32_16x16x32_bf16 v[60:63], v[116:119], v[132:135], v[60:63]
    s_add_u32 m0, s40, 2048
    s_nop 0
    buffer_load_dwordx4 v11, s[8:11], s44 offen lds
    s_add_u32 m0, s40, 3072
    s_mov_b64 exec, 0xffffff
    buffer_load_dwordx4 v12, s[8:11], s44 offen lds
    s_mov_b64 exec, -1
    ds_read_b64_tr_b16 v[100:101], v149 offset:27680
    ds_read_b64_tr_b16 v[102:103], v149 offset:32288
    s_waitcnt lgkmcnt(9)
    v_mfma_f32_16x16x32_bf16 v[64:67], v[120:123], v[124:127], v[64:67]
    v_mfma_f32_16x16x32_bf16 v[68:71], v[120:123], v[128:131], v[68:71]
    v_mfma_f32_16x16x32_bf16 v[72:75], v[120:123], v[132:135], v[72:75]
    s_mul_i32 s44, s42, 110592
    s_add_u32 s44, s44, s41
    s_add_u32 s44, s44, 995328
    s_add_u32 s42, s42, 1
    s_cmp_ge_u32 s42, 9
    s_cselect_b32 s42, 0, s42
    s_add_u32 m0, s40, 27648
    s_nop 0
    buffer_load_dwordx4 v9, s[8:11], s44 offen lds
    s_add_u32 m0, s40, 28672
    s_nop 0
    buffer_load_dwordx4 v10, s[8:11], s44 offen lds
    ds_read_b64_tr_b16 v[104:105], v149 offset:27712
    ds_read_b64_tr_b16 v[106:107], v149 offset:32320
    s_waitcnt lgkmcnt(9)
    v_mfma_f32_16x16x32_bf16 v[76:79], v[92:95], v[124:127], v[76:79]
    v_mfma_f32_16x16x32_bf16 v[80:83], v[92:95], v[128:131], v[80:83]
    v_mfma_f32_16x16x32_bf16 v[84:87], v[92:95], v[132:135], v[84:87]
    s_add_u32 m0, s40, 29696
    s_nop 0
    buffer_load_dwordx4 v11, s[8:11], s44 offen lds
    s_add_u32 m0, s40, 30720
    s_mov_b64 exec, 0xffffff
    buffer_load_dwordx4 v12, s[8:11], s44 offen lds
    s_mov_b64 exec, -1
    s_waitcnt vmcnt(4)
    s_barrier
    s_mul_i32 s45, s43, 3072
    s_add_u32 s43, s43, 1
    s_cmp_ge_u32 s43, 9
    s_cselect_b32 s43, 0, s43
    v_add_u32 v150, s45, v151
    ds_read_b128 v[124:127], v150 offset:0
    ds_read_b128 v[128:131], v150 offset:1024
    ds_read_b128 v[132:135], v150 offset:2048
    ds_read_b64_tr_b16 v[108:109], v148 offset:0
    ds_read_b64_tr_b16 v[110:111], v148 offset:4608
    s_waitcnt lgkmcnt(9)
    v_mfma_f32_16x16x32_bf16 v[52:55], v[96:99], v[136:139], v[52:55]
    v_mfma_f32_16x16x32_bf16 v[56:59], v[96:99], v[140:143], v[56:59]
    v_mfma_f32_16x16x32_bf16 v[60:63], v[96:99], v[144:147], v[60:63]
    s_mul_i32 s44, s42, 110592
    s_add_u32 s44, s44, s41
    s_add_u32 s44, s44, 995328
    s_add_u32 s42, s42, 1
    s_cmp_ge_u32 s42, 9
    s_cselect_b32 s42, 0, s42
    s_add_u32 m0, s40, 55296
    s_nop 0
    buffer_load_dwordx4 v9, s[8:11], s44 offen lds
    s_add_u32 m0, s40, 56320
    s_nop 0
    buffer_load_dwordx4 v10, s[8:11], s44 offen lds
    ds_read_b64_tr_b16 v[112:113], v148 offset:32
    ds_read_b64_tr_b16 v[114:115], v148 offset:4640
    s_waitcnt lgkmcnt(9)
    v_mfma_f32_16x16x32_bf16 v[64:67], v[100:103], v[136:139], v[64:67]
    v_mfma_f32_16x16x32_bf16 v[68:71], v[100:103], v[140:143], v[68:71]
    v_mfma_f32_16x16x32_bf16 v[72:75], v[100:103], v[144:147], v[72:75]
    s_add_u32 m0, s40, 57344
    s_nop 0
    buffer_load_dwordx4 v11, s[8:11], s44 offen lds
    s_add_u32 m0, s40, 58368
    s_mov_b64 exec, 0xffffff
    buffer_load_dwordx4 v12, s[8:11], s44 offen lds
    s_mov_b64 exec, -1
    ds_read_b64_tr_b16 v[116:117], v148 offset:64
    ds_read_b64_tr_b16 v[118:119], v148 offset:4672
    s_waitcnt lgkmcnt(9)
    v_mfma_f32_16x16x32_bf16 v[76:79], v[104:107], v[136:139], v[76:79]
    v_mfma_f32_16x16x32_bf16 v[80:83], v[104:107], v[140:143], v[80:83]
    v_mfma_f32_16x16x32_bf16 v[84:87], v[104:107], v[144:147], v[84:87]
    s_waitcnt vmcnt(4)
    s_barrier
    s_mul_i32 s45, s43, 3072
    s_add_u32 s43, s43, 1
    s_cmp_ge_u32 s43, 9
    s_cselect_b32 s43, 0, s43
    v_add_u32 v150, s45, v151
    ds_read_b128 v[136:139], v150 offset:0
    ds_read_b128 v[140:143], v150 offset:1024
    ds_read_b128 v[144:147], v150 offset:2048
    ds_read_b64_tr_b16 v[120:121], v148 offset:27648
    ds_read_b64_tr_b16 v[122:123], v148 offset:32256
    s_waitcnt lgkmcnt(9)
    v_mfma_f32_16x16x32_bf16 v[52:55], v[108:111], v[124:127], v[52:55]
    v_mfma_f32_16x16x32_bf16 v[56:59], v[108:111], v[128:131], v[56:59]
    v_mfma_f32_16x16x32_bf16 v[60:63], v[108:111], v[132:135], v[60:63]
    s_mul_i32 s44, s42, 110592
    s_add_u32 s44, s44, s41
    s_add_u32 s44, s44, 995328
    s_add_u32 s42, s42, 1
    s_cmp_ge_u32 s42, 9
    s_cselect_b32 s42, 0, s42
    s_add_u32 m0, s40, 82944
    s_nop 0
    buffer_load_dwordx4 v9, s[8:11], s44 offen lds
    s_add_u32 m0, s40, 83968
    s_nop 0
    buffer_load_dwordx4 v10, s[8:11], s44 offen lds
    ds_read_b64_tr_b16 v[92:93], v148 offset:27680
    ds_read_b64_tr_b16 v[94:95], v148 offset:32288
    s_waitcnt lgkmcnt(9)
    v_mfma_f32_16x16x32_bf16 v[64:67], v[112:115], v[124:127], v[64:67]
    v_mfma_f32_16x16x32_bf16 v[68:71], v[112:115], v[128:131], v[68:71]
    v_mfma_f32_16x16x32_bf16 v[72:75], v[112:115], v[132:135], v[72:75]
    s_add_u32 m0, s40, 84992
    s_nop 0
    buffer_load_dwordx4 v11, s[8:11], s44 offen lds
    s_add_u32 m0, s40, 86016
    s_mov_b64 exec, 0xffffff
    buffer_load_dwordx4 v12, s[8:11], s44 offen lds
    s_mov_b64 exec, -1
    ds_read_b64_tr_b16 v[96:97], v148 offset:27712
    ds_read_b64_tr_b16 v[98:99], v148 offset:32320
    s_waitcnt lgkmcnt(9)
    v_mfma_f32_16x16x32_bf16 v[76:79], v[116:119], v[124:127], v[76:79]
    v_mfma_f32_16x16x32_bf16 v[80:83], v[116:119], v[128:131], v[80:83]
    v_mfma_f32_16x16x32_bf16 v[84:87], v[116:119], v[132:135], v[84:87]
    s_waitcnt vmcnt(4)
    s_barrier
    s_mul_i32 s45, s43, 3072
    s_add_u32 s43, s43, 1
    s_cmp_ge_u32 s43, 9
    s_cselect_b32 s43, 0, s43
    v_add_u32 v150, s45, v151
    ds_read_b128 v[124:127], v150 offset:0
    ds_read_b128 v[128:131], v150 offset:1024
    ds_read_b128 v[132:135], v150 offset:2048
    ds_read_b64_tr_b16 v[100:101], v149 offset:0
    ds_read_b64_tr_b16 v[102:103], v149 offset:4608
    s_waitcnt lgkmcnt(9)
    v_mfma_f32_16x16x32_bf16 v[52:55], v[120:123], v[136:139], v[52:55]
    v_mfma_f32_16x16x32_bf16 v[56:59], v[120:123], v[140:143], v[56:59]
    v_mfma_f32_16x16x32_bf16 v[60:63], v[120:123], v[144:147], v[60:63]
    s_mul_i32 s44, s42, 110592
    s_add_u32 s44, s44, s41
    s_add_u32 s44, s44, 995328
    s_add_u32 s42, s42, 1
    s_cmp_ge_u32 s42, 9
    s_cselect_b32 s42, 0, s42
    s_add_u32 m0, s40, 0
    s_nop 0
    buffer_load_dwordx4 v9, s[8:11], s44 offen lds
    s_add_u32 m0, s40, 1024
    s_nop 0
    buffer_load_dwordx4 v10, s[8:11], s44 offen lds
    ds_read_b64_tr_b16 v[104:105], v149 offset:32
    ds_read_b64_tr_b16 v[106:107], v149 offset:4640
    s_waitcnt lgkmcnt(9)
    v_mfma_f32_16x16x32_bf16 v[64:67], v[92:95], v[136:139], v[64:67]
    v_mfma_f32_16x16x32_bf16 v[68:71], v[92:95], v[140:143], v[68:71]
    v_mfma_f32_16x16x32_bf16 v[72:75], v[92:95], v[144:147], v[72:75]
    s_add_u32 m0, s40, 2048
    s_nop 0
    buffer_load_dwordx4 v11, s[8:11], s44 offen lds
    s_add_u32 m0, s40, 3072
    s_mov_b64 exec, 0xffffff
    buffer_load_dwordx4 v12, s[8:11], s44 offen lds
    s_mov_b64 exec, -1
    ds_read_b64_tr_b16 v[108:109], v149 offset:64
    ds_read_b64_tr_b16 v[110:111], v149 offset:4672
    s_waitcnt lgkmcnt(9)
    v_mfma_f32_16x16x32_bf16 v[76:79], v[96:99], v[136:139], v[76:79]
    v_mfma_f32_16x16x32_bf16 v[80:83], v[96:99], v[140:143], v[80:83]
    v_mfma_f32_16x16x32_bf16 v[84:87], v[96:99], v[144:147], v[84:87]
    s_waitcnt vmcnt(4)
    s_barrier
    s_mul_i32 s45, s43, 3072
    s_add_u32 s43, s43, 1
    s_cmp_ge_u32 s43, 9
    s_cselect_b32 s43, 0, s43
    v_add_u32 v150, s45, v151
    ds_read_b128 v[136:139], v150 offset:0
    ds_read_b128 v[140:143], v150 offset:1024
    ds_read_b128 v[144:147], v150 offset:2048
    ds_read_b64_tr_b16 v[112:113], v149 offset:27648
    ds_read_b64_tr_b16 v[114:115], v149 offset:32256
    s_waitcnt lgkmcnt(9)
    v_mfma_f32_16x16x32_bf16 v[52:55], v[100:103], v[124:127], v[52:55]
    v_mfma_f32_16x16x32_bf16 v[56:59], v[100:103], v[128:131], v[56:59]
    v_mfma_f32_16x16x32_bf16 v[60:63], v[100:103], v[132:135], v[60:63]
    s_mul_i32 s44, s42, 110592
    s_add_u32 s44, s44, s41
    s_add_u32 s44, s44, 995328
    s_add_u32 s42, s42, 1
    s_cmp_ge_u32 s42, 9
    s_cselect_b32 s42, 0, s42
    s_add_u32 m0, s40, 27648
    s_nop 0
    buffer_load_dwordx4 v9, s[8:11], s44 offen lds
    s_add_u32 m0, s40, 28672
    s_nop 0
    buffer_load_dwordx4 v10, s[8:11], s44 offen lds
    ds_read_b64_tr_b16 v[116:117], v149 offset:27680
    ds_read_b64_tr_b16 v[118:119], v149 offset:32288
    s_waitcnt lgkmcnt(9)
    v_mfma_f32_16x16x32_bf16 v[64:67], v[104:107], v[124:127], v[64:67]
    v_mfma_f32_16x16x32_bf16 v[68:71], v[104:107], v[128:131], v[68:71]
    v_mfma_f32_16x16x32_bf16 v[72:75], v[104:107], v[132:135], v[72:75]
    s_add_u32 m0, s40, 29696
    s_nop 0
    buffer_load_dwordx4 v11, s[8:11], s44 offen lds
    s_add_u32 m0, s40, 30720
    s_mov_b64 exec, 0xffffff
    buffer_load_dwordx4 v12, s[8:11], s44 offen lds
    s_mov_b64 exec, -1
    ds_read_b64_tr_b16 v[120:121], v149 offset:27712
    ds_read_b64_tr_b16 v[122:123], v149 offset:32320
    s_waitcnt lgkmcnt(9)
    v_mfma_f32_16x16x32_bf16 v[76:79], v[108:111], v[124:127], v[76:79]
    v_mfma_f32_16x16x32_bf16 v[80:83], v[108:111], v[128:131], v[80:83]
    v_mfma_f32_16x16x32_bf16 v[84:87], v[108:111], v[132:135], v[84:87]
    s_waitcnt vmcnt(4)
    s_barrier
    s_mul_i32 s45, s43, 3072
    s_add_u32 s43, s43, 1
    s_cmp_ge_u32 s43, 9
    s_cselect_b32 s43, 0, s43
    v_add_u32 v150, s45, v151
    ds_read_b128 v[124:127], v150 offset:0
    ds_read_b128 v[128:131], v150 offset:1024
    ds_read_b128 v[132:135], v150 offset:2048
    ds_read_b64_tr_b16 v[92:93], v148 offset:0
    ds_read_b64_tr_b16 v[94:95], v148 offset:4608
    s_waitcnt lgkmcnt(9)
    v_mfma_f32_16x16x32_bf16 v[52:55], v[112:115], v[136:139], v[52:55]
    v_mfma_f32_16x16x32_bf16 v[56:59], v[112:115], v[140:143], v[56:59]
    v_mfma_f32_16x16x32_bf16 v[60:63], v[112:115], v[144:147], v[60:63]
    ds_read_b64_tr_b16 v[96:97], v148 offset:32
    ds_read_b64_tr_b16 v[98:99], v148 offset:4640
    s_waitcnt lgkmcnt(9)
    v_mfma_f32_16x16x32_bf16 v[64:67], v[116:119], v[136:139], v[64:67]
    v_mfma_f32_16x16x32_bf16 v[68:71], v[116:119], v[140:143], v[68:71]
    v_mfma_f32_16x16x32_bf16 v[72:75], v[116:119], v[144:147], v[72:75]
    ds_read_b64_tr_b16 v[100:101], v148 offset:64
    ds_read_b64_tr_b16 v[102:103], v148 offset:4672
    s_waitcnt lgkmcnt(9)
    v_mfma_f32_16x16x32_bf16 v[76:79], v[120:123], v[136:139], v[76:79]
    v_mfma_f32_16x16x32_bf16 v[80:83], v[120:123], v[140:143], v[80:83]
    v_mfma_f32_16x16x32_bf16 v[84:87], v[120:123], v[144:147], v[84:87]
    s_waitcnt vmcnt(0)
    s_barrier
    s_mul_i32 s45, s43, 3072
    s_add_u32 s43, s43, 1
    s_cmp_ge_u32 s43, 9
    s_cselect_b32 s43, 0, s43
    v_add_u32 v150, s45, v151
    ds_read_b128 v[136:139], v150 offset:0
    ds_read_b128 v[140:143], v150 offset:1024
    ds_read_b128 v[144:147], v150 offset:2048
    ds_read_b64_tr_b16 v[104:105], v148 offset:27648
    ds_read_b64_tr_b16 v[106:107], v148 offset:32256
    s_waitcnt lgkmcnt(9)
    v_mfma_f32_16x16x32_bf16 v[52:55], v[92:95], v[124:127], v[52:55]
    v_mfma_f32_16x16x32_bf16 v[56:59], v[92:95], v[128:131], v[56:59]
    v_mfma_f32_16x16x32_bf16 v[60:63], v[92:95], v[132:135], v[60:63]
    ds_read_b64_tr_b16 v[108:109], v148 offset:27680
    ds_read_b64_tr_b16 v[110:111], v148 offset:32288
    s_waitcnt lgkmcnt(9)
    v_mfma_f32_16x16x32_bf16 v[64:67], v[96:99], v[124:127], v[64:67]
    v_mfma_f32_16x16x32_bf16 v[68:71], v[96:99], v[128:131], v[68:71]
    v_mfma_f32_16x16x32_bf16 v[72:75], v[96:99], v[132:135], v[72:75]
    ds_read_b64_tr_b16 v[112:113], v148 offset:27712
    ds_read_b64_tr_b16 v[114:115], v148 offset:32320
    s_waitcnt lgkmcnt(9)
    v_mfma_f32_16x16x32_bf16 v[76:79], v[100:103], v[124:127], v[76:79]
    v_mfma_f32_16x16x32_bf16 v[80:83], v[100:103], v[128:131], v[80:83]
    v_mfma_f32_16x16x32_bf16 v[84:87], v[100:103], v[132:135], v[84:87]
    s_waitcnt lgkmcnt(4)
    v_mfma_f32_16x16x32_bf16 v[52:55], v[104:107], v[136:139], v[52:55]
    v_mfma_f32_16x16x32_bf16 v[56:59], v[104:107], v[140:143], v[56:59]
    v_mfma_f32_16x16x32_bf16 v[60:63], v[104:107], v[144:147], v[60:63]
    s_waitcnt lgkmcnt(2)
    v_mfma_f32_16x16x32_bf16 v[64:67], v[108:111], v[136:139], v[64:67]
    v_mfma_f32_16x16x32_bf16 v[68:71], v[108:111], v[140:143], v[68:71]
    v_mfma_f32_16x16x32_bf16 v[72:75], v[108:111], v[144:147], v[72:75]
    s_waitcnt lgkmcnt(0)
    v_mfma_f32_16x16x32_bf16 v[76:79], v[112:115], v[136:139], v[76:79]
    v_mfma_f32_16x16x32_bf16 v[80:83], v[112:115], v[140:143], v[80:83]
    v_mfma_f32_16x16x32_bf16 v[84:87], v[112:115], v[144:147], v[84:87]
    s_barrier
    s_nop 3
    v_and_b32 v1, 15, v0
    v_mul_u32_u24 v1, 1744, v1
    v_lshrrev_b32 v2, 4, v0
    v_lshl_add_u32 v1, v2, 4, v1
    s_mul_i32 s45, s49, 576
    s_lshl_b32 s46, s50, 6
    s_add_u32 s45, s45, s46
    v_add_u32 v1, s45, v1
    ds_write_b128 v1, v[52:55] offset:0
    ds_write_b128 v1, v[56:59] offset:27904
    ds_write_b128 v1, v[60:63] offset:55808
    ds_write_b128 v1, v[64:67] offset:64
    ds_write_b128 v1, v[68:71] offset:27968
    ds_write_b128 v1, v[72:75] offset:55872
    ds_write_b128 v1, v[76:79] offset:128
    ds_write_b128 v1, v[80:83] offset:28032
    ds_write_b128 v1, v[84:87] offset:55936
    s_branch P12_GE_13
P12_GB_12:
    s_waitcnt vmcnt(18)
    s_barrier
    s_mul_i32 s45, s43, 3072
    s_add_u32 s43, s43, 1
    s_cmp_ge_u32 s43, 9
    s_cselect_b32 s43, 0, s43
    v_add_u32 v150, s45, v151
    ds_read_b128 v[128:131], v150 offset:1024
    ds_read_b128 v[132:135], v150 offset:2048
    ds_read_b64_tr_b16 v[92:93], v148 offset:0
    ds_read_b64_tr_b16 v[94:95], v148 offset:4608
    ds_read_b64_tr_b16 v[96:97], v148 offset:32
    ds_read_b64_tr_b16 v[98:99], v148 offset:4640
    ds_read_b64_tr_b16 v[100:101], v148 offset:64
    ds_read_b64_tr_b16 v[102:103], v148 offset:4672
    ds_read_b64_tr_b16 v[104:105], v148 offset:96
    ds_read_b64_tr_b16 v[106:107], v148 offset:4704
    ds_read_b64_tr_b16 v[108:109], v148 offset:128
    ds_read_b64_tr_b16 v[110:111], v148 offset:4736
    s_waitcnt vmcnt(14)
    s_barrier
    s_mul_i32 s45, s43, 3072
    s_add_u32 s43, s43, 1
    s_cmp_ge_u32 s43, 9
    s_cselect_b32 s43, 0, s43
    v_add_u32 v150, s45, v151
    ds_read_b128 v[140:143], v150 offset:1024
    ds_read_b128 v[144:147], v150 offset:2048
    ds_read_b64_tr_b16 v[112:113], v148 offset:27648
    ds_read_b64_tr_b16 v[114:115], v148 offset:32256
    s_waitcnt lgkmcnt(12)
    v_mfma_f32_16x16x32_bf16 v[52:55], v[92:95], v[128:131], 0
    v_mfma_f32_16x16x32_bf16 v[56:59], v[92:95], v[132:135], 0
    ds_read_b64_tr_b16 v[116:117], v148 offset:27680
    ds_read_b64_tr_b16 v[118:119], v148 offset:32288
    s_waitcnt lgkmcnt(12)
    v_mfma_f32_16x16x32_bf16 v[60:63], v[96:99], v[128:131], 0
    v_mfma_f32_16x16x32_bf16 v[64:67], v[96:99], v[132:135], 0
    ds_read_b64_tr_b16 v[120:121], v148 offset:27712
    ds_read_b64_tr_b16 v[122:123], v148 offset:32320
    s_waitcnt lgkmcnt(12)
    v_mfma_f32_16x16x32_bf16 v[68:71], v[100:103], v[128:131], 0
    v_mfma_f32_16x16x32_bf16 v[72:75], v[100:103], v[132:135], 0
    ds_read_b64_tr_b16 v[92:93], v148 offset:27744
    ds_read_b64_tr_b16 v[94:95], v148 offset:32352
    s_waitcnt lgkmcnt(12)
    v_mfma_f32_16x16x32_bf16 v[76:79], v[104:107], v[128:131], 0
    v_mfma_f32_16x16x32_bf16 v[80:83], v[104:107], v[132:135], 0
    ds_read_b64_tr_b16 v[96:97], v148 offset:27776
    ds_read_b64_tr_b16 v[98:99], v148 offset:32384
    s_waitcnt lgkmcnt(12)
    v_mfma_f32_16x16x32_bf16 v[84:87], v[108:111], v[128:131], 0
    v_mfma_f32_16x16x32_bf16 v[88:91], v[108:111], v[132:135], 0
    s_waitcnt vmcnt(10)
    s_barrier
    s_mul_i32 s45, s43, 3072
    s_add_u32 s43, s43, 1
    s_cmp_ge_u32 s43, 9
    s_cselect_b32 s43, 0, s43
    v_add_u32 v150, s45, v151
    ds_read_b128 v[128:131], v150 offset:1024
    ds_read_b128 v[132:135], v150 offset:2048
    ds_read_b64_tr_b16 v[100:101], v149 offset:0
    ds_read_b64_tr_b16 v[102:103], v149 offset:4608
    s_waitcnt lgkmcnt(12)
    v_mfma_f32_16x16x32_bf16 v[52:55], v[112:115], v[140:143], v[52:55]
    v_mfma_f32_16x16x32_bf16 v[56:59], v[112:115], v[144:147], v[56:59]
    s_mul_i32 s44, s42, 110592
    s_add_u32 s44, s44, s41
    s_add_u32 s42, s42, 1
    s_cmp_ge_u32 s42, 9
    s_cselect_b32 s42, 0, s42
    s_add_u32 m0, s40, 0
    s_nop 0
    buffer_load_dwordx4 v9, s[8:11], s44 offen lds
    ds_read_b64_tr_b16 v[104:105], v149 offset:32
    ds_read_b64_tr_b16 v[106:107], v149 offset:4640
    s_waitcnt lgkmcnt(12)
    v_mfma_f32_16x16x32_bf16 v[60:63], v[116:119], v[140:143], v[60:63]
    v_mfma_f32_16x16x32_bf16 v[64:67], v[116:119], v[144:147], v[64:67]
    s_add_u32 m0, s40, 1024
    s_nop 0
    buffer_load_dwordx4 v10, s[8:11], s44 offen lds
    ds_read_b64_tr_b16 v[108:109], v149 offset:64
    ds_read_b64_tr_b16 v[110:111], v149 offset:4672
    s_waitcnt lgkmcnt(12)
    v_mfma_f32_16x16x32_bf16 v[68:71], v[120:123], v[140:143], v[68:71]
    v_mfma_f32_16x16x32_bf16 v[72:75], v[120:123], v[144:147], v[72:75]
    s_add_u32 m0, s40, 2048
    s_nop 0
    buffer_load_dwordx4 v11, s[8:11], s44 offen lds
    ds_read_b64_tr_b16 v[112:113], v149 offset:96
    ds_read_b64_tr_b16 v[114:115], v149 offset:4704
    s_waitcnt lgkmcnt(12)
    v_mfma_f32_16x16x32_bf16 v[76:79], v[92:95], v[140:143], v[76:79]
    v_mfma_f32_16x16x32_bf16 v[80:83], v[92:95], v[144:147], v[80:83]
    s_add_u32 m0, s40, 3072
    s_mov_b64 exec, 0xffffff
    buffer_load_dwordx4 v12, s[8:11], s44 offen lds
    s_mov_b64 exec, -1
    ds_read_b64_tr_b16 v[116:117], v149 offset:128
    ds_read_b64_tr_b16 v[118:119], v149 offset:4736
    s_waitcnt lgkmcnt(12)
    v_mfma_f32_16x16x32_bf16 v[84:87], v[96:99], v[140:143], v[84:87]
    v_mfma_f32_16x16x32_bf16 v[88:91], v[96:99], v[144:147], v[88:91]
    s_waitcnt vmcnt(10)
    s_barrier
    s_mul_i32 s45, s43, 3072
    s_add_u32 s43, s43, 1
    s_cmp_ge_u32 s43, 9
    s_cselect_b32 s43, 0, s43
    v_add_u32 v150, s45, v151
    ds_read_b128 v[140:143], v150 offset:1024
    ds_read_b128 v[144:147], v150 offset:2048
    ds_read_b64_tr_b16 v[120:121], v149 offset:27648
    ds_read_b64_tr_b16 v[122:123], v149 offset:32256
    s_waitcnt lgkmcnt(12)
    v_mfma_f32_16x16x32_bf16 v[52:55], v[100:103], v[128:131], v[52:55]
    v_mfma_f32_16x16x32_bf16 v[56:59], v[100:103], v[132:135], v[56:59]
    s_mul_i32 s44, s42, 110592
    s_add_u32 s44, s44, s41
    s_add_u32 s42, s42, 1
    s_cmp_ge_u32 s42, 9
    s_cselect_b32 s42, 0, s42
    s_add_u32 m0, s40, 27648
    s_nop 0
    buffer_load_dwordx4 v9, s[8:11], s44 offen lds
    ds_read_b64_tr_b16 v[92:93], v149 offset:27680
    ds_read_b64_tr_b16 v[94:95], v149 offset:32288
    s_waitcnt lgkmcnt(12)
    v_mfma_f32_16x16x32_bf16 v[60:63], v[104:107], v[128:131], v[60:63]
    v_mfma_f32_16x16x32_bf16 v[64:67], v[104:107], v[132:135], v[64:67]
    s_add_u32 m0, s40, 28672
    s_nop 0
    buffer_load_dwordx4 v10, s[8:11], s44 offen lds
    ds_read_b64_tr_b16 v[96:97], v149 offset:27712
    ds_read_b64_tr_b16 v[98:99], v149 offset:32320
    s_waitcnt lgkmcnt(12)
    v_mfma_f32_16x16x32_bf16 v[68:71], v[108:111], v[128:131], v[68:71]
    v_mfma_f32_16x16x32_bf16 v[72:75], v[108:111], v[132:135], v[72:75]
    s_add_u32 m0, s40, 29696
    s_nop 0
    buffer_load_dwordx4 v11, s[8:11], s44 offen lds
    ds_read_b64_tr_b16 v[100:101], v149 offset:27744
    ds_read_b64_tr_b16 v[102:103], v149 offset:32352
    s_waitcnt lgkmcnt(12)
    v_mfma_f32_16x16x32_bf16 v[76:79], v[112:115], v[128:131], v[76:79]
    v_mfma_f32_16x16x32_bf16 v[80:83], v[112:115], v[132:135], v[80:83]
    s_add_u32 m0, s40, 30720
    s_mov_b64 exec, 0xffffff
    buffer_load_dwordx4 v12, s[8:11], s44 offen lds
    s_mov_b64 exec, -1
    ds_read_b64_tr_b16 v[104:105], v149 offset:27776
    ds_read_b64_tr_b16 v[106:107], v149 offset:32384
    s_waitcnt lgkmcnt(12)
    v_mfma_f32_16x16x32_bf16 v[84:87], v[116:119], v[128:131], v[84:87]
    v_mfma_f32_16x16x32_bf16 v[88:91], v[116:119], v[132:135], v[88:91]
    s_waitcnt vmcnt(4)
    s_barrier
    s_mul_i32 s45, s43, 3072
    s_add_u32 s43, s43, 1
    s_cmp_ge_u32 s43, 9
    s_cselect_b32 s43, 0, s43
    v_add_u32 v150, s45, v151
    ds_read_b128 v[128:131], v150 offset:1024
    ds_read_b128 v[132:135], v150 offset:2048
    ds_read_b64_tr_b16 v[108:109], v148 offset:0
    ds_read_b64_tr_b16 v[110:111], v148 offset:4608
    s_waitcnt lgkmcnt(12)
    v_mfma_f32_16x16x32_bf16 v[52:55], v[120:123], v[140:143], v[52:55]
    v_mfma_f32_16x16x32_bf16 v[56:59], v[120:123], v[144:147], v[56:59]
    s_mul_i32 s44, s42, 110592
    s_add_u32 s44, s44, s41
    s_add_u32 s42, s42, 1
    s_cmp_ge_u32 s42, 9
    s_cselect_b32 s42, 0, s42
    s_add_u32 m0, s40, 55296
    s_nop 0
    buffer_load_dwordx4 v9, s[8:11], s44 offen lds
    ds_read_b64_tr_b16 v[112:113], v148 offset:32
    ds_read_b64_tr_b16 v[114:115], v148 offset:4640
    s_waitcnt lgkmcnt(12)
    v_mfma_f32_16x16x32_bf16 v[60:63], v[92:95], v[140:143], v[60:63]
    v_mfma_f32_16x16x32_bf16 v[64:67], v[92:95], v[144:147], v[64:67]
    s_add_u32 m0, s40, 56320
    s_nop 0
    buffer_load_dwordx4 v10, s[8:11], s44 offen lds
    ds_read_b64_tr_b16 v[116:117], v148 offset:64
    ds_read_b64_tr_b16 v[118:119], v148 offset:4672
    s_waitcnt lgkmcnt(12)
    v_mfma_f32_16x16x32_bf16 v[68:71], v[96:99], v[140:143], v[68:71]
    v_mfma_f32_16x16x32_bf16 v[72:75], v[96:99], v[144:147], v[72:75]
    s_add_u32 m0, s40, 57344
    s_nop 0
    buffer_load_dwordx4 v11, s[8:11], s44 offen lds
    ds_read_b64_tr_b16 v[120:121], v148 offset:96
    ds_read_b64_tr_b16 v[122:123], v148 offset:4704
    s_waitcnt lgkmcnt(12)
    v_mfma_f32_16x16x32_bf16 v[76:79], v[100:103], v[140:143], v[76:79]
    v_mfma_f32_16x16x32_bf16 v[80:83], v[100:103], v[144:147], v[80:83]
    s_add_u32 m0, s40, 58368
    s_mov_b64 exec, 0xffffff
    buffer_load_dwordx4 v12, s[8:11], s44 offen lds
    s_mov_b64 exec, -1
    ds_read_b64_tr_b16 v[92:93], v148 offset:128
    ds_read_b64_tr_b16 v[94:95], v148 offset:4736
    s_waitcnt lgkmcnt(12)
    v_mfma_f32_16x16x32_bf16 v[84:87], v[104:107], v[140:143], v[84:87]
    v_mfma_f32_16x16x32_bf16 v[88:91], v[104:107], v[144:147], v[88:91]
    s_waitcnt vmcnt(4)
    s_barrier
    s_mul_i32 s45, s43, 3072
    s_add_u32 s43, s43, 1
    s_cmp_ge_u32 s43, 9
    s_cselect_b32 s43, 0, s43
    v_add_u32 v150, s45, v151
    ds_read_b128 v[140:143], v150 offset:1024
    ds_read_b128 v[144:147], v150 offset:2048
    ds_read_b64_tr_b16 v[96:97], v148 offset:27648
    ds_read_b64_tr_b16 v[98:99], v148 offset:32256
    s_waitcnt lgkmcnt(12)
    v_mfma_f32_16x16x32_bf16 v[52:55], v[108:111], v[128:131], v[52:55]
    v_mfma_f32_16x16x32_bf16 v[56:59], v[108:111], v[132:135], v[56:59]
    s_mul_i32 s44, s42, 110592
    s_add_u32 s44, s44, s41
    s_add_u32 s42, s42, 1
    s_cmp_ge_u32 s42, 9
    s_cselect_b32 s42, 0, s42
    s_add_u32 m0, s40, 82944
    s_nop 0
    buffer_load_dwordx4 v9, s[8:11], s44 offen lds
    ds_read_b64_tr_b16 v[100:101], v148 offset:27680
    ds_read_b64_tr_b16 v[102:103], v148 offset:32288
    s_waitcnt lgkmcnt(12)
    v_mfma_f32_16x16x32_bf16 v[60:63], v[112:115], v[128:131], v[60:63]
    v_mfma_f32_16x16x32_bf16 v[64:67], v[112:115], v[132:135], v[64:67]
    s_add_u32 m0, s40, 83968
    s_nop 0
    buffer_load_dwordx4 v10, s[8:11], s44 offen lds
    ds_read_b64_tr_b16 v[104:105], v148 offset:27712
    ds_read_b64_tr_b16 v[106:107], v148 offset:32320
    s_waitcnt lgkmcnt(12)
    v_mfma_f32_16x16x32_bf16 v[68:71], v[116:119], v[128:131], v[68:71]
    v_mfma_f32_16x16x32_bf16 v[72:75], v[116:119], v[132:135], v[72:75]
    s_add_u32 m0, s40, 84992
    s_nop 0
    buffer_load_dwordx4 v11, s[8:11], s44 offen lds
    ds_read_b64_tr_b16 v[108:109], v148 offset:27744
    ds_read_b64_tr_b16 v[110:111], v148 offset:32352
    s_waitcnt lgkmcnt(12)
    v_mfma_f32_16x16x32_bf16 v[76:79], v[120:123], v[128:131], v[76:79]
    v_mfma_f32_16x16x32_bf16 v[80:83], v[120:123], v[132:135], v[80:83]
    s_add_u32 m0, s40, 86016
    s_mov_b64 exec, 0xffffff
    buffer_load_dwordx4 v12, s[8:11], s44 offen lds
    s_mov_b64 exec, -1
    ds_read_b64_tr_b16 v[112:113], v148 offset:27776
    ds_read_b64_tr_b16 v[114:115], v148 offset:32384
    s_waitcnt lgkmcnt(12)
    v_mfma_f32_16x16x32_bf16 v[84:87], v[92:95], v[128:131], v[84:87]
    v_mfma_f32_16x16x32_bf16 v[88:91], v[92:95], v[132:135], v[88:91]
    s_waitcnt vmcnt(4)
    s_barrier
    s_mul_i32 s45, s43, 3072
    s_add_u32 s43, s43, 1
    s_cmp_ge_u32 s43, 9
    s_cselect_b32 s43, 0, s43
    v_add_u32 v150, s45, v151
    ds_read_b128 v[128:131], v150 offset:1024
    ds_read_b128 v[132:135], v150 offset:2048
    ds_read_b64_tr_b16 v[116:117], v149 offset:0
    ds_read_b64_tr_b16 v[118:119], v149 offset:4608
    s_waitcnt lgkmcnt(12)
    v_mfma_f32_16x16x32_bf16 v[52:55], v[96:99], v[140:143], v[52:55]
    v_mfma_f32_16x16x32_bf16 v[56:59], v[96:99], v[144:147], v[56:59]
    s_mul_i32 s44, s42, 110592
    s_add_u32 s44, s44, s41
    s_add_u32 s42, s42, 1
    s_cmp_ge_u32 s42, 9
    s_cselect_b32 s42, 0, s42
    s_add_u32 m0, s40, 0
    s_nop 0
    buffer_load_dwordx4 v9, s[8:11], s44 offen lds
    ds_read_b64_tr_b16 v[120:121], v149 offset:32
    ds_read_b64_tr_b16 v[122:123], v149 offset:4640
    s_waitcnt lgkmcnt(12)
    v_mfma_f32_16x16x32_bf16 v[60:63], v[100:103], v[140:143], v[60:63]
    v_mfma_f32_16x16x32_bf16 v[64:67], v[100:103], v[144:147], v[64:67]
    s_add_u32 m0, s40, 1024
    s_nop 0
    buffer_load_dwordx4 v10, s[8:11], s44 offen lds
    ds_read_b64_tr_b16 v[92:93], v149 offset:64
    ds_read_b64_tr_b16 v[94:95], v149 offset:4672
    s_waitcnt lgkmcnt(12)
    v_mfma_f32_16x16x32_bf16 v[68:71], v[104:107], v[140:143], v[68:71]
    v_mfma_f32_16x16x32_bf16 v[72:75], v[104:107], v[144:147], v[72:75]
    s_add_u32 m0, s40, 2048
    s_nop 0
    buffer_load_dwordx4 v11, s[8:11], s44 offen lds
    ds_read_b64_tr_b16 v[96:97], v149 offset:96
    ds_read_b64_tr_b16 v[98:99], v149 offset:4704
    s_waitcnt lgkmcnt(12)
    v_mfma_f32_16x16x32_bf16 v[76:79], v[108:111], v[140:143], v[76:79]
    v_mfma_f32_16x16x32_bf16 v[80:83], v[108:111], v[144:147], v[80:83]
    s_add_u32 m0, s40, 3072
    s_mov_b64 exec, 0xffffff
    buffer_load_dwordx4 v12, s[8:11], s44 offen lds
    s_mov_b64 exec, -1
    ds_read_b64_tr_b16 v[100:101], v149 offset:128
    ds_read_b64_tr_b16 v[102:103], v149 offset:4736
    s_waitcnt lgkmcnt(12)
    v_mfma_f32_16x16x32_bf16 v[84:87], v[112:115], v[140:143], v[84:87]
    v_mfma_f32_16x16x32_bf16 v[88:91], v[112:115], v[144:147], v[88:91]
    s_waitcnt vmcnt(4)
    s_barrier
    s_mul_i32 s45, s43, 3072
    s_add_u32 s43, s43, 1
    s_cmp_ge_u32 s43, 9
    s_cselect_b32 s43, 0, s43
    v_add_u32 v150, s45, v151
    ds_read_b128 v[140:143], v150 offset:1024
    ds_read_b128 v[144:147], v150 offset:2048
    ds_read_b64_tr_b16 v[104:105], v149 offset:27648
    ds_read_b64_tr_b16 v[106:107], v149 offset:32256
    s_waitcnt lgkmcnt(12)
    v_mfma_f32_16x16x32_bf16 v[52:55], v[116:119], v[128:131], v[52:55]
    v_mfma_f32_16x16x32_bf16 v[56:59], v[116:119], v[132:135], v[56:59]
    s_mul_i32 s44, s42, 110592
    s_add_u32 s44, s44, s41
    s_add_u32 s44, s44, 995328
    s_add_u32 s42, s42, 1
    s_cmp_ge_u32 s42, 9
    s_cselect_b32 s42, 0, s42
    s_add_u32 m0, s40, 27648
    s_nop 0
    buffer_load_dwordx4 v9, s[8:11], s44 offen lds
    ds_read_b64_tr_b16 v[108:109], v149 offset:27680
    ds_read_b64_tr_b16 v[110:111], v149 offset:32288
    s_waitcnt lgkmcnt(12)
    v_mfma_f32_16x16x32_bf16 v[60:63], v[120:123], v[128:131], v[60:63]
    v_mfma_f32_16x16x32_bf16 v[64:67], v[120:123], v[132:135], v[64:67]
    s_add_u32 m0, s40, 28672
    s_nop 0
    buffer_load_dwordx4 v10, s[8:11], s44 offen lds
    ds_read_b64_tr_b16 v[112:113], v149 offset:27712
    ds_read_b64_tr_b16 v[114:115], v149 offset:32320
    s_waitcnt lgkmcnt(12)
    v_mfma_f32_16x16x32_bf16 v[68:71], v[92:95], v[128:131], v[68:71]
    v_mfma_f32_16x16x32_bf16 v[72:75], v[92:95], v[132:135], v[72:75]
    s_add_u32 m0, s40, 29696
    s_nop 0
    buffer_load_dwordx4 v11, s[8:11], s44 offen lds
    ds_read_b64_tr_b16 v[116:117], v149 offset:27744
    ds_read_b64_tr_b16 v[118:119], v149 offset:32352
    s_waitcnt lgkmcnt(12)
    v_mfma_f32_16x16x32_bf16 v[76:79], v[96:99], v[128:131], v[76:79]
    v_mfma_f32_16x16x32_bf16 v[80:83], v[96:99], v[132:135], v[80:83]
    s_add_u32 m0, s40, 30720
    s_mov_b64 exec, 0xffffff
    buffer_load_dwordx4 v12, s[8:11], s44 offen lds
    s_mov_b64 exec, -1
    ds_read_b64_tr_b16 v[120:121], v149 offset:27776
    ds_read_b64_tr_b16 v[122:123], v149 offset:32384
    s_waitcnt lgkmcnt(12)
    v_mfma_f32_16x16x32_bf16 v[84:87], v[100:103], v[128:131], v[84:87]
    v_mfma_f32_16x16x32_bf16 v[88:91], v[100:103], v[132:135], v[88:91]
    s_waitcnt vmcnt(4)
    s_barrier
    s_mul_i32 s45, s43, 3072
    s_add_u32 s43, s43, 1
    s_cmp_ge_u32 s43, 9
    s_cselect_b32 s43, 0, s43
    v_add_u32 v150, s45, v151
    ds_read_b128 v[128:131], v150 offset:1024
    ds_read_b128 v[132:135], v150 offset:2048
    ds_read_b64_tr_b16 v[92:93], v148 offset:0
    ds_read_b64_tr_b16 v[94:95], v148 offset:4608
    s_waitcnt lgkmcnt(12)
    v_mfma_f32_16x16x32_bf16 v[52:55], v[104:107], v[140:143], v[52:55]
    v_mfma_f32_16x16x32_bf16 v[56:59], v[104:107], v[144:147], v[56:59]
    s_mul_i32 s44, s42, 110592
    s_add_u32 s44, s44, s41
    s_add_u32 s44, s44, 995328
    s_add_u32 s42, s42, 1
    s_cmp_ge_u32 s42, 9
    s_cselect_b32 s42, 0, s42
    s_add_u32 m0, s40, 55296
    s_nop 0
    buffer_load_dwordx4 v9, s[8:11], s44 offen lds
    ds_read_b64_tr_b16 v[96:97], v148 offset:32
    ds_read_b64_tr_b16 v[98:99], v148 offset:4640
    s_waitcnt lgkmcnt(12)
    v_mfma_f32_16x16x32_bf16 v[60:63], v[108:111], v[140:143], v[60:63]
    v_mfma_f32_16x16x32_bf16 v[64:67], v[108:111], v[144:147], v[64:67]
    s_add_u32 m0, s40, 56320
    s_nop 0
    buffer_load_dwordx4 v10, s[8:11], s44 offen lds
    ds_read_b64_tr_b16 v[100:101], v148 offset:64
    ds_read_b64_tr_b16 v[102:103], v148 offset:4672
    s_waitcnt lgkmcnt(12)
    v_mfma_f32_16x16x32_bf16 v[68:71], v[112:115], v[140:143], v[68:71]
    v_mfma_f32_16x16x32_bf16 v[72:75], v[112:115], v[144:147], v[72:75]
    s_add_u32 m0, s40, 57344
    s_nop 0
    buffer_load_dwordx4 v11, s[8:11], s44 offen lds
    ds_read_b64_tr_b16 v[104:105], v148 offset:96
    ds_read_b64_tr_b16 v[106:107], v148 offset:4704
    s_waitcnt lgkmcnt(12)
    v_mfma_f32_16x16x32_bf16 v[76:79], v[116:119], v[140:143], v[76:79]
    v_mfma_f32_16x16x32_bf16 v[80:83], v[116:119], v[144:147], v[80:83]
    s_add_u32 m0, s40, 58368
    s_mov_b64 exec, 0xffffff
    buffer_load_dwordx4 v12, s[8:11], s44 offen lds
    s_mov_b64 exec, -1
    ds_read_b64_tr_b16 v[108:109], v148 offset:128
    ds_read_b64_tr_b16 v[110:111], v148 offset:4736
    s_waitcnt lgkmcnt(12)
    v_mfma_f32_16x16x32_bf16 v[84:87], v[120:123], v[140:143], v[84:87]
    v_mfma_f32_16x16x32_bf16 v[88:91], v[120:123], v[144:147], v[88:91]
    s_waitcnt lgkmcnt(8)
    v_mfma_f32_16x16x32_bf16 v[52:55], v[92:95], v[128:131], v[52:55]
    v_mfma_f32_16x16x32_bf16 v[56:59], v[92:95], v[132:135], v[56:59]
    s_waitcnt lgkmcnt(6)
    v_mfma_f32_16x16x32_bf16 v[60:63], v[96:99], v[128:131], v[60:63]
    v_mfma_f32_16x16x32_bf16 v[64:67], v[96:99], v[132:135], v[64:67]
    s_waitcnt lgkmcnt(4)
    v_mfma_f32_16x16x32_bf16 v[68:71], v[100:103], v[128:131], v[68:71]
    v_mfma_f32_16x16x32_bf16 v[72:75], v[100:103], v[132:135], v[72:75]
    s_waitcnt lgkmcnt(2)
    v_mfma_f32_16x16x32_bf16 v[76:79], v[104:107], v[128:131], v[76:79]
    v_mfma_f32_16x16x32_bf16 v[80:83], v[104:107], v[132:135], v[80:83]
    s_waitcnt lgkmcnt(0)
    v_mfma_f32_16x16x32_bf16 v[84:87], v[108:111], v[128:131], v[84:87]
    v_mfma_f32_16x16x32_bf16 v[88:91], v[108:111], v[132:135], v[88:91]
    s_barrier
    ds_write_b128 v152, v[28:31] offset:0
    ds_write_b128 v152, v[32:35] offset:1024
    ds_write_b128 v152, v[36:39] offset:2048
    s_cmp_lg_u32 s24, 1
    s_cbranch_scc1 P12_H1_16
    ds_write_b128 v151, v[40:43] offset:24576
    ds_write_b128 v151, v[44:47] offset:25600
    ds_write_b128 v151, v[48:51] offset:26624
P12_H1_16:
    s_waitcnt lgkmcnt(0)
    s_waitcnt vmcnt(4)
    s_barrier
    s_mul_i32 s45, s43, 3072
    s_add_u32 s43, s43, 1
    s_cmp_ge_u32 s43, 9
    s_cselect_b32 s43, 0, s43
    v_add_u32 v150, s45, v151
    ds_read_b128 v[140:143], v150 offset:1024
    ds_read_b128 v[144:147], v150 offset:2048
    ds_read_b64_tr_b16 v[112:113], v148 offset:27648
    ds_read_b64_tr_b16 v[114:115], v148 offset:32256
    ds_read_b64_tr_b16 v[116:117], v148 offset:27680
    ds_read_b64_tr_b16 v[118:119], v148 offset:32288
    ds_read_b64_tr_b16 v[120:121], v148 offset:27712
    ds_read_b64_tr_b16 v[122:123], v148 offset:32320
    ds_read_b64_tr_b16 v[92:93], v148 offset:27744
    ds_read_b64_tr_b16 v[94:95], v148 offset:32352
    ds_read_b64_tr_b16 v[96:97], v148 offset:27776
    ds_read_b64_tr_b16 v[98:99], v148 offset:32384
    s_waitcnt vmcnt(0)
    s_barrier
    s_mul_i32 s45, s43, 3072
    s_add_u32 s43, s43, 1
    s_cmp_ge_u32 s43, 9
    s_cselect_b32 s43, 0, s43
    v_add_u32 v150, s45, v151
    ds_read_b128 v[128:131], v150 offset:1024
    ds_read_b128 v[132:135], v150 offset:2048
    ds_read_b64_tr_b16 v[100:101], v149 offset:0
    ds_read_b64_tr_b16 v[102:103], v149 offset:4608
    s_waitcnt lgkmcnt(12)
    v_mfma_f32_16x16x32_bf16 v[52:55], v[112:115], v[140:143], v[52:55]
    v_mfma_f32_16x16x32_bf16 v[56:59], v[112:115], v[144:147], v[56:59]
    s_mul_i32 s44, s42, 110592
    s_add_u32 s44, s44, s41
    s_add_u32 s44, s44, 995328
    s_add_u32 s42, s42, 1
    s_cmp_ge_u32 s42, 9
    s_cselect_b32 s42, 0, s42
    s_add_u32 m0, s40, 82944
    s_nop 0
    buffer_load_dwordx4 v9, s[8:11], s44 offen lds
    ds_read_b64_tr_b16 v[104:105], v149 offset:32
    ds_read_b64_tr_b16 v[106:107], v149 offset:4640
    s_waitcnt lgkmcnt(12)
    v_mfma_f32_16x16x32_bf16 v[60:63], v[116:119], v[140:143], v[60:63]
    v_mfma_f32_16x16x32_bf16 v[64:67], v[116:119], v[144:147], v[64:67]
    s_add_u32 m0, s40, 83968
    s_nop 0
    buffer_load_dwordx4 v10, s[8:11], s44 offen lds
    ds_read_b64_tr_b16 v[108:109], v149 offset:64
    ds_read_b64_tr_b16 v[110:111], v149 offset:4672
    s_waitcnt lgkmcnt(12)
    v_mfma_f32_16x16x32_bf16 v[68:71], v[120:123], v[140:143], v[68:71]
    v_mfma_f32_16x16x32_bf16 v[72:75], v[120:123], v[144:147], v[72:75]
    s_add_u32 m0, s40, 84992
    s_nop 0
    buffer_load_dwordx4 v11, s[8:11], s44 offen lds
    ds_read_b64_tr_b16 v[112:113], v149 offset:96
    ds_read_b64_tr_b16 v[114:115], v149 offset:4704
    s_waitcnt lgkmcnt(12)
    v_mfma_f32_16x16x32_bf16 v[76:79], v[92:95], v[140:143], v[76:79]
    v_mfma_f32_16x16x32_bf16 v[80:83], v[92:95], v[144:147], v[80:83]
    s_add_u32 m0, s40, 86016
    s_mov_b64 exec, 0xffffff
    buffer_load_dwordx4 v12, s[8:11], s44 offen lds
    s_mov_b64 exec, -1
    ds_read_b64_tr_b16 v[116:117], v149 offset:128
    ds_read_b64_tr_b16 v[118:119], v149 offset:4736
    s_waitcnt lgkmcnt(12)
    v_mfma_f32_16x16x32_bf16 v[84:87], v[96:99], v[140:143], v[84:87]
    v_mfma_f32_16x16x32_bf16 v[88:91], v[96:99], v[144:147], v[88:91]
    s_mul_i32 s44, s42, 110592
    s_add_u32 s44, s44, s41
    s_add_u32 s44, s44, 995328
    s_add_u32 s42, s42, 1
    s_cmp_ge_u32 s42, 9
    s_cselect_b32 s42, 0, s42
    s_add_u32 m0, s40, 0
    s_nop 0
    buffer_load_dwordx4 v9, s[8:11], s44 offen lds
    s_waitcnt vmcnt(1)
    s_barrier
    s_mul_i32 s45, s43, 3072
    s_add_u32 s43, s43, 1
    s_cmp_ge_u32 s43, 9
    s_cselect_b32 s43, 0, s43
    v_add_u32 v150, s45, v151
    ds_read_b128 v[140:143], v150 offset:1024
    ds_read_b128 v[144:147], v150 offset:2048
    ds_read_b64_tr_b16 v[120:121], v149 offset:27648
    ds_read_b64_tr_b16 v[122:123], v149 offset:32256
    s_waitcnt lgkmcnt(12)
    v_mfma_f32_16x16x32_bf16 v[52:55], v[100:103], v[128:131], v[52:55]
    v_mfma_f32_16x16x32_bf16 v[56:59], v[100:103], v[132:135], v[56:59]
    s_add_u32 m0, s40, 1024
    s_nop 0
    buffer_load_dwordx4 v10, s[8:11], s44 offen lds
    ds_read_b64_tr_b16 v[92:93], v149 offset:27680
    ds_read_b64_tr_b16 v[94:95], v149 offset:32288
    s_waitcnt lgkmcnt(12)
    v_mfma_f32_16x16x32_bf16 v[60:63], v[104:107], v[128:131], v[60:63]
    v_mfma_f32_16x16x32_bf16 v[64:67], v[104:107], v[132:135], v[64:67]
    s_add_u32 m0, s40, 2048
    s_nop 0
    buffer_load_dwordx4 v11, s[8:11], s44 offen lds
    ds_read_b64_tr_b16 v[96:97], v149 offset:27712
    ds_read_b64_tr_b16 v[98:99], v149 offset:32320
    s_waitcnt lgkmcnt(12)
    v_mfma_f32_16x16x32_bf16 v[68:71], v[108:111], v[128:131], v[68:71]
    v_mfma_f32_16x16x32_bf16 v[72:75], v[108:111], v[132:135], v[72:75]
    s_add_u32 m0, s40, 3072
    s_mov_b64 exec, 0xffffff
    buffer_load_dwordx4 v12, s[8:11], s44 offen lds
    s_mov_b64 exec, -1
    ds_read_b64_tr_b16 v[100:101], v149 offset:27744
    ds_read_b64_tr_b16 v[102:103], v149 offset:32352
    s_waitcnt lgkmcnt(12)
    v_mfma_f32_16x16x32_bf16 v[76:79], v[112:115], v[128:131], v[76:79]
    v_mfma_f32_16x16x32_bf16 v[80:83], v[112:115], v[132:135], v[80:83]
    s_mul_i32 s44, s42, 110592
    s_add_u32 s44, s44, s41
    s_add_u32 s44, s44, 995328
    s_add_u32 s42, s42, 1
    s_cmp_ge_u32 s42, 9
    s_cselect_b32 s42, 0, s42
    s_add_u32 m0, s40, 27648
    s_nop 0
    buffer_load_dwordx4 v9, s[8:11], s44 offen lds
    ds_read_b64_tr_b16 v[104:105], v149 offset:27776
    ds_read_b64_tr_b16 v[106:107], v149 offset:32384
    s_waitcnt lgkmcnt(12)
    v_mfma_f32_16x16x32_bf16 v[84:87], v[116:119], v[128:131], v[84:87]
    v_mfma_f32_16x16x32_bf16 v[88:91], v[116:119], v[132:135], v[88:91]
    s_add_u32 m0, s40, 28672
    s_nop 0
    buffer_load_dwordx4 v10, s[8:11], s44 offen lds
    s_waitcnt vmcnt(2)
    s_barrier
    s_mul_i32 s45, s43, 3072
    s_add_u32 s43, s43, 1
    s_cmp_ge_u32 s43, 9
    s_cselect_b32 s43, 0, s43
    v_add_u32 v150, s45, v151
    ds_read_b128 v[128:131], v150 offset:1024
    ds_read_b128 v[132:135], v150 offset:2048
    ds_read_b64_tr_b16 v[108:109], v148 offset:0
    ds_read_b64_tr_b16 v[110:111], v148 offset:4608
    s_waitcnt lgkmcnt(12)
    v_mfma_f32_16x16x32_bf16 v[52:55], v[120:123], v[140:143], v[52:55]
    v_mfma_f32_16x16x32_bf16 v[56:59], v[120:123], v[144:147], v[56:59]
    s_add_u32 m0, s40, 29696
    s_nop 0
    buffer_load_dwordx4 v11, s[8:11], s44 offen lds
    ds_read_b64_tr_b16 v[112:113], v148 offset:32
    ds_read_b64_tr_b16 v[114:115], v148 offset:4640
    s_waitcnt lgkmcnt(12)
    v_mfma_f32_16x16x32_bf16 v[60:63], v[92:95], v[140:143], v[60:63]
    v_mfma_f32_16x16x32_bf16 v[64:67], v[92:95], v[144:147], v[64:67]
    s_add_u32 m0, s40, 30720
    s_mov_b64 exec, 0xffffff
    buffer_load_dwordx4 v12, s[8:11], s44 offen lds
    s_mov_b64 exec, -1
    ds_read_b64_tr_b16 v[116:117], v148 offset:64
    ds_read_b64_tr_b16 v[118:119], v148 offset:4672
    s_waitcnt lgkmcnt(12)
    v_mfma_f32_16x16x32_bf16 v[68:71], v[96:99], v[140:143], v[68:71]
    v_mfma_f32_16x16x32_bf16 v[72:75], v[96:99], v[144:147], v[72:75]
    s_mul_i32 s44, s42, 110592
    s_add_u32 s44, s44, s41
    s_add_u32 s44, s44, 995328
    s_add_u32 s42, s42, 1
    s_cmp_ge_u32 s42, 9
    s_cselect_b32 s42, 0, s42
    s_add_u32 m0, s40, 55296
    s_nop 0
    buffer_load_dwordx4 v9, s[8:11], s44 offen lds
    ds_read_b64_tr_b16 v[120:121], v148 offset:96
    ds_read_b64_tr_b16 v[122:123], v148 offset:4704
    s_waitcnt lgkmcnt(12)
    v_mfma_f32_16x16x32_bf16 v[76:79], v[100:103], v[140:143], v[76:79]
    v_mfma_f32_16x16x32_bf16 v[80:83], v[100:103], v[144:147], v[80:83]
    s_add_u32 m0, s40, 56320
    s_nop 0
    buffer_load_dwordx4 v10, s[8:11], s44 offen lds
    ds_read_b64_tr_b16 v[92:93], v148 offset:128
    ds_read_b64_tr_b16 v[94:95], v148 offset:4736
    s_waitcnt lgkmcnt(12)
    v_mfma_f32_16x16x32_bf16 v[84:87], v[104:107], v[140:143], v[84:87]
    v_mfma_f32_16x16x32_bf16 v[88:91], v[104:107], v[144:147], v[88:91]
    s_add_u32 m0, s40, 57344
    s_nop 0
    buffer_load_dwordx4 v11, s[8:11], s44 offen lds
    s_waitcnt vmcnt(3)
    s_barrier
    s_mul_i32 s45, s43, 3072
    s_add_u32 s43, s43, 1
    s_cmp_ge_u32 s43, 9
    s_cselect_b32 s43, 0, s43
    v_add_u32 v150, s45, v151
    ds_read_b128 v[140:143], v150 offset:1024
    ds_read_b128 v[144:147], v150 offset:2048
    ds_read_b64_tr_b16 v[96:97], v148 offset:27648
    ds_read_b64_tr_b16 v[98:99], v148 offset:32256
    s_waitcnt lgkmcnt(12)
    v_mfma_f32_16x16x32_bf16 v[52:55], v[108:111], v[128:131], v[52:55]
    v_mfma_f32_16x16x32_bf16 v[56:59], v[108:111], v[132:135], v[56:59]
    s_add_u32 m0, s40, 58368
    s_mov_b64 exec, 0xffffff
    buffer_load_dwordx4 v12, s[8:11], s44 offen lds
    s_mov_b64 exec, -1
    ds_read_b64_tr_b16 v[100:101], v148 offset:27680
    ds_read_b64_tr_b16 v[102:103], v148 offset:32288
    s_waitcnt lgkmcnt(12)
    v_mfma_f32_16x16x32_bf16 v[60:63], v[112:115], v[128:131], v[60:63]
    v_mfma_f32_16x16x32_bf16 v[64:67], v[112:115], v[132:135], v[64:67]
    s_mul_i32 s44, s42, 110592
    s_add_u32 s44, s44, s41
    s_add_u32 s44, s44, 995328
    s_add_u32 s42, s42, 1
    s_cmp_ge_u32 s42, 9
    s_cselect_b32 s42, 0, s42
    s_add_u32 m0, s40, 82944
    s_nop 0
    buffer_load_dwordx4 v9, s[8:11], s44 offen lds
    ds_read_b64_tr_b16 v[104:105], v148 offset:27712
    ds_read_b64_tr_b16 v[106:107], v148 offset:32320
    s_waitcnt lgkmcnt(12)
    v_mfma_f32_16x16x32_bf16 v[68:71], v[116:119], v[128:131], v[68:71]
    v_mfma_f32_16x16x32_bf16 v[72:75], v[116:119], v[132:135], v[72:75]
    s_add_u32 m0, s40, 83968
    s_nop 0
    buffer_load_dwordx4 v10, s[8:11], s44 offen lds
    ds_read_b64_tr_b16 v[108:109], v148 offset:27744
    ds_read_b64_tr_b16 v[110:111], v148 offset:32352
    s_waitcnt lgkmcnt(12)
    v_mfma_f32_16x16x32_bf16 v[76:79], v[120:123], v[128:131], v[76:79]
    v_mfma_f32_16x16x32_bf16 v[80:83], v[120:123], v[132:135], v[80:83]
    s_add_u32 m0, s40, 84992
    s_nop 0
    buffer_load_dwordx4 v11, s[8:11], s44 offen lds
    ds_read_b64_tr_b16 v[112:113], v148 offset:27776
    ds_read_b64_tr_b16 v[114:115], v148 offset:32384
    s_waitcnt lgkmcnt(12)
    v_mfma_f32_16x16x32_bf16 v[84:87], v[92:95], v[128:131], v[84:87]
    v_mfma_f32_16x16x32_bf16 v[88:91], v[92:95], v[132:135], v[88:91]
    s_add_u32 m0, s40, 86016
    s_mov_b64 exec, 0xffffff
    buffer_load_dwordx4 v12, s[8:11], s44 offen lds
    s_mov_b64 exec, -1
    s_waitcnt vmcnt(4)
    s_barrier
    s_mul_i32 s45, s43, 3072
    s_add_u32 s43, s43, 1
    s_cmp_ge_u32 s43, 9
    s_cselect_b32 s43, 0, s43
    v_add_u32 v150, s45, v151
    ds_read_b128 v[128:131], v150 offset:1024
    ds_read_b128 v[132:135], v150 offset:2048
    ds_read_b64_tr_b16 v[116:117], v149 offset:0
    ds_read_b64_tr_b16 v[118:119], v149 offset:4608
    s_waitcnt lgkmcnt(12)
    v_mfma_f32_16x16x32_bf16 v[52:55], v[96:99], v[140:143], v[52:55]
    v_mfma_f32_16x16x32_bf16 v[56:59], v[96:99], v[144:147], v[56:59]
    s_mul_i32 s44, s42, 110592
    s_add_u32 s44, s44, s41
    s_add_u32 s44, s44, 995328
    s_add_u32 s42, s42, 1
    s_cmp_ge_u32 s42, 9
    s_cselect_b32 s42, 0, s42
    s_add_u32 m0, s40, 0
    s_nop 0
    buffer_load_dwordx4 v9, s[8:11], s44 offen lds
    ds_read_b64_tr_b16 v[120:121], v149 offset:32
    ds_read_b64_tr_b16 v[122:123], v149 offset:4640
    s_waitcnt lgkmcnt(12)
    v_mfma_f32_16x16x32_bf16 v[60:63], v[100:103], v[140:143], v[60:63]
    v_mfma_f32_16x16x32_bf16 v[64:67], v[100:103], v[144:147], v[64:67]
    s_add_u32 m0, s40, 1024
    s_nop 0
    buffer_load_dwordx4 v10, s[8:11], s44 offen lds
    ds_read_b64_tr_b16 v[92:93], v149 offset:64
    ds_read_b64_tr_b16 v[94:95], v149 offset:4672
    s_waitcnt lgkmcnt(12)
    v_mfma_f32_16x16x32_bf16 v[68:71], v[104:107], v[140:143], v[68:71]
    v_mfma_f32_16x16x32_bf16 v[72:75], v[104:107], v[144:147], v[72:75]
    s_add_u32 m0, s40, 2048
    s_nop 0
    buffer_load_dwordx4 v11, s[8:11], s44 offen lds
    ds_read_b64_tr_b16 v[96:97], v149 offset:96
    ds_read_b64_tr_b16 v[98:99], v149 offset:4704
    s_waitcnt lgkmcnt(12)
    v_mfma_f32_16x16x32_bf16 v[76:79], v[108:111], v[140:143], v[76:79]
    v_mfma_f32_16x16x32_bf16 v[80:83], v[108:111], v[144:147], v[80:83]
    s_add_u32 m0, s40, 3072
    s_mov_b64 exec, 0xffffff
    buffer_load_dwordx4 v12, s[8:11], s44 offen lds
    s_mov_b64 exec, -1
    ds_read_b64_tr_b16 v[100:101], v149 offset:128
    ds_read_b64_tr_b16 v[102:103], v149 offset:4736
    s_waitcnt lgkmcnt(12)
    v_mfma_f32_16x16x32_bf16 v[84:87], v[112:115], v[140:143], v[84:87]
    v_mfma_f32_16x16x32_bf16 v[88:91], v[112:115], v[144:147], v[88:91]
    s_waitcnt vmcnt(4)
    s_barrier
    s_mul_i32 s45, s43, 3072
    s_add_u32 s43, s43, 1
    s_cmp_ge_u32 s43, 9
    s_cselect_b32 s43, 0, s43
    v_add_u32 v150, s45, v151
    ds_read_b128 v[140:143], v150 offset:1024
    ds_read_b128 v[144:147], v150 offset:2048
    ds_read_b64_tr_b16 v[104:105], v149 offset:27648
    ds_read_b64_tr_b16 v[106:107], v149 offset:32256
    s_waitcnt lgkmcnt(12)
    v_mfma_f32_16x16x32_bf16 v[52:55], v[116:119], v[128:131], v[52:55]
    v_mfma_f32_16x16x32_bf16 v[56:59], v[116:119], v[132:135], v[56:59]
    s_mul_i32 s44, s42, 110592
    s_add_u32 s44, s44, s41
    s_add_u32 s44, s44, 995328
    s_add_u32 s42, s42, 1
    s_cmp_ge_u32 s42, 9
    s_cselect_b32 s42, 0, s42
    s_add_u32 m0, s40, 27648
    s_nop 0
    buffer_load_dwordx4 v9, s[8:11], s44 offen lds
    ds_read_b64_tr_b16 v[108:109], v149 offset:27680
    ds_read_b64_tr_b16 v[110:111], v149 offset:32288
    s_waitcnt lgkmcnt(12)
    v_mfma_f32_16x16x32_bf16 v[60:63], v[120:123], v[128:131], v[60:63]
    v_mfma_f32_16x16x32_bf16 v[64:67], v[120:123], v[132:135], v[64:67]
    s_add_u32 m0, s40, 28672
    s_nop 0
    buffer_load_dwordx4 v10, s[8:11], s44 offen lds
    ds_read_b64_tr_b16 v[112:113], v149 offset:27712
    ds_read_b64_tr_b16 v[114:115], v149 offset:32320
    s_waitcnt lgkmcnt(12)
    v_mfma_f32_16x16x32_bf16 v[68:71], v[92:95], v[128:131], v[68:71]
    v_mfma_f32_16x16x32_bf16 v[72:75], v[92:95], v[132:135], v[72:75]
    s_add_u32 m0, s40, 29696
    s_nop 0
    buffer_load_dwordx4 v11, s[8:11], s44 offen lds
    ds_read_b64_tr_b16 v[116:117], v149 offset:27744
    ds_read_b64_tr_b16 v[118:119], v149 offset:32352
    s_waitcnt lgkmcnt(12)
    v_mfma_f32_16x16x32_bf16 v[76:79], v[96:99], v[128:131], v[76:79]
    v_mfma_f32_16x16x32_bf16 v[80:83], v[96:99], v[132:135], v[80:83]
    s_add_u32 m0, s40, 30720
    s_mov_b64 exec, 0xffffff
    buffer_load_dwordx4 v12, s[8:11], s44 offen lds
    s_mov_b64 exec, -1
    ds_read_b64_tr_b16 v[120:121], v149 offset:27776
    ds_read_b64_tr_b16 v[122:123], v149 offset:32384
    s_waitcnt lgkmcnt(12)
    v_mfma_f32_16x16x32_bf16 v[84:87], v[100:103], v[128:131], v[84:87]
    v_mfma_f32_16x16x32_bf16 v[88:91], v[100:103], v[132:135], v[88:91]
    s_waitcnt vmcnt(4)
    s_barrier
    s_mul_i32 s45, s43, 3072
    s_add_u32 s43, s43, 1
    s_cmp_ge_u32 s43, 9
    s_cselect_b32 s43, 0, s43
    v_add_u32 v150, s45, v151
    ds_read_b128 v[128:131], v150 offset:1024
    ds_read_b128 v[132:135], v150 offset:2048
    ds_read_b64_tr_b16 v[92:93], v148 offset:0
    ds_read_b64_tr_b16 v[94:95], v148 offset:4608
    s_waitcnt lgkmcnt(12)
    v_mfma_f32_16x16x32_bf16 v[52:55], v[104:107], v[140:143], v[52:55]
    v_mfma_f32_16x16x32_bf16 v[56:59], v[104:107], v[144:147], v[56:59]
    ds_read_b64_tr_b16 v[96:97], v148 offset:32
    ds_read_b64_tr_b16 v[98:99], v148 offset:4640
    s_waitcnt lgkmcnt(12)
    v_mfma_f32_16x16x32_bf16 v[60:63], v[108:111], v[140:143], v[60:63]
    v_mfma_f32_16x16x32_bf16 v[64:67], v[108:111], v[144:147], v[64:67]
    ds_read_b64_tr_b16 v[100:101], v148 offset:64
    ds_read_b64_tr_b16 v[102:103], v148 offset:4672
    s_waitcnt lgkmcnt(12)
    v_mfma_f32_16x16x32_bf16 v[68:71], v[112:115], v[140:143], v[68:71]
    v_mfma_f32_16x16x32_bf16 v[72:75], v[112:115], v[144:147], v[72:75]
    ds_read_b64_tr_b16 v[104:105], v148 offset:96
    ds_read_b64_tr_b16 v[106:107], v148 offset:4704
    s_waitcnt lgkmcnt(12)
    v_mfma_f32_16x16x32_bf16 v[76:79], v[116:119], v[140:143], v[76:79]
    v_mfma_f32_16x16x32_bf16 v[80:83], v[116:119], v[144:147], v[80:83]
    ds_read_b64_tr_b16 v[108:109], v148 offset:128
    ds_read_b64_tr_b16 v[110:111], v148 offset:4736
    s_waitcnt lgkmcnt(12)
    v_mfma_f32_16x16x32_bf16 v[84:87], v[120:123], v[140:143], v[84:87]
    v_mfma_f32_16x16x32_bf16 v[88:91], v[120:123], v[144:147], v[88:91]
    s_waitcnt vmcnt(0)
    s_barrier
    s_mul_i32 s45, s43, 3072
    s_add_u32 s43, s43, 1
    s_cmp_ge_u32 s43, 9
    s_cselect_b32 s43, 0, s43
    v_add_u32 v150, s45, v151
    ds_read_b128 v[140:143], v150 offset:1024
    ds_read_b128 v[144:147], v150 offset:2048
    ds_read_b64_tr_b16 v[112:113], v148 offset:27648
    ds_read_b64_tr_b16 v[114:115], v148 offset:32256
    s_waitcnt lgkmcnt(12)
    v_mfma_f32_16x16x32_bf16 v[52:55], v[92:95], v[128:131], v[52:55]
    v_mfma_f32_16x16x32_bf16 v[56:59], v[92:95], v[132:135], v[56:59]
    ds_read_b64_tr_b16 v[116:117], v148 offset:27680
    ds_read_b64_tr_b16 v[118:119], v148 offset:32288
    s_waitcnt lgkmcnt(12)
    v_mfma_f32_16x16x32_bf16 v[60:63], v[96:99], v[128:131], v[60:63]
    v_mfma_f32_16x16x32_bf16 v[64:67], v[96:99], v[132:135], v[64:67]
    ds_read_b64_tr_b16 v[120:121], v148 offset:27712
    ds_read_b64_tr_b16 v[122:123], v148 offset:32320
    s_waitcnt lgkmcnt(12)
    v_mfma_f32_16x16x32_bf16 v[68:71], v[100:103], v[128:131], v[68:71]
    v_mfma_f32_16x16x32_bf16 v[72:75], v[100:103], v[132:135], v[72:75]
    ds_read_b64_tr_b16 v[92:93], v148 offset:27744
    ds_read_b64_tr_b16 v[94:95], v148 offset:32352
    s_waitcnt lgkmcnt(12)
    v_mfma_f32_16x16x32_bf16 v[76:79], v[104:107], v[128:131], v[76:79]
    v_mfma_f32_16x16x32_bf16 v[80:83], v[104:107], v[132:135], v[80:83]
    ds_read_b64_tr_b16 v[96:97], v148 offset:27776
    ds_read_b64_tr_b16 v[98:99], v148 offset:32384
    s_waitcnt lgkmcnt(12)
    v_mfma_f32_16x16x32_bf16 v[84:87], v[108:111], v[128:131], v[84:87]
    v_mfma_f32_16x16x32_bf16 v[88:91], v[108:111], v[132:135], v[88:91]
    s_waitcnt lgkmcnt(8)
    v_mfma_f32_16x16x32_bf16 v[52:55], v[112:115], v[140:143], v[52:55]
    v_mfma_f32_16x16x32_bf16 v[56:59], v[112:115], v[144:147], v[56:59]
    s_waitcnt lgkmcnt(6)
    v_mfma_f32_16x16x32_bf16 v[60:63], v[116:119], v[140:143], v[60:63]
    v_mfma_f32_16x16x32_bf16 v[64:67], v[116:119], v[144:147], v[64:67]
    s_waitcnt lgkmcnt(4)
    v_mfma_f32_16x16x32_bf16 v[68:71], v[120:123], v[140:143], v[68:71]
    v_mfma_f32_16x16x32_bf16 v[72:75], v[120:123], v[144:147], v[72:75]
    s_waitcnt lgkmcnt(2)
    v_mfma_f32_16x16x32_bf16 v[76:79], v[92:95], v[140:143], v[76:79]
    v_mfma_f32_16x16x32_bf16 v[80:83], v[92:95], v[144:147], v[80:83]
    s_waitcnt lgkmcnt(0)
    v_mfma_f32_16x16x32_bf16 v[84:87], v[96:99], v[140:143], v[84:87]
    v_mfma_f32_16x16x32_bf16 v[88:91], v[96:99], v[144:147], v[88:91]
    s_barrier
    s_nop 3
    v_and_b32 v1, 15, v0
    v_mul_u32_u24 v1, 1744, v1
    v_lshrrev_b32 v2, 4, v0
    v_lshl_add_u32 v1, v2, 4, v1
    s_mul_i32 s45, s49, 576
    s_lshl_b32 s46, s50, 6
    s_add_u32 s45, s45, s46
    v_add_u32 v1, s45, v1
    ds_write_b128 v1, v[52:55] offset:27904
    ds_write_b128 v1, v[56:59] offset:55808
    ds_write_b128 v1, v[60:63] offset:27968
    ds_write_b128 v1, v[64:67] offset:55872
    ds_write_b128 v1, v[68:71] offset:28032
    ds_write_b128 v1, v[72:75] offset:55936
    ds_write_b128 v1, v[76:79] offset:28096
    ds_write_b128 v1, v[80:83] offset:56000
    s_cmp_eq_u32 s24, 7
    s_cbranch_scc1 P12_S_17
    ds_write_b128 v1, v[84:87] offset:28160
    ds_write_b128 v1, v[88:91] offset:56064
P12_S_17:
P12_GE_13:
    s_cmp_lg_u32 s24, 0
    s_cbranch_scc1 W0DONE_18
    s_mov_b32 s56, 0
    v_and_b32 v4, 1, v0
    v_lshlrev_b32 v4, 6, v4
W0LOOP_19:
    buffer_load_dword v3, v4, s[72:75], 0 offen offset:128 sc1
    s_waitcnt vmcnt(0)
    v_readlane_b32 s76, v3, 0
    v_readlane_b32 s77, v3, 1
    s_add_u32 s56, s56, 1
    s_add_u32 s76, s76, s77
    s_cmp_ge_u32 s76, 256
    s_cbranch_scc1 W0DONE_18
    s_cmp_gt_u32 s56, 0x400000
    s_cbranch_scc1 W0DONE_18
    s_sleep 4
    s_branch W0LOOP_19
W0DONE_18:
    s_barrier
    s_lshr_b32 s76, s2, 5
    s_lshl_b32 s76, s76, 2
    s_and_b32 s77, s24, 3
    s_add_u32 s76, s76, s77
    s_mul_i32 s76, s76, 54
    v_add_u32 v150, s76, v0
    v_mul_u32_u24 v151, 21846, v150
    v_lshrrev_b32 v151, 16, v151
    v_mul_u32_u24 v152, 3, v151
    v_sub_u32 v150, v150, v152
    v_mul_u32_u24 v150, 142, v150
    v_and_b32 v150, 0x1fc, v150
    v_mul_u32_u24 v151, 9216, v151
    v_add_u32 v150, v150, v151
    s_and_b32 s76, s2, 31
    s_mul_i32 s76, s76, 288
    s_mov_b32 exec_hi, 0x3fffff
    buffer_load_dword v155, v150, s[12:15], s76 offen
    s_mov_b64 exec, -1
    v_lshrrev_b32 v140, 4, v0
    s_lshl_b32 s45, s24, 2
    v_add_u32 v140, s45, v140
    v_bfe_u32 v1, v0, 1, 3
    v_mul_u32_u24 v1, 72, v1
    v_mul_u32_u24 v141, 1744, v140
    v_add_u32 v141, v141, v1
    v_and_b32 v2, 1, v0
    v_mul_u32_u24 v3, 13952, v2
    v_sub_u32 v142, v141, v3
    v_add_u32 v142, 17440, v142
    s_waitcnt lgkmcnt(0)
    s_barrier
    ds_read_b64 v[16:17], v141 offset:27904
    ds_read_b64 v[18:19], v141 offset:27912
    ds_read_b64 v[20:21], v141 offset:27920
    ds_read_b64 v[22:23], v141 offset:27928
    ds_read_b64 v[24:25], v141 offset:27936
    ds_read_b64 v[26:27], v141 offset:27944
    ds_read_b64 v[28:29], v141 offset:27952
    ds_read_b64 v[30:31], v141 offset:27960
    ds_read_b64 v[32:33], v141 offset:27968
    ds_read_b64 v[34:35], v142 offset:11040
    ds_read_b64 v[52:53], v142 offset:7552
    ds_read_b64 v[70:71], v142 offset:4064
    ds_read_b64 v[88:89], v142 offset:576
    ds_read_b64 v[36:37], v142 offset:11048
    ds_read_b64 v[54:55], v142 offset:7560
    ds_read_b64 v[72:73], v142 offset:4072
    ds_read_b64 v[90:91], v142 offset:584
    ds_read_b64 v[38:39], v142 offset:11056
    ds_read_b64 v[56:57], v142 offset:7568
    s_and_b32 s52, s2, 3
    s_mul_i32 s53, s52, 9
    s_and_b32 s54, s24, 1
    s_mul_i32 s54, s54, 5
    s_add_u32 s53, s53, s54
    s_mul_i32 s53, s53, 18
    s_lshr_b32 s54, s24, 1
    s_mul_i32 s54, s54, 5
    s_add_u32 s53, s53, s54
    s_lshl_b32 s53, s53, 10
    s_add_u32 s53, s53, 1048576
    ds_read_b64 v[74:75], v142 offset:4080
    ds_read_b64 v[92:93], v142 offset:592
    ds_read_b64 v[40:41], v142 offset:11064
    ds_read_b64 v[58:59], v142 offset:7576
    ds_read_b64 v[76:77], v142 offset:4088
    ds_read_b64 v[94:95], v142 offset:600
    ds_read_b64 v[42:43], v142 offset:11072
    ds_read_b64 v[60:61], v142 offset:7584
    ds_read_b64 v[78:79], v142 offset:4096
    ds_read_b64 v[96:97], v142 offset:608
    ds_read_b64 v[44:45], v142 offset:11080
    ds_read_b64 v[62:63], v142 offset:7592
    ds_read_b64 v[80:81], v142 offset:4104
    ds_read_b64 v[98:99], v142 offset:616
    ds_read_b64 v[46:47], v142 offset:11088
    ds_read_b64 v[64:65], v142 offset:7600
    ds_read_b64 v[82:83], v142 offset:4112
    ds_read_b64 v[100:101], v142 offset:624
    ds_read_b64 v[48:49], v142 offset:11096
    ds_read_b64 v[66:67], v142 offset:7608
    ds_read_b64 v[84:85], v142 offset:4120
    ds_read_b64 v[102:103], v142 offset:632
    ds_read_b64 v[50:51], v142 offset:11104
    ds_read_b64 v[68:69], v142 offset:7616
    ds_read_b64 v[86:87], v142 offset:4128
    ds_read_b64 v[104:105], v142 offset:640
    s_waitcnt lgkmcnt(15)
    v_pk_mul_f32 v[106:107], v[34:35], v[16:17]
    v_pk_mul_f32 v[108:109], v[52:53], v[16:17]
    v_pk_mul_f32 v[110:111], v[70:71], v[16:17]
    v_pk_mul_f32 v[112:113], v[88:89], v[16:17]
    ds_read_b64 v[34:35], v142 offset:11616
    s_add_u32 s55, s54, 0
    s_cmp_ge_u32 s55, 18
    s_cselect_b32 s55, 0x7f000000, s53
    s_add_u32 s52, s55, 0
    buffer_load_dwordx4 v[156:159], v13, s[28:31], s52 offen
    ds_read_b64 v[52:53], v142 offset:8128
    ds_read_b64 v[70:71], v142 offset:4640
    ds_read_b64 v[88:89], v142 offset:1152
    s_waitcnt lgkmcnt(15)
    v_pk_fma_f32 v[106:107], v[36:37], v[18:19], v[106:107]
    v_pk_fma_f32 v[108:109], v[54:55], v[18:19], v[108:109]
    v_pk_fma_f32 v[110:111], v[72:73], v[18:19], v[110:111]
    v_pk_fma_f32 v[112:113], v[90:91], v[18:19], v[112:113]
    ds_read_b64 v[36:37], v142 offset:11624
    ds_read_b64 v[54:55], v142 offset:8136
    ds_read_b64 v[72:73], v142 offset:4648
    ds_read_b64 v[90:91], v142 offset:1160
    s_waitcnt lgkmcnt(15)
    v_pk_fma_f32 v[106:107], v[38:39], v[20:21], v[106:107]
    v_pk_fma_f32 v[108:109], v[56:57], v[20:21], v[108:109]
    v_pk_fma_f32 v[110:111], v[74:75], v[20:21], v[110:111]
    v_pk_fma_f32 v[112:113], v[92:93], v[20:21], v[112:113]
    ds_read_b64 v[38:39], v142 offset:11632
    ds_read_b64 v[56:57], v142 offset:8144
    ds_read_b64 v[74:75], v142 offset:4656
    ds_read_b64 v[92:93], v142 offset:1168
    s_waitcnt lgkmcnt(15)
    v_pk_fma_f32 v[106:107], v[40:41], v[22:23], v[106:107]
    v_pk_fma_f32 v[108:109], v[58:59], v[22:23], v[108:109]
    v_pk_fma_f32 v[110:111], v[76:77], v[22:23], v[110:111]
    v_pk_fma_f32 v[112:113], v[94:95], v[22:23], v[112:113]
    ds_read_b64 v[40:41], v142 offset:11640
    ds_read_b64 v[58:59], v142 offset:8152
    ds_read_b64 v[76:77], v142 offset:4664
    ds_read_b64 v[94:95], v142 offset:1176
    s_waitcnt lgkmcnt(15)
    v_pk_fma_f32 v[106:107], v[42:43], v[24:25], v[106:107]
    s_add_u32 s52, s55, 18432
    buffer_load_dwordx4 v[160:163], v13, s[28:31], s52 offen
    v_pk_fma_f32 v[108:109], v[60:61], v[24:25], v[108:109]
    v_pk_fma_f32 v[110:111], v[78:79], v[24:25], v[110:111]
    v_pk_fma_f32 v[112:113], v[96:97], v[24:25], v[112:113]
    ds_read_b64 v[42:43], v142 offset:11648
    ds_read_b64 v[60:61], v142 offset:8160
    ds_read_b64 v[78:79], v142 offset:4672
    ds_read_b64 v[96:97], v142 offset:1184
    s_waitcnt lgkmcnt(15)
    v_pk_fma_f32 v[106:107], v[44:45], v[26:27], v[106:107]
    v_pk_fma_f32 v[108:109], v[62:63], v[26:27], v[108:109]
    v_pk_fma_f32 v[110:111], v[80:81], v[26:27], v[110:111]
    v_pk_fma_f32 v[112:113], v[98:99], v[26:27], v[112:113]
    ds_read_b64 v[44:45], v142 offset:11656
    ds_read_b64 v[62:63], v142 offset:8168
    ds_read_b64 v[80:81], v142 offset:4680
    ds_read_b64 v[98:99], v142 offset:1192
    s_waitcnt lgkmcnt(15)
    v_pk_fma_f32 v[106:107], v[46:47], v[28:29], v[106:107]
    v_pk_fma_f32 v[108:109], v[64:65], v[28:29], v[108:109]
    v_pk_fma_f32 v[110:111], v[82:83], v[28:29], v[110:111]
    v_pk_fma_f32 v[112:113], v[100:101], v[28:29], v[112:113]
    ds_read_b64 v[46:47], v142 offset:11664
    ds_read_b64 v[64:65], v142 offset:8176
    ds_read_b64 v[82:83], v142 offset:4688
    ds_read_b64 v[100:101], v142 offset:1200
    s_waitcnt lgkmcnt(15)
    v_pk_fma_f32 v[106:107], v[48:49], v[30:31], v[106:107]
    v_pk_fma_f32 v[108:109], v[66:67], v[30:31], v[108:109]
    v_pk_fma_f32 v[110:111], v[84:85], v[30:31], v[110:111]
    v_pk_fma_f32 v[112:113], v[102:103], v[30:31], v[112:113]
    ds_read_b64 v[48:49], v142 offset:11672
    ds_read_b64 v[66:67], v142 offset:8184
    s_add_u32 s52, s55, 36864
    buffer_load_dwordx4 v[164:167], v13, s[28:31], s52 offen
    ds_read_b64 v[84:85], v142 offset:4696
    ds_read_b64 v[102:103], v142 offset:1208
    s_waitcnt lgkmcnt(15)
    v_pk_fma_f32 v[106:107], v[50:51], v[32:33], v[106:107]
    v_pk_fma_f32 v[108:109], v[68:69], v[32:33], v[108:109]
    v_pk_fma_f32 v[110:111], v[86:87], v[32:33], v[110:111]
    v_pk_fma_f32 v[112:113], v[104:105], v[32:33], v[112:113]
    ds_read_b64 v[50:51], v142 offset:11680
    ds_read_b64 v[68:69], v142 offset:8192
    ds_read_b64 v[86:87], v142 offset:4704
    ds_read_b64 v[104:105], v142 offset:1216
    v_add_f32 v106, v106, v107
    v_add_f32 v108, v108, v109
    v_add_f32 v110, v110, v111
    v_add_f32 v112, v112, v113
    s_cmp_lg_u32 s37, 0
    s_cbranch_scc1 P12_NOMASK_20
    v_mov_b32 v1, 0xce6e6b28
    v_lshlrev_b32 v3, 3, v2
    v_add_u32 v4, 0, v3
    v_cmp_le_u32 vcc, v4, v140
    s_nop 1
    v_cndmask_b32 v106, v1, v106, vcc
    v_add_u32 v4, 2, v3
    v_cmp_le_u32 vcc, v4, v140
    s_nop 1
    v_cndmask_b32 v108, v1, v108, vcc
    v_add_u32 v4, 4, v3
    v_cmp_le_u32 vcc, v4, v140
    s_nop 1
    v_cndmask_b32 v110, v1, v110, vcc
    v_add_u32 v4, 6, v3
    v_cmp_le_u32 vcc, v4, v140
    s_nop 1
    v_cndmask_b32 v112, v1, v112, vcc
P12_NOMASK_20:
    s_mov_b32 s45, 0x3eae1a93
    v_max3_f32 v1, v106, v108, v110
    v_max_f32 v1, v1, v112
    s_nop 1
    v_max_f32_dpp v1, v1, v1 quad_perm:[1,0,3,2] row_mask:0xf bank_mask:0xf
    v_mul_f32 v1, s45, v1
    v_fma_f32 v106, v106, s45, -v1
    v_fma_f32 v108, v108, s45, -v1
    v_fma_f32 v110, v110, s45, -v1
    v_fma_f32 v112, v112, s45, -v1
    v_exp_f32 v106, v106
    v_exp_f32 v108, v108
    v_exp_f32 v110, v110
    v_exp_f32 v112, v112
    s_nop 0
    v_add_f32 v1, v106, v108
    v_add_f32 v3, v110, v112
    s_add_u32 s52, s55, 55296
    buffer_load_dwordx4 v[168:171], v13, s[28:31], s52 offen
    v_add_f32 v1, v1, v3
    s_nop 1
    v_add_f32_dpp v1, v1, v1 quad_perm:[1,0,3,2] row_mask:0xf bank_mask:0xf
    v_rcp_f32 v1, v1
    s_nop 0
    v_mul_f32 v132, v106, v1
    v_mul_f32 v134, v108, v1
    v_mul_f32 v136, v110, v1
    v_mul_f32 v138, v112, v1
    s_waitcnt lgkmcnt(0)
    v_pk_mul_f32 v[114:115], v[34:35], v[132:133] op_sel_hi:[1,0]
    v_pk_mul_f32 v[116:117], v[36:37], v[132:133] op_sel_hi:[1,0]
    v_pk_mul_f32 v[118:119], v[38:39], v[132:133] op_sel_hi:[1,0]
    v_pk_mul_f32 v[120:121], v[40:41], v[132:133] op_sel_hi:[1,0]
    v_pk_mul_f32 v[122:123], v[42:43], v[132:133] op_sel_hi:[1,0]
    v_pk_mul_f32 v[124:125], v[44:45], v[132:133] op_sel_hi:[1,0]
    v_pk_mul_f32 v[126:127], v[46:47], v[132:133] op_sel_hi:[1,0]
    v_pk_mul_f32 v[128:129], v[48:49], v[132:133] op_sel_hi:[1,0]
    v_pk_mul_f32 v[130:131], v[50:51], v[132:133] op_sel_hi:[1,0]
    v_pk_fma_f32 v[114:115], v[52:53], v[134:135], v[114:115] op_sel_hi:[1,0,1]
    v_pk_fma_f32 v[116:117], v[54:55], v[134:135], v[116:117] op_sel_hi:[1,0,1]
    v_pk_fma_f32 v[118:119], v[56:57], v[134:135], v[118:119] op_sel_hi:[1,0,1]
    v_pk_fma_f32 v[120:121], v[58:59], v[134:135], v[120:121] op_sel_hi:[1,0,1]
    v_pk_fma_f32 v[122:123], v[60:61], v[134:135], v[122:123] op_sel_hi:[1,0,1]
    v_pk_fma_f32 v[124:125], v[62:63], v[134:135], v[124:125] op_sel_hi:[1,0,1]
    v_pk_fma_f32 v[126:127], v[64:65], v[134:135], v[126:127] op_sel_hi:[1,0,1]
    v_pk_fma_f32 v[128:129], v[66:67], v[134:135], v[128:129] op_sel_hi:[1,0,1]
    v_pk_fma_f32 v[130:131], v[68:69], v[134:135], v[130:131] op_sel_hi:[1,0,1]
    v_pk_fma_f32 v[114:115], v[70:71], v[136:137], v[114:115] op_sel_hi:[1,0,1]
    v_pk_fma_f32 v[116:117], v[72:73], v[136:137], v[116:117] op_sel_hi:[1,0,1]
    v_pk_fma_f32 v[118:119], v[74:75], v[136:137], v[118:119] op_sel_hi:[1,0,1]
    v_pk_fma_f32 v[120:121], v[76:77], v[136:137], v[120:121] op_sel_hi:[1,0,1]
    s_add_u32 s52, s55, 73728
    buffer_load_dwordx4 v[172:175], v13, s[28:31], s52 offen
    v_pk_fma_f32 v[122:123], v[78:79], v[136:137], v[122:123] op_sel_hi:[1,0,1]
    v_pk_fma_f32 v[124:125], v[80:81], v[136:137], v[124:125] op_sel_hi:[1,0,1]
    v_pk_fma_f32 v[126:127], v[82:83], v[136:137], v[126:127] op_sel_hi:[1,0,1]
    v_pk_fma_f32 v[128:129], v[84:85], v[136:137], v[128:129] op_sel_hi:[1,0,1]
    v_pk_fma_f32 v[130:131], v[86:87], v[136:137], v[130:131] op_sel_hi:[1,0,1]
    v_pk_fma_f32 v[114:115], v[88:89], v[138:139], v[114:115] op_sel_hi:[1,0,1]
    v_pk_fma_f32 v[116:117], v[90:91], v[138:139], v[116:117] op_sel_hi:[1,0,1]
    v_pk_fma_f32 v[118:119], v[92:93], v[138:139], v[118:119] op_sel_hi:[1,0,1]
    v_pk_fma_f32 v[120:121], v[94:95], v[138:139], v[120:121] op_sel_hi:[1,0,1]
    v_pk_fma_f32 v[122:123], v[96:97], v[138:139], v[122:123] op_sel_hi:[1,0,1]
    v_pk_fma_f32 v[124:125], v[98:99], v[138:139], v[124:125] op_sel_hi:[1,0,1]
    v_pk_fma_f32 v[126:127], v[100:101], v[138:139], v[126:127] op_sel_hi:[1,0,1]
    v_pk_fma_f32 v[128:129], v[102:103], v[138:139], v[128:129] op_sel_hi:[1,0,1]
    v_pk_fma_f32 v[130:131], v[104:105], v[138:139], v[130:131] op_sel_hi:[1,0,1]
    s_nop 1
    v_add_f32_dpp v114, v114, v114 quad_perm:[1,0,3,2] row_mask:0xf bank_mask:0xf
    v_add_f32_dpp v115, v115, v115 quad_perm:[1,0,3,2] row_mask:0xf bank_mask:0xf
    v_add_f32_dpp v116, v116, v116 quad_perm:[1,0,3,2] row_mask:0xf bank_mask:0xf
    v_add_f32_dpp v117, v117, v117 quad_perm:[1,0,3,2] row_mask:0xf bank_mask:0xf
    v_add_f32_dpp v118, v118, v118 quad_perm:[1,0,3,2] row_mask:0xf bank_mask:0xf
    v_add_f32_dpp v119, v119, v119 quad_perm:[1,0,3,2] row_mask:0xf bank_mask:0xf
    v_add_f32_dpp v120, v120, v120 quad_perm:[1,0,3,2] row_mask:0xf bank_mask:0xf
    v_add_f32_dpp v121, v121, v121 quad_perm:[1,0,3,2] row_mask:0xf bank_mask:0xf
    v_add_f32_dpp v122, v122, v122 quad_perm:[1,0,3,2] row_mask:0xf bank_mask:0xf
    v_add_f32_dpp v123, v123, v123 quad_perm:[1,0,3,2] row_mask:0xf bank_mask:0xf
    v_add_f32_dpp v124, v124, v124 quad_perm:[1,0,3,2] row_mask:0xf bank_mask:0xf
    v_add_f32_dpp v125, v125, v125 quad_perm:[1,0,3,2] row_mask:0xf bank_mask:0xf
    v_add_f32_dpp v126, v126, v126 quad_perm:[1,0,3,2] row_mask:0xf bank_mask:0xf
    v_add_f32_dpp v127, v127, v127 quad_perm:[1,0,3,2] row_mask:0xf bank_mask:0xf
    v_add_f32_dpp v128, v128, v128 quad_perm:[1,0,3,2] row_mask:0xf bank_mask:0xf
    v_add_f32_dpp v129, v129, v129 quad_perm:[1,0,3,2] row_mask:0xf bank_mask:0xf
    v_add_f32_dpp v130, v130, v130 quad_perm:[1,0,3,2] row_mask:0xf bank_mask:0xf
    s_add_u32 s55, s54, 1
    s_cmp_ge_u32 s55, 18
    s_cselect_b32 s55, 0x7f000000, s53
    s_add_u32 s52, s55, 1024
    buffer_load_dwordx4 v[176:179], v13, s[28:31], s52 offen
    v_add_f32_dpp v131, v131, v131 quad_perm:[1,0,3,2] row_mask:0xf bank_mask:0xf
    v_mul_u32_u24 v3, 304, v140
    v_bfe_u32 v1, v0, 1, 3
    v_mul_u32_u24 v1, 36, v1
    v_add3_u32 v1, v1, v3, v14
    v_cvt_pk_bf16_f32 v114, v114, v115
    ds_write_b32 v1, v114 offset:0
    v_cvt_pk_bf16_f32 v116, v116, v117
    ds_write_b32 v1, v116 offset:4
    v_cvt_pk_bf16_f32 v118, v118, v119
    ds_write_b32 v1, v118 offset:8
    v_cvt_pk_bf16_f32 v120, v120, v121
    ds_write_b32 v1, v120 offset:12
    v_cvt_pk_bf16_f32 v122, v122, v123
    ds_write_b32 v1, v122 offset:16
    v_cvt_pk_bf16_f32 v124, v124, v125
    ds_write_b32 v1, v124 offset:20
    v_cvt_pk_bf16_f32 v126, v126, v127
    ds_write_b32 v1, v126 offset:24
    v_cvt_pk_bf16_f32 v128, v128, v129
    ds_write_b32 v1, v128 offset:28
    v_cvt_pk_bf16_f32 v130, v130, v131
    ds_write_b32 v1, v130 offset:32
    s_lshl_b32 s45, s24, 6
    v_add_u32 v1, s45, v0
    s_mul_i32 s46, s36, 18
    s_mul_i32 s47, s37, 36864
    s_add_u32 s47, s47, 5242880
    s_waitcnt lgkmcnt(0)
    s_barrier
    v_and_b32 v2, 31, v1
    v_lshrrev_b32 v3, 5, v1
    v_mul_u32_u24 v4, 304, v2
    v_lshl_add_u32 v4, v3, 4, v4
    v_add_u32 v4, v4, v14
    ds_read_b128 v[16:19], v4
    v_add_u32 v3, s46, v3
    v_lshrrev_b32 v4, 4, v2
    v_mul_u32_u24 v4, 1152, v4
    v_lshl_add_u32 v4, v3, 4, v4
    v_and_b32 v2, 15, v2
    v_add_u32 v4, v4, v2
    v_lshlrev_b32 v4, 4, v4
    s_waitcnt lgkmcnt(0)
    v_min_u32 v16, -2, v16
    buffer_store_dwordx4 v[16:19], v4, s[28:31], s47 offen sc1
    s_cmp_lg_u32 s24, 0
    s_cbranch_scc1 P12_PUB_21
    v_add_u32 v1, 512, v0
    v_and_b32 v2, 31, v1
    v_lshrrev_b32 v3, 5, v1
    v_mul_u32_u24 v4, 304, v2
    v_lshl_add_u32 v4, v3, 4, v4
    v_add_u32 v4, v4, v14
    ds_read_b128 v[16:19], v4
    v_add_u32 v3, s46, v3
    v_lshrrev_b32 v4, 4, v2
    v_mul_u32_u24 v4, 1152, v4
    v_lshl_add_u32 v4, v3, 4, v4
    v_and_b32 v2, 15, v2
    v_add_u32 v4, v4, v2
    v_lshlrev_b32 v4, 4, v4
    s_waitcnt lgkmcnt(0)
    v_min_u32 v16, -2, v16
    buffer_store_dwordx4 v[16:19], v4, s[28:31], s47 offen sc1
P12_PUB_21:
    s_add_u32 s52, s55, 19456
    buffer_load_dwordx4 v[180:183], v13, s[28:31], s52 offen
    s_add_u32 s52, s55, 37888
    buffer_load_dwordx4 v[184:187], v13, s[28:31], s52 offen
    s_add_u32 s52, s55, 56320
    buffer_load_dwordx4 v[188:191], v13, s[28:31], s52 offen
    s_add_u32 s52, s55, 74752
    buffer_load_dwordx4 v[192:195], v13, s[28:31], s52 offen
    s_add_u32 s55, s54, 2
    s_cmp_ge_u32 s55, 18
    s_cselect_b32 s55, 0x7f000000, s53
    s_add_u32 s52, s55, 2048
    buffer_load_dwordx4 v[196:199], v13, s[28:31], s52 offen
    s_add_u32 s52, s55, 20480
    buffer_load_dwordx4 v[200:203], v13, s[28:31], s52 offen
    s_add_u32 s52, s55, 38912
    buffer_load_dwordx4 v[204:207], v13, s[28:31], s52 offen
    s_add_u32 s52, s55, 57344
    buffer_load_dwordx4 v[208:211], v13, s[28:31], s52 offen
    s_add_u32 s52, s55, 75776
    buffer_load_dwordx4 v[212:215], v13, s[28:31], s52 offen
    s_add_u32 s55, s54, 3
    s_cmp_ge_u32 s55, 18
    s_cselect_b32 s55, 0x7f000000, s53
    s_add_u32 s52, s55, 3072
    buffer_load_dwordx4 v[216:219], v13, s[28:31], s52 offen
    s_add_u32 s52, s55, 21504
    buffer_load_dwordx4 v[220:223], v13, s[28:31], s52 offen
    s_add_u32 s52, s55, 39936
    buffer_load_dwordx4 v[224:227], v13, s[28:31], s52 offen
    s_add_u32 s52, s55, 58368
    buffer_load_dwordx4 v[228:231], v13, s[28:31], s52 offen
    s_add_u32 s52, s55, 76800
    buffer_load_dwordx4 v[232:235], v13, s[28:31], s52 offen
    s_add_u32 s55, s54, 4
    s_cmp_ge_u32 s55, 18
    s_cselect_b32 s55, 0x7f000000, s53
    s_add_u32 s52, s55, 4096
    buffer_load_dwordx4 v[236:239], v13, s[28:31], s52 offen
    s_add_u32 s52, s55, 22528
    buffer_load_dwordx4 v[240:243], v13, s[28:31], s52 offen
    s_add_u32 s52, s55, 40960
    buffer_load_dwordx4 v[244:247], v13, s[28:31], s52 offen
    s_add_u32 s52, s55, 59392
    buffer_load_dwordx4 v[248:251], v13, s[28:31], s52 offen
    s_add_u32 s52, s55, 77824
    buffer_load_dwordx4 v[252:255], v13, s[28:31], s52 offen
    s_barrier
    s_and_b32 s36, s2, 3
    s_bfe_u32 s37, s2, 0x10002
    s_lshl_b32 s37, s37, 5
    s_lshr_b32 s38, s2, 3
    s_add_u32 s37, s37, s38
    s_lshr_b32 s39, s24, 1
    s_and_b32 s40, s24, 1
    v_lshlrev_b32 v9, 4, v0
    v_and_b32 v132, 31, v0
    v_lshrrev_b32 v134, 5, v0
    s_lshl_b32 s41, s24, 1
    v_add_u32 v134, s41, v134
    s_lshl_b32 s41, s37, 5
    v_add_u32 v1, s41, v134
    v_mul_u32_u24 v133, 1152, v1
    s_mul_i32 s42, s36, 288
    v_lshl_add_u32 v133, v132, 4, v133
    v_add_u32 v133, s42, v133
    v_cmp_gt_u32 vcc, 18, v132
    v_mov_b32 v2, 0x7f000000
    s_nop 0
    v_cndmask_b32 v133, v2, v133, vcc
    s_mov_b64 s[50:51], vcc
    s_mov_b32 s43, 18432
    buffer_load_dwordx4 v[92:95], v133, s[4:7], 0 offen
    buffer_load_dwordx4 v[96:99], v133, s[4:7], s43 offen
    v_lshlrev_b32 v2, 5, v132
    s_mul_i32 s44, s36, 576
    s_add_u32 s44, s44, 20992
    buffer_load_dwordx4 v[100:103], v2, s[28:31], s44 offen sc1
    buffer_load_dwordx4 v[104:107], v2, s[28:31], s44 offen offset:16 sc1
    v_lshlrev_b32 v2, 4, v132
    s_add_u32 s44, s42, 45568
    buffer_load_dwordx4 v[108:111], v2, s[28:31], s44 offen sc1
    s_add_u32 s44, s42, 44416
    buffer_load_dwordx4 v[112:115], v2, s[28:31], s44 offen sc1
    v_add_u32 v1, 0, v0
    v_mul_u32_u24 v2, 3641, v1
    v_lshrrev_b32 v2, 16, v2
    v_mul_u32_u24 v150, 18, v2
    v_sub_u32 v1, v1, v150
    v_mul_u32_u24 v150, 9216, v2
    v_lshl_add_u32 v150, v1, 4, v150
    v_add_u32 v1, 64, v0
    v_mul_u32_u24 v2, 3641, v1
    v_lshrrev_b32 v2, 16, v2
    v_mul_u32_u24 v151, 18, v2
    v_sub_u32 v1, v1, v151
    v_mul_u32_u24 v151, 9216, v2
    v_lshl_add_u32 v151, v1, 4, v151
    v_add_u32 v1, 128, v0
    v_mul_u32_u24 v2, 3641, v1
    v_lshrrev_b32 v2, 16, v2
    v_mul_u32_u24 v152, 18, v2
    v_sub_u32 v1, v1, v152
    v_mul_u32_u24 v152, 9216, v2
    v_lshl_add_u32 v152, v1, 4, v152
    v_add_u32 v1, 192, v0
    v_mul_u32_u24 v2, 3641, v1
    v_lshrrev_b32 v2, 16, v2
    v_mul_u32_u24 v153, 18, v2
    v_sub_u32 v1, v1, v153
    v_mul_u32_u24 v153, 9216, v2
    v_lshl_add_u32 v153, v1, 4, v153
    v_add_u32 v1, 256, v0
    v_mul_u32_u24 v2, 3641, v1
    v_lshrrev_b32 v2, 16, v2
    v_mul_u32_u24 v154, 18, v2
    v_sub_u32 v1, v1, v154
    v_mul_u32_u24 v154, 9216, v2
    v_lshl_add_u32 v154, v1, 4, v154
    s_and_b32 s79, s24, 3
    s_lshr_b32 s76, s24, 2
    s_mul_i32 s76, s76, 18560
    s_mul_i32 s77, s79, 4608
    s_add_u32 s76, s76, s77
    s_mul_i32 s77, s79, 147456
    s_and_b32 s79, s2, 31
    s_mul_i32 s78, s79, 288
    s_add_u32 s77, s77, s78
    s_lshr_b32 s78, s79, 3
    s_lshl_b32 s78, s78, 1
    s_lshr_b32 s79, s2, 5
    s_add_u32 s78, s78, s79
    s_cmp_ge_u32 s78, 9
    s_cselect_b32 s79, 9, 0
    s_sub_u32 s78, s78, s79
    s_lshr_b32 s78, s2, 5
    s_mov_b32 s3, s78
    s_mul_i32 s46, s37, 36864
    s_add_u32 s46, s46, 5242880
    s_mul_i32 s47, s39, 5
    s_mov_b32 s56, 0
PL_22:
    s_add_u32 s48, s47, 0
    s_min_u32 s48, s48, 17
    s_lshl_b32 s48, s48, 10
    s_add_u32 s48, s48, s46
    s_add_u32 s49, s48, 18432
    buffer_load_dwordx4 v[12:15], v9, s[28:31], s48 offen sc1
    buffer_load_dwordx4 v[16:19], v9, s[28:31], s49 offen sc1
    s_add_u32 s48, s47, 1
    s_min_u32 s48, s48, 17
    s_lshl_b32 s48, s48, 10
    s_add_u32 s48, s48, s46
    s_add_u32 s49, s48, 18432
    buffer_load_dwordx4 v[20:23], v9, s[28:31], s48 offen sc1
    buffer_load_dwordx4 v[24:27], v9, s[28:31], s49 offen sc1
    s_add_u32 s48, s47, 2
    s_min_u32 s48, s48, 17
    s_lshl_b32 s48, s48, 10
    s_add_u32 s48, s48, s46
    s_add_u32 s49, s48, 18432
    buffer_load_dwordx4 v[28:31], v9, s[28:31], s48 offen sc1
    buffer_load_dwordx4 v[32:35], v9, s[28:31], s49 offen sc1
    s_add_u32 s48, s47, 3
    s_min_u32 s48, s48, 17
    s_lshl_b32 s48, s48, 10
    s_add_u32 s48, s48, s46
    s_add_u32 s49, s48, 18432
    buffer_load_dwordx4 v[36:39], v9, s[28:31], s48 offen sc1
    buffer_load_dwordx4 v[40:43], v9, s[28:31], s49 offen sc1
    s_add_u32 s48, s47, 4
    s_min_u32 s48, s48, 17
    s_lshl_b32 s48, s48, 10
    s_add_u32 s48, s48, s46
    s_add_u32 s49, s48, 18432
    buffer_load_dwordx4 v[44:47], v9, s[28:31], s48 offen sc1
    buffer_load_dwordx4 v[48:51], v9, s[28:31], s49 offen sc1
    s_waitcnt vmcnt(0)
    v_max3_u32 v1, v12, v16, v20
    v_max3_u32 v1, v1, v24, v28
    v_max3_u32 v1, v1, v32, v36
    v_max3_u32 v1, v1, v40, v44
    v_max_u32 v1, v1, v48
    v_cmp_eq_u32 vcc, -1, v1
    s_add_u32 s56, s56, 1
    s_nop 0
    s_cbranch_vccz PLD_23
    s_cmp_gt_u32 s56, 0x400000
    s_cbranch_scc1 PLD_23
    s_sleep 1
    s_branch PL_22
PLD_23:
    v_and_b32 v1, 15, v0
    v_mul_u32_u24 v1, 656, v1
    v_lshrrev_b32 v2, 4, v0
    v_lshl_add_u32 v1, v2, 4, v1
    s_mul_i32 s48, s39, 20992
    s_mul_i32 s49, s40, 320
    s_add_u32 s48, s48, s49
    s_add_u32 s48, s48, 73984
    v_add_u32 v1, s48, v1
    v_mul_u32_u24 v135, 656, v134
    v_min_u32 v2, 17, v132
    v_lshl_add_u32 v135, v2, 5, v135
    v_add_u32 v135, 73984, v135
    v_add_u32 v136, 10496, v135
    v_mfma_f32_16x16x32_bf16 v[52:55], v[156:159], v[12:15], 0
    v_mfma_f32_16x16x32_bf16 v[72:75], v[156:159], v[16:19], 0
    v_mfma_f32_16x16x32_bf16 v[56:59], v[160:163], v[12:15], 0
    v_mfma_f32_16x16x32_bf16 v[76:79], v[160:163], v[16:19], 0
    s_mul_i32 s79, s78, 589824
    s_add_u32 s79, s79, s77
    s_add_u32 s78, s78, 1
    s_cmp_ge_u32 s78, 9
    s_cselect_b32 s78, 0, s78
    s_add_u32 m0, s76, 0
    s_nop 0
    buffer_load_dwordx4 v150, s[12:15], s79 offen lds
    v_mfma_f32_16x16x32_bf16 v[60:63], v[164:167], v[12:15], 0
    v_mfma_f32_16x16x32_bf16 v[80:83], v[164:167], v[16:19], 0
    v_mfma_f32_16x16x32_bf16 v[64:67], v[168:171], v[12:15], 0
    v_mfma_f32_16x16x32_bf16 v[84:87], v[168:171], v[16:19], 0
    s_add_u32 m0, s76, 1024
    s_nop 0
    buffer_load_dwordx4 v151, s[12:15], s79 offen lds
    v_mfma_f32_16x16x32_bf16 v[68:71], v[172:175], v[12:15], 0
    v_mfma_f32_16x16x32_bf16 v[88:91], v[172:175], v[16:19], 0
    v_mfma_f32_16x16x32_bf16 v[52:55], v[176:179], v[20:23], v[52:55]
    v_mfma_f32_16x16x32_bf16 v[72:75], v[176:179], v[24:27], v[72:75]
    v_mfma_f32_16x16x32_bf16 v[56:59], v[180:183], v[20:23], v[56:59]
    v_mfma_f32_16x16x32_bf16 v[76:79], v[180:183], v[24:27], v[76:79]
    s_add_u32 m0, s76, 2048
    s_nop 0
    buffer_load_dwordx4 v152, s[12:15], s79 offen lds
    v_mfma_f32_16x16x32_bf16 v[60:63], v[184:187], v[20:23], v[60:63]
    v_mfma_f32_16x16x32_bf16 v[80:83], v[184:187], v[24:27], v[80:83]
    v_mfma_f32_16x16x32_bf16 v[64:67], v[188:191], v[20:23], v[64:67]
    v_mfma_f32_16x16x32_bf16 v[84:87], v[188:191], v[24:27], v[84:87]
    s_add_u32 m0, s76, 3072
    s_nop 0
    buffer_load_dwordx4 v153, s[12:15], s79 offen lds
    v_mfma_f32_16x16x32_bf16 v[68:71], v[192:195], v[20:23], v[68:71]
    v_mfma_f32_16x16x32_bf16 v[88:91], v[192:195], v[24:27], v[88:91]
    v_mfma_f32_16x16x32_bf16 v[52:55], v[196:199], v[28:31], v[52:55]
    v_mfma_f32_16x16x32_bf16 v[72:75], v[196:199], v[32:35], v[72:75]
    v_mfma_f32_16x16x32_bf16 v[56:59], v[200:203], v[28:31], v[56:59]
    v_mfma_f32_16x16x32_bf16 v[76:79], v[200:203], v[32:35], v[76:79]
    s_add_u32 m0, s76, 4096
    s_mov_b64 exec, 0xffffffff
    buffer_load_dwordx4 v154, s[12:15], s79 offen lds
    s_mov_b64 exec, -1
    v_mfma_f32_16x16x32_bf16 v[60:63], v[204:207], v[28:31], v[60:63]
    v_mfma_f32_16x16x32_bf16 v[80:83], v[204:207], v[32:35], v[80:83]
    v_mfma_f32_16x16x32_bf16 v[64:67], v[208:211], v[28:31], v[64:67]
    v_mfma_f32_16x16x32_bf16 v[84:87], v[208:211], v[32:35], v[84:87]
    s_mul_i32 s79, s78, 589824
    s_add_u32 s79, s79, s77
    s_add_u32 s78, s78, 1
    s_cmp_ge_u32 s78, 9
    s_cselect_b32 s78, 0, s78
    s_add_u32 m0, s76, 36992
    s_nop 0
    buffer_load_dwordx4 v150, s[12:15], s79 offen lds
    v_mfma_f32_16x16x32_bf16 v[68:71], v[212:215], v[28:31], v[68:71]
    v_mfma_f32_16x16x32_bf16 v[88:91], v[212:215], v[32:35], v[88:91]
    v_mfma_f32_16x16x32_bf16 v[52:55], v[216:219], v[36:39], v[52:55]
    v_mfma_f32_16x16x32_bf16 v[72:75], v[216:219], v[40:43], v[72:75]
    v_mfma_f32_16x16x32_bf16 v[56:59], v[220:223], v[36:39], v[56:59]
    v_mfma_f32_16x16x32_bf16 v[76:79], v[220:223], v[40:43], v[76:79]
    s_add_u32 m0, s76, 38016
    s_nop 0
    buffer_load_dwordx4 v151, s[12:15], s79 offen lds
    v_mfma_f32_16x16x32_bf16 v[60:63], v[224:227], v[36:39], v[60:63]
    v_mfma_f32_16x16x32_bf16 v[80:83], v[224:227], v[40:43], v[80:83]
    v_mfma_f32_16x16x32_bf16 v[64:67], v[228:231], v[36:39], v[64:67]
    v_mfma_f32_16x16x32_bf16 v[84:87], v[228:231], v[40:43], v[84:87]
    s_add_u32 m0, s76, 39040
    s_nop 0
    buffer_load_dwordx4 v152, s[12:15], s79 offen lds
    v_mfma_f32_16x16x32_bf16 v[68:71], v[232:235], v[36:39], v[68:71]
    v_mfma_f32_16x16x32_bf16 v[88:91], v[232:235], v[40:43], v[88:91]
    v_mfma_f32_16x16x32_bf16 v[52:55], v[236:239], v[44:47], v[52:55]
    v_mfma_f32_16x16x32_bf16 v[72:75], v[236:239], v[48:51], v[72:75]
    v_mfma_f32_16x16x32_bf16 v[56:59], v[240:243], v[44:47], v[56:59]
    v_mfma_f32_16x16x32_bf16 v[76:79], v[240:243], v[48:51], v[76:79]
    s_add_u32 m0, s76, 40064
    s_nop 0
    buffer_load_dwordx4 v153, s[12:15], s79 offen lds
    v_mfma_f32_16x16x32_bf16 v[60:63], v[244:247], v[44:47], v[60:63]
    v_mfma_f32_16x16x32_bf16 v[80:83], v[244:247], v[48:51], v[80:83]
    v_mfma_f32_16x16x32_bf16 v[64:67], v[248:251], v[44:47], v[64:67]
    v_mfma_f32_16x16x32_bf16 v[84:87], v[248:251], v[48:51], v[84:87]
    s_add_u32 m0, s76, 41088
    s_mov_b64 exec, 0xffffffff
    buffer_load_dwordx4 v154, s[12:15], s79 offen lds
    s_mov_b64 exec, -1
    v_mfma_f32_16x16x32_bf16 v[68:71], v[252:255], v[44:47], v[68:71]
    v_mfma_f32_16x16x32_bf16 v[88:91], v[252:255], v[48:51], v[88:91]
    s_nop 7
    ds_write_b128 v1, v[52:55] offset:0
    ds_write_b128 v1, v[56:59] offset:64
    ds_write_b128 v1, v[60:63] offset:128
    ds_write_b128 v1, v[64:67] offset:192
    ds_write_b128 v1, v[68:71] offset:256
    ds_write_b128 v1, v[72:75] offset:10496
    ds_write_b128 v1, v[76:79] offset:10560
    ds_write_b128 v1, v[80:83] offset:10624
    ds_write_b128 v1, v[84:87] offset:10688
    ds_write_b128 v1, v[88:91] offset:10752
    s_waitcnt lgkmcnt(0)
    s_barrier
    s_mov_b32 s52, 8388608
    s_add_u32 s53, s52, 18432
    ds_read_b128 v[12:15], v135 offset:0
    ds_read_b128 v[16:19], v135 offset:16
    ds_read_b128 v[20:23], v135 offset:20992
    ds_read_b128 v[24:27], v135 offset:21008
    ds_read_b128 v[28:31], v135 offset:41984
    ds_read_b128 v[32:35], v135 offset:42000
    ds_read_b128 v[36:39], v135 offset:62976
    ds_read_b128 v[40:43], v135 offset:62992
    ds_read_b128 v[60:63], v136 offset:0
    ds_read_b128 v[64:67], v136 offset:16
    ds_read_b128 v[68:71], v136 offset:20992
    ds_read_b128 v[72:75], v136 offset:21008
    ds_read_b128 v[76:79], v136 offset:41984
    ds_read_b128 v[80:83], v136 offset:42000
    ds_read_b128 v[84:87], v136 offset:62976
    ds_read_b128 v[88:91], v136 offset:62992
    s_waitcnt lgkmcnt(8)
    v_add_f32 v12, v12, v20
    v_add_f32 v28, v28, v36
    v_add_f32 v12, v12, v28
    v_add_f32 v13, v13, v21
    v_add_f32 v29, v29, v37
    v_add_f32 v13, v13, v29
    v_add_f32 v14, v14, v22
    v_add_f32 v30, v30, v38
    v_add_f32 v14, v14, v30
    v_add_f32 v15, v15, v23
    v_add_f32 v31, v31, v39
    v_add_f32 v15, v15, v31
    v_add_f32 v16, v16, v24
    v_add_f32 v32, v32, v40
    v_add_f32 v16, v16, v32
    v_add_f32 v17, v17, v25
    v_add_f32 v33, v33, v41
    v_add_f32 v17, v17, v33
    v_add_f32 v18, v18, v26
    v_add_f32 v34, v34, v42
    v_add_f32 v18, v18, v34
    v_add_f32 v19, v19, v27
    v_add_f32 v35, v35, v43
    v_add_f32 v19, v19, v35
    v_lshlrev_b32 v2, 16, v92
    v_and_b32 v3, 0xffff0000, v92
    v_fmac_f32 v2, v100, v12
    v_fmac_f32 v3, v101, v13
    v_cvt_pk_bf16_f32 v92, v2, v3
    v_lshlrev_b32 v116, 16, v92
    v_and_b32 v117, 0xffff0000, v92
    v_lshlrev_b32 v2, 16, v93
    v_and_b32 v3, 0xffff0000, v93
    v_fmac_f32 v2, v102, v14
    v_fmac_f32 v3, v103, v15
    v_cvt_pk_bf16_f32 v93, v2, v3
    v_lshlrev_b32 v118, 16, v93
    v_and_b32 v119, 0xffff0000, v93
    v_lshlrev_b32 v2, 16, v94
    v_and_b32 v3, 0xffff0000, v94
    v_fmac_f32 v2, v104, v16
    v_fmac_f32 v3, v105, v17
    v_cvt_pk_bf16_f32 v94, v2, v3
    v_lshlrev_b32 v120, 16, v94
    v_and_b32 v121, 0xffff0000, v94
    v_lshlrev_b32 v2, 16, v95
    v_and_b32 v3, 0xffff0000, v95
    v_fmac_f32 v2, v106, v18
    v_fmac_f32 v3, v107, v19
    v_cvt_pk_bf16_f32 v95, v2, v3
    v_lshlrev_b32 v122, 16, v95
    v_and_b32 v123, 0xffff0000, v95
    buffer_store_dwordx4 v[92:95], v133, s[28:31], s52 offen sc1
    v_add_f32 v52, v116, v117
    v_add_f32 v52, v52, v118
    v_add_f32 v52, v52, v119
    v_add_f32 v52, v52, v120
    v_add_f32 v52, v52, v121
    v_add_f32 v52, v52, v122
    v_add_f32 v52, v52, v123
    v_cndmask_b32 v52, 0, v52, s[50:51]
    s_waitcnt lgkmcnt(0)
    v_add_f32 v60, v60, v68
    v_add_f32 v76, v76, v84
    v_add_f32 v60, v60, v76
    v_add_f32 v61, v61, v69
    v_add_f32 v77, v77, v85
    v_add_f32 v61, v61, v77
    v_add_f32 v62, v62, v70
    v_add_f32 v78, v78, v86
    v_add_f32 v62, v62, v78
    v_add_f32 v63, v63, v71
    v_add_f32 v79, v79, v87
    v_add_f32 v63, v63, v79
    v_add_f32 v64, v64, v72
    v_add_f32 v80, v80, v88
    v_add_f32 v64, v64, v80
    v_add_f32 v65, v65, v73
    v_add_f32 v81, v81, v89
    v_add_f32 v65, v65, v81
    v_add_f32 v66, v66, v74
    v_add_f32 v82, v82, v90
    v_add_f32 v66, v66, v82
    v_add_f32 v67, v67, v75
    v_add_f32 v83, v83, v91
    v_add_f32 v67, v67, v83
    v_lshlrev_b32 v2, 16, v96
    v_and_b32 v3, 0xffff0000, v96
    v_fmac_f32 v2, v100, v60
    v_fmac_f32 v3, v101, v61
    v_cvt_pk_bf16_f32 v96, v2, v3
    v_lshlrev_b32 v124, 16, v96
    v_and_b32 v125, 0xffff0000, v96
    v_lshlrev_b32 v2, 16, v97
    v_and_b32 v3, 0xffff0000, v97
    v_fmac_f32 v2, v102, v62
    v_fmac_f32 v3, v103, v63
    v_cvt_pk_bf16_f32 v97, v2, v3
    v_lshlrev_b32 v126, 16, v97
    v_and_b32 v127, 0xffff0000, v97
    v_lshlrev_b32 v2, 16, v98
    v_and_b32 v3, 0xffff0000, v98
    v_fmac_f32 v2, v104, v64
    v_fmac_f32 v3, v105, v65
    v_cvt_pk_bf16_f32 v98, v2, v3
    v_lshlrev_b32 v128, 16, v98
    v_and_b32 v129, 0xffff0000, v98
    v_lshlrev_b32 v2, 16, v99
    v_and_b32 v3, 0xffff0000, v99
    v_fmac_f32 v2, v106, v66
    v_fmac_f32 v3, v107, v67
    v_cvt_pk_bf16_f32 v99, v2, v3
    v_lshlrev_b32 v130, 16, v99
    v_and_b32 v131, 0xffff0000, v99
    buffer_store_dwordx4 v[96:99], v133, s[28:31], s53 offen sc1
    v_add_f32 v54, v124, v125
    v_add_f32 v54, v54, v126
    v_add_f32 v54, v54, v127
    v_add_f32 v54, v54, v128
    v_add_f32 v54, v54, v129
    v_add_f32 v54, v54, v130
    v_add_f32 v54, v54, v131
    v_cndmask_b32 v54, 0, v54, s[50:51]
    s_nop 0
    v_add_f32_dpp v52, v52, v52 quad_perm:[1,0,3,2] row_mask:0xf bank_mask:0xf
    v_add_f32_dpp v54, v54, v54 quad_perm:[1,0,3,2] row_mask:0xf bank_mask:0xf
    s_nop 0
    v_add_f32_dpp v52, v52, v52 quad_perm:[2,3,0,1] row_mask:0xf bank_mask:0xf
    v_add_f32_dpp v54, v54, v54 quad_perm:[2,3,0,1] row_mask:0xf bank_mask:0xf
    s_nop 0
    v_add_f32_dpp v52, v52, v52 row_half_mirror row_mask:0xf bank_mask:0xf
    v_add_f32_dpp v54, v54, v54 row_half_mirror row_mask:0xf bank_mask:0xf
    s_nop 0
    v_add_f32_dpp v52, v52, v52 row_mirror row_mask:0xf bank_mask:0xf
    v_add_f32_dpp v54, v54, v54 row_mirror row_mask:0xf bank_mask:0xf
    v_mov_b32 v2, v52
    v_mov_b32 v3, v54
    s_nop 1
    v_permlane16_swap_b32 v52, v2
    v_permlane16_swap_b32 v54, v3
    v_add_f32 v52, v52, v2
    v_add_f32 v54, v54, v3
    v_mul_f32 v3, 0x3be38e39, v52
    v_sub_f32 v2, v116, v3
    v_mul_f32 v53, v2, v2
    v_sub_f32 v2, v117, v3
    v_fmac_f32 v53, v2, v2
    v_sub_f32 v2, v118, v3
    v_fmac_f32 v53, v2, v2
    v_sub_f32 v2, v119, v3
    v_fmac_f32 v53, v2, v2
    v_sub_f32 v2, v120, v3
    v_fmac_f32 v53, v2, v2
    v_sub_f32 v2, v121, v3
    v_fmac_f32 v53, v2, v2
    v_sub_f32 v2, v122, v3
    v_fmac_f32 v53, v2, v2
    v_sub_f32 v2, v123, v3
    v_fmac_f32 v53, v2, v2
    v_cndmask_b32 v53, 0, v53, s[50:51]
    v_mul_f32 v3, 0x3be38e39, v54
    v_sub_f32 v2, v124, v3
    v_mul_f32 v55, v2, v2
    v_sub_f32 v2, v125, v3
    v_fmac_f32 v55, v2, v2
    v_sub_f32 v2, v126, v3
    v_fmac_f32 v55, v2, v2
    v_sub_f32 v2, v127, v3
    v_fmac_f32 v55, v2, v2
    v_sub_f32 v2, v128, v3
    v_fmac_f32 v55, v2, v2
    v_sub_f32 v2, v129, v3
    v_fmac_f32 v55, v2, v2
    v_sub_f32 v2, v130, v3
    v_fmac_f32 v55, v2, v2
    v_sub_f32 v2, v131, v3
    v_fmac_f32 v55, v2, v2
    v_cndmask_b32 v55, 0, v55, s[50:51]
    s_nop 0
    v_add_f32_dpp v53, v53, v53 quad_perm:[1,0,3,2] row_mask:0xf bank_mask:0xf
    v_add_f32_dpp v55, v55, v55 quad_perm:[1,0,3,2] row_mask:0xf bank_mask:0xf
    s_nop 0
    v_add_f32_dpp v53, v53, v53 quad_perm:[2,3,0,1] row_mask:0xf bank_mask:0xf
    v_add_f32_dpp v55, v55, v55 quad_perm:[2,3,0,1] row_mask:0xf bank_mask:0xf
    s_nop 0
    v_add_f32_dpp v53, v53, v53 row_half_mirror row_mask:0xf bank_mask:0xf
    v_add_f32_dpp v55, v55, v55 row_half_mirror row_mask:0xf bank_mask:0xf
    s_nop 0
    v_add_f32_dpp v53, v53, v53 row_mirror row_mask:0xf bank_mask:0xf
    v_add_f32_dpp v55, v55, v55 row_mirror row_mask:0xf bank_mask:0xf
    v_mov_b32 v2, v53
    v_mov_b32 v3, v55
    s_nop 1
    v_permlane16_swap_b32 v53, v2
    v_permlane16_swap_b32 v55, v3
    v_add_f32 v53, v53, v2
    v_add_f32 v55, v55, v3
    s_lshl_b32 s46, s37, 10
    s_add_u32 s46, s46, 65536
    s_lshl_b32 s47, s36, 8
    s_add_u32 s47, s47, s46
    v_lshlrev_b32 v1, 3, v134
    v_cmp_eq_u32 vcc, 0, v132
    v_mov_b32 v2, 0x7f000000
    s_nop 0
    v_cndmask_b32 v2, v2, v1, vcc
    v_min_u32 v52, -2, v52
    v_min_u32 v54, -2, v54
    buffer_store_dwordx2 v[52:53], v2, s[28:31], s47 offen sc1
    buffer_store_dwordx2 v[54:55], v2, s[28:31], s47 offen offset:128 sc1
    s_mul_i32 s47, s36, 18
    v_add_u32 v2, s47, v132
    v_lshrrev_b32 v3, 1, v2
    v_lshlrev_b32 v3, 6, v3
    v_and_b32 v2, 1, v2
    v_add_u32 v3, v3, v2
    v_lshl_add_u32 v3, v134, 1, v3
    v_lshlrev_b32 v3, 4, v3
    v_mov_b32 v2, 0x7f000000
    v_cndmask_b32 v3, v2, v3, s[50:51]
    s_mul_i32 s47, s37, 36864
    s_add_u32 s47, s47, 11534336
    v_lshlrev_b32 v28, 16, v108
    v_and_b32 v29, 0xffff0000, v108
    v_lshlrev_b32 v36, 16, v112
    v_and_b32 v37, 0xffff0000, v112
    v_lshlrev_b32 v30, 16, v109
    v_and_b32 v31, 0xffff0000, v109
    v_lshlrev_b32 v38, 16, v113
    v_and_b32 v39, 0xffff0000, v113
    v_lshlrev_b32 v32, 16, v110
    v_and_b32 v33, 0xffff0000, v110
    v_lshlrev_b32 v40, 16, v114
    v_and_b32 v41, 0xffff0000, v114
    v_lshlrev_b32 v34, 16, v111
    v_and_b32 v35, 0xffff0000, v111
    v_lshlrev_b32 v42, 16, v115
    v_and_b32 v43, 0xffff0000, v115
    s_mov_b32 s56, 0
PL_24:
    buffer_load_dwordx2 v[12:13], v1, s[28:31], s46 offen offset:0 sc1
    buffer_load_dwordx2 v[14:15], v1, s[28:31], s46 offen offset:256 sc1
    buffer_load_dwordx2 v[16:17], v1, s[28:31], s46 offen offset:512 sc1
    buffer_load_dwordx2 v[18:19], v1, s[28:31], s46 offen offset:768 sc1
    buffer_load_dwordx2 v[20:21], v1, s[28:31], s46 offen offset:128 sc1
    buffer_load_dwordx2 v[22:23], v1, s[28:31], s46 offen offset:384 sc1
    buffer_load_dwordx2 v[24:25], v1, s[28:31], s46 offen offset:640 sc1
    buffer_load_dwordx2 v[26:27], v1, s[28:31], s46 offen offset:896 sc1
    s_waitcnt vmcnt(0)
    v_max3_u32 v4, v12, v14, v16
    v_max3_u32 v4, v4, v18, v20
    v_max3_u32 v4, v4, v22, v24
    v_max_u32 v4, v4, v26
    v_cmp_eq_u32 vcc, -1, v4
    s_add_u32 s56, s56, 1
    s_nop 0
    s_cbranch_vccz PLD_25
    s_cmp_gt_u32 s56, 0x400000
    s_cbranch_scc1 PLD_25
    s_sleep 1
    s_branch PL_24
PLD_25:
    v_add_f32 v4, v12, v14
    v_add_f32 v6, v16, v18
    v_add_f32 v4, v4, v6
    v_mul_f32 v4, 0x3ae38e39, v4
    v_add_f32 v5, v13, v15
    v_add_f32 v6, v17, v19
    v_add_f32 v5, v5, v6
    v_mov_b32 v7, 0x43100000
    v_mul_f32 v6, 0x3be38e39, v12
    v_sub_f32 v6, v6, v4
    v_mul_f32 v6, v6, v6
    v_fmac_f32 v5, v6, v7
    v_mul_f32 v6, 0x3be38e39, v14
    v_sub_f32 v6, v6, v4
    v_mul_f32 v6, v6, v6
    v_fmac_f32 v5, v6, v7
    v_mul_f32 v6, 0x3be38e39, v16
    v_sub_f32 v6, v6, v4
    v_mul_f32 v6, v6, v6
    v_fmac_f32 v5, v6, v7
    v_mul_f32 v6, 0x3be38e39, v18
    v_sub_f32 v6, v6, v4
    v_mul_f32 v6, v6, v6
    v_fmac_f32 v5, v6, v7
    v_mul_f32 v5, 0x3ae38e39, v5
    v_cvt_pk_bf16_f32 v5, v5, v5
    v_lshlrev_b32 v5, 16, v5
    v_add_f32 v5, 0x3727c5ac, v5
    v_cvt_pk_bf16_f32 v5, v5, v5
    v_lshlrev_b32 v5, 16, v5
    v_sqrt_f32 v5, v5
    s_nop 0
    v_cvt_pk_bf16_f32 v5, v5, v5
    v_lshlrev_b32 v5, 16, v5
    v_rcp_f32 v5, v5
    v_cvt_pk_bf16_f32 v7, v4, v4
    v_lshlrev_b32 v7, 16, v7
    v_sub_f32 v6, v4, v7
    v_mul_f32 v6, v6, v5
    v_sub_f32 v116, v116, v4
    v_fma_f32 v116, v116, v5, v6
    v_fma_f32 v116, v116, v28, v36
    v_sub_f32 v117, v117, v4
    v_fma_f32 v117, v117, v5, v6
    v_fma_f32 v117, v117, v29, v37
    v_sub_f32 v118, v118, v4
    v_fma_f32 v118, v118, v5, v6
    v_fma_f32 v118, v118, v30, v38
    v_sub_f32 v119, v119, v4
    v_fma_f32 v119, v119, v5, v6
    v_fma_f32 v119, v119, v31, v39
    v_sub_f32 v120, v120, v4
    v_fma_f32 v120, v120, v5, v6
    v_fma_f32 v120, v120, v32, v40
    v_sub_f32 v121, v121, v4
    v_fma_f32 v121, v121, v5, v6
    v_fma_f32 v121, v121, v33, v41
    v_sub_f32 v122, v122, v4
    v_fma_f32 v122, v122, v5, v6
    v_fma_f32 v122, v122, v34, v42
    v_sub_f32 v123, v123, v4
    v_fma_f32 v123, v123, v5, v6
    v_fma_f32 v123, v123, v35, v43
    v_cvt_pk_bf16_f32 v92, v116, v117
    v_cvt_pk_bf16_f32 v93, v118, v119
    v_cvt_pk_bf16_f32 v94, v120, v121
    v_cvt_pk_bf16_f32 v95, v122, v123
    v_min_u32 v92, -2, v92
    buffer_store_dwordx4 v[92:95], v3, s[28:31], s47 offen offset:0 sc1
    v_add_f32 v4, v20, v22
    v_add_f32 v6, v24, v26
    v_add_f32 v4, v4, v6
    v_mul_f32 v4, 0x3ae38e39, v4
    v_add_f32 v5, v21, v23
    v_add_f32 v6, v25, v27
    v_add_f32 v5, v5, v6
    v_mov_b32 v7, 0x43100000
    v_mul_f32 v6, 0x3be38e39, v20
    v_sub_f32 v6, v6, v4
    v_mul_f32 v6, v6, v6
    v_fmac_f32 v5, v6, v7
    v_mul_f32 v6, 0x3be38e39, v22
    v_sub_f32 v6, v6, v4
    v_mul_f32 v6, v6, v6
    v_fmac_f32 v5, v6, v7
    v_mul_f32 v6, 0x3be38e39, v24
    v_sub_f32 v6, v6, v4
    v_mul_f32 v6, v6, v6
    v_fmac_f32 v5, v6, v7
    v_mul_f32 v6, 0x3be38e39, v26
    v_sub_f32 v6, v6, v4
    v_mul_f32 v6, v6, v6
    v_fmac_f32 v5, v6, v7
    v_mul_f32 v5, 0x3ae38e39, v5
    v_cvt_pk_bf16_f32 v5, v5, v5
    v_lshlrev_b32 v5, 16, v5
    v_add_f32 v5, 0x3727c5ac, v5
    v_cvt_pk_bf16_f32 v5, v5, v5
    v_lshlrev_b32 v5, 16, v5
    v_sqrt_f32 v5, v5
    s_nop 0
    v_cvt_pk_bf16_f32 v5, v5, v5
    v_lshlrev_b32 v5, 16, v5
    v_rcp_f32 v5, v5
    v_cvt_pk_bf16_f32 v7, v4, v4
    v_lshlrev_b32 v7, 16, v7
    v_sub_f32 v6, v4, v7
    v_mul_f32 v6, v6, v5
    v_sub_f32 v124, v124, v4
    v_fma_f32 v124, v124, v5, v6
    v_fma_f32 v124, v124, v28, v36
    v_sub_f32 v125, v125, v4
    v_fma_f32 v125, v125, v5, v6
    v_fma_f32 v125, v125, v29, v37
    v_sub_f32 v126, v126, v4
    v_fma_f32 v126, v126, v5, v6
    v_fma_f32 v126, v126, v30, v38
    v_sub_f32 v127, v127, v4
    v_fma_f32 v127, v127, v5, v6
    v_fma_f32 v127, v127, v31, v39
    v_sub_f32 v128, v128, v4
    v_fma_f32 v128, v128, v5, v6
    v_fma_f32 v128, v128, v32, v40
    v_sub_f32 v129, v129, v4
    v_fma_f32 v129, v129, v5, v6
    v_fma_f32 v129, v129, v33, v41
    v_sub_f32 v130, v130, v4
    v_fma_f32 v130, v130, v5, v6
    v_fma_f32 v130, v130, v34, v42
    v_sub_f32 v131, v131, v4
    v_fma_f32 v131, v131, v5, v6
    v_fma_f32 v131, v131, v35, v43
    v_cvt_pk_bf16_f32 v96, v124, v125
    v_cvt_pk_bf16_f32 v97, v126, v127
    v_cvt_pk_bf16_f32 v98, v128, v129
    v_cvt_pk_bf16_f32 v99, v130, v131
    v_min_u32 v96, -2, v96
    buffer_store_dwordx4 v[96:99], v3, s[28:31], s47 offen offset:512 sc1
    s_lshr_b32 s59, s37, 3
    s_lshl_b32 s59, s59, 6
    s_add_u32 s59, s59, 8192
    s_waitcnt vmcnt(0)
    s_barrier
    s_cmp_lg_u32 s24, 0
    s_cbranch_scc1 SIG_26
    v_mov_b32 v2, 1
    s_mov_b64 exec, 1
    buffer_atomic_add v2, off, s[28:31], s59 sc1
    s_mov_b64 exec, -1
SIG_26:
    s_and_b32 s36, s2, 31
    s_lshr_b32 s37, s2, 5
    s_and_b32 s38, s24, 3
    s_lshr_b32 s39, s24, 2
    v_mov_b32 v7, v150
    v_mov_b32 v8, v151
    v_mov_b32 v9, v152
    v_mov_b32 v10, v153
    v_mov_b32 v11, v154
    v_and_b32 v1, 31, v0
    v_lshrrev_b32 v2, 5, v0
    v_lshl_add_u32 v12, v1, 1, v2
    v_lshlrev_b32 v12, 4, v12
    s_lshl_b32 s43, s37, 3
    s_add_u32 s43, s43, s24
    s_mul_i32 s44, s43, 36864
    s_add_u32 s44, s44, 11534336
    s_mov_b32 s47, s3
    s_mul_i32 s79, s78, 589824
    s_add_u32 s79, s79, s77
    s_add_u32 s78, s78, 1
    s_cmp_ge_u32 s78, 9
    s_cselect_b32 s78, 0, s78
    s_add_u32 m0, s76, 73984
    s_nop 0
    buffer_load_dwordx4 v7, s[12:15], s79 offen lds
    s_add_u32 m0, s76, 75008
    s_nop 0
    buffer_load_dwordx4 v8, s[12:15], s79 offen lds
    s_add_u32 m0, s76, 76032
    s_nop 0
    buffer_load_dwordx4 v9, s[12:15], s79 offen lds
    s_add_u32 m0, s76, 77056
    s_nop 0
    buffer_load_dwordx4 v10, s[12:15], s79 offen lds
    s_add_u32 m0, s76, 78080
    s_mov_b64 exec, 0xffffffff
    buffer_load_dwordx4 v11, s[12:15], s79 offen lds
    s_mov_b64 exec, -1
    s_bfe_u32 s56, s2, 0x30003
    s_lshl_b32 s56, s56, 3
    s_add_u32 s56, s56, s24
    s_mul_i32 s56, s56, 54
    v_add_u32 v252, s56, v0
    v_mul_u32_u24 v253, 21846, v252
    v_lshrrev_b32 v253, 16, v253
    v_mul_u32_u24 v254, 3, v253
    v_sub_u32 v252, v252, v254
    v_mul_u32_u24 v252, 142, v252
    v_and_b32 v252, 0x1fc, v252
    v_mul_u32_u24 v253, 1152, v253
    v_add_u32 v252, v252, v253
    s_bfe_u32 s56, s2, 0x20001
    s_mul_i32 s56, s56, 1327104
    s_lshr_b32 s57, s2, 6
    s_mul_i32 s57, s57, 288
    s_add_u32 s56, s56, s57
    s_mov_b32 exec_hi, 0x3fffff
    buffer_load_dword v255, v252, s[16:19], s56 offen
    s_mov_b64 exec, -1
    v_and_b32 v1, 3, v0
    v_bfe_u32 v2, v0, 2, 2
    v_bfe_u32 v3, v0, 4, 1
    v_lshrrev_b32 v4, 5, v0
    v_lshl_add_u32 v2, v4, 3, v2
    v_mul_u32_u24 v2, 288, v2
    v_lshrrev_b32 v4, 1, v1
    v_mul_u32_u24 v4, 18560, v4
    v_add_u32 v2, v2, v4
    v_lshl_add_u32 v2, v3, 4, v2
    v_and_b32 v1, 1, v1
    v_lshl_add_u32 v13, v1, 3, v2
    v_add_u32 v14, 36992, v13
    v_add_u32 v15, 73984, v13
    v_add_u32 v16, 110976, v13
    v_bfe_u32 v1, v0, 4, 1
    v_lshrrev_b32 v2, 5, v0
    v_and_b32 v3, 15, v0
    v_lshl_add_u32 v3, v1, 6, v3
    v_lshl_add_u32 v3, v2, 4, v3
    v_lshlrev_b32 v17, 4, v3
    s_lshl_b32 s45, s37, 6
    s_add_u32 s45, s45, 8192
    s_cmp_lg_u32 s24, 0
    s_cbranch_scc1 WDONE_27
    s_mov_b32 s56, 0
WLOOP_28:
    buffer_load_dword v1, off, s[28:31], s45 sc1
    s_waitcnt vmcnt(0)
    v_readfirstlane_b32 s57, v1
    s_add_u32 s56, s56, 1
    s_cmp_ge_u32 s57, 32
    s_cbranch_scc1 WDONE_27
    s_cmp_gt_u32 s56, 0x400000
    s_cbranch_scc1 WDONE_27
    s_sleep 1
    s_branch WLOOP_28
WDONE_27:
    s_barrier
    s_lshl_b32 s52, s47, 12
    s_add_u32 s52, s52, s44
    s_add_u32 s47, s47, 1
    s_cmp_ge_u32 s47, 9
    s_cselect_b32 s47, 0, s47
    buffer_load_dwordx4 v[20:23], v12, s[28:31], s52 offen offset:0
    buffer_load_dwordx4 v[24:27], v12, s[28:31], s52 offen offset:1024
    buffer_load_dwordx4 v[28:31], v12, s[28:31], s52 offen offset:2048
    buffer_load_dwordx4 v[32:35], v12, s[28:31], s52 offen offset:3072
    s_lshl_b32 s53, s47, 12
    s_add_u32 s53, s53, s44
    s_add_u32 s47, s47, 1
    s_cmp_ge_u32 s47, 9
    s_cselect_b32 s47, 0, s47
    buffer_load_dwordx4 v[36:39], v12, s[28:31], s53 offen offset:0
    buffer_load_dwordx4 v[40:43], v12, s[28:31], s53 offen offset:1024
    buffer_load_dwordx4 v[44:47], v12, s[28:31], s53 offen offset:2048
    buffer_load_dwordx4 v[48:51], v12, s[28:31], s53 offen offset:3072
    s_mul_i32 s50, s36, 9
    s_lshl_b32 s51, s43, 11
    s_add_u32 s51, s51, 18874368
    s_waitcnt vmcnt(4)
    s_barrier
    ds_read_b64_tr_b16 v[84:85], v13 offset:0
    ds_read_b64_tr_b16 v[86:87], v13 offset:1152
    ds_read_b64_tr_b16 v[88:89], v13 offset:32
    ds_read_b64_tr_b16 v[90:91], v13 offset:1184
    ds_read_b64_tr_b16 v[92:93], v13 offset:64
    ds_read_b64_tr_b16 v[94:95], v13 offset:1216
    ds_read_b64_tr_b16 v[96:97], v13 offset:96
    ds_read_b64_tr_b16 v[98:99], v13 offset:1248
    ds_read_b64_tr_b16 v[100:101], v13 offset:128
    ds_read_b64_tr_b16 v[102:103], v13 offset:1280
    ds_read_b64_tr_b16 v[104:105], v13 offset:160
    ds_read_b64_tr_b16 v[106:107], v13 offset:1312
    s_waitcnt lgkmcnt(10)
    v_mfma_f32_32x32x16_bf16 v[108:123], v[84:87], v[20:23], 0
    ds_read_b64_tr_b16 v[84:85], v13 offset:192
    ds_read_b64_tr_b16 v[86:87], v13 offset:1344
    s_waitcnt lgkmcnt(10)
    v_mfma_f32_32x32x16_bf16 v[124:139], v[88:91], v[20:23], 0
    s_mul_i32 s79, s78, 589824
    s_add_u32 s79, s79, s77
    s_add_u32 s78, s78, 1
    s_cmp_ge_u32 s78, 9
    s_cselect_b32 s78, 0, s78
    s_add_u32 m0, s76, 110976
    s_nop 0
    buffer_load_dwordx4 v7, s[12:15], s79 offen lds
    ds_read_b64_tr_b16 v[88:89], v13 offset:224
    ds_read_b64_tr_b16 v[90:91], v13 offset:1376
    s_waitcnt lgkmcnt(10)
    v_mfma_f32_32x32x16_bf16 v[140:155], v[92:95], v[20:23], 0
    ds_read_b64_tr_b16 v[92:93], v13 offset:256
    ds_read_b64_tr_b16 v[94:95], v13 offset:1408
    s_waitcnt lgkmcnt(10)
    v_mfma_f32_32x32x16_bf16 v[156:171], v[96:99], v[20:23], 0
    ds_read_b64_tr_b16 v[96:97], v13 offset:4608
    ds_read_b64_tr_b16 v[98:99], v13 offset:5760
    s_waitcnt lgkmcnt(10)
    v_mfma_f32_32x32x16_bf16 v[172:187], v[100:103], v[20:23], 0
    s_add_u32 m0, s76, 112000
    s_nop 0
    buffer_load_dwordx4 v8, s[12:15], s79 offen lds
    ds_read_b64_tr_b16 v[100:101], v13 offset:4640
    ds_read_b64_tr_b16 v[102:103], v13 offset:5792
    s_waitcnt lgkmcnt(10)
    v_mfma_f32_32x32x16_bf16 v[188:203], v[104:107], v[20:23], 0
    ds_read_b64_tr_b16 v[104:105], v13 offset:4672
    ds_read_b64_tr_b16 v[106:107], v13 offset:5824
    s_waitcnt lgkmcnt(10)
    v_mfma_f32_32x32x16_bf16 v[204:219], v[84:87], v[20:23], 0
    ds_read_b64_tr_b16 v[84:85], v13 offset:4704
    ds_read_b64_tr_b16 v[86:87], v13 offset:5856
    s_waitcnt lgkmcnt(10)
    v_mfma_f32_32x32x16_bf16 v[220:235], v[88:91], v[20:23], 0
    ds_read_b64_tr_b16 v[88:89], v13 offset:4736
    ds_read_b64_tr_b16 v[90:91], v13 offset:5888
    s_waitcnt lgkmcnt(10)
    v_mfma_f32_32x32x16_bf16 v[236:251], v[92:95], v[20:23], 0
    s_add_u32 m0, s76, 113024
    s_nop 0
    buffer_load_dwordx4 v9, s[12:15], s79 offen lds
    ds_read_b64_tr_b16 v[92:93], v13 offset:4768
    ds_read_b64_tr_b16 v[94:95], v13 offset:5920
    s_waitcnt lgkmcnt(10)
    v_mfma_f32_32x32x16_bf16 v[108:123], v[96:99], v[24:27], v[108:123]
    ds_read_b64_tr_b16 v[96:97], v13 offset:4800
    ds_read_b64_tr_b16 v[98:99], v13 offset:5952
    s_waitcnt lgkmcnt(10)
    v_mfma_f32_32x32x16_bf16 v[124:139], v[100:103], v[24:27], v[124:139]
    ds_read_b64_tr_b16 v[100:101], v13 offset:4832
    ds_read_b64_tr_b16 v[102:103], v13 offset:5984
    s_waitcnt lgkmcnt(10)
    v_mfma_f32_32x32x16_bf16 v[140:155], v[104:107], v[24:27], v[140:155]
    ds_read_b64_tr_b16 v[104:105], v13 offset:4864
    ds_read_b64_tr_b16 v[106:107], v13 offset:6016
    s_waitcnt lgkmcnt(10)
    v_mfma_f32_32x32x16_bf16 v[156:171], v[84:87], v[24:27], v[156:171]
    s_add_u32 m0, s76, 114048
    s_nop 0
    buffer_load_dwordx4 v10, s[12:15], s79 offen lds
    ds_read_b64_tr_b16 v[84:85], v13 offset:9216
    ds_read_b64_tr_b16 v[86:87], v13 offset:10368
    s_waitcnt lgkmcnt(10)
    v_mfma_f32_32x32x16_bf16 v[172:187], v[88:91], v[24:27], v[172:187]
    ds_read_b64_tr_b16 v[88:89], v13 offset:9248
    ds_read_b64_tr_b16 v[90:91], v13 offset:10400
    s_waitcnt lgkmcnt(10)
    v_mfma_f32_32x32x16_bf16 v[188:203], v[92:95], v[24:27], v[188:203]
    ds_read_b64_tr_b16 v[92:93], v13 offset:9280
    ds_read_b64_tr_b16 v[94:95], v13 offset:10432
    s_waitcnt lgkmcnt(10)
    v_mfma_f32_32x32x16_bf16 v[204:219], v[96:99], v[24:27], v[204:219]
    s_add_u32 m0, s76, 115072
    s_mov_b64 exec, 0xffffffff
    buffer_load_dwordx4 v11, s[12:15], s79 offen lds
    s_mov_b64 exec, -1
    ds_read_b64_tr_b16 v[96:97], v13 offset:9312
    ds_read_b64_tr_b16 v[98:99], v13 offset:10464
    s_waitcnt lgkmcnt(10)
    v_mfma_f32_32x32x16_bf16 v[220:235], v[100:103], v[24:27], v[220:235]
    ds_read_b64_tr_b16 v[100:101], v13 offset:9344
    ds_read_b64_tr_b16 v[102:103], v13 offset:10496
    s_waitcnt lgkmcnt(10)
    v_mfma_f32_32x32x16_bf16 v[236:251], v[104:107], v[24:27], v[236:251]
    ds_read_b64_tr_b16 v[104:105], v13 offset:9376
    ds_read_b64_tr_b16 v[106:107], v13 offset:10528
    s_waitcnt lgkmcnt(10)
    v_mfma_f32_32x32x16_bf16 v[108:123], v[84:87], v[28:31], v[108:123]
    ds_read_b64_tr_b16 v[84:85], v13 offset:9408
    ds_read_b64_tr_b16 v[86:87], v13 offset:10560
    s_waitcnt lgkmcnt(10)
    v_mfma_f32_32x32x16_bf16 v[124:139], v[88:91], v[28:31], v[124:139]
    s_lshl_b32 s54, s47, 12
    s_add_u32 s54, s54, s44
    s_add_u32 s47, s47, 1
    s_cmp_ge_u32 s47, 9
    s_cselect_b32 s47, 0, s47
    buffer_load_dwordx4 v[52:55], v12, s[28:31], s54 offen offset:0
    ds_read_b64_tr_b16 v[88:89], v13 offset:9440
    ds_read_b64_tr_b16 v[90:91], v13 offset:10592
    s_waitcnt lgkmcnt(10)
    v_mfma_f32_32x32x16_bf16 v[140:155], v[92:95], v[28:31], v[140:155]
    ds_read_b64_tr_b16 v[92:93], v13 offset:9472
    ds_read_b64_tr_b16 v[94:95], v13 offset:10624
    s_waitcnt lgkmcnt(10)
    v_mfma_f32_32x32x16_bf16 v[156:171], v[96:99], v[28:31], v[156:171]
    ds_read_b64_tr_b16 v[96:97], v13 offset:13824
    ds_read_b64_tr_b16 v[98:99], v13 offset:14976
    s_waitcnt lgkmcnt(10)
    v_mfma_f32_32x32x16_bf16 v[172:187], v[100:103], v[28:31], v[172:187]
    ds_read_b64_tr_b16 v[100:101], v13 offset:13856
    ds_read_b64_tr_b16 v[102:103], v13 offset:15008
    s_waitcnt lgkmcnt(10)
    v_mfma_f32_32x32x16_bf16 v[188:203], v[104:107], v[28:31], v[188:203]
    buffer_load_dwordx4 v[56:59], v12, s[28:31], s54 offen offset:1024
    ds_read_b64_tr_b16 v[104:105], v13 offset:13888
    ds_read_b64_tr_b16 v[106:107], v13 offset:15040
    s_waitcnt lgkmcnt(10)
    v_mfma_f32_32x32x16_bf16 v[204:219], v[84:87], v[28:31], v[204:219]
    ds_read_b64_tr_b16 v[84:85], v13 offset:13920
    ds_read_b64_tr_b16 v[86:87], v13 offset:15072
    s_waitcnt lgkmcnt(10)
    v_mfma_f32_32x32x16_bf16 v[220:235], v[88:91], v[28:31], v[220:235]
    ds_read_b64_tr_b16 v[88:89], v13 offset:13952
    ds_read_b64_tr_b16 v[90:91], v13 offset:15104
    s_waitcnt lgkmcnt(10)
    v_mfma_f32_32x32x16_bf16 v[236:251], v[92:95], v[28:31], v[236:251]
    buffer_load_dwordx4 v[60:63], v12, s[28:31], s54 offen offset:2048
    ds_read_b64_tr_b16 v[92:93], v13 offset:13984
    ds_read_b64_tr_b16 v[94:95], v13 offset:15136
    s_waitcnt lgkmcnt(10)
    v_mfma_f32_32x32x16_bf16 v[108:123], v[96:99], v[32:35], v[108:123]
    ds_read_b64_tr_b16 v[96:97], v13 offset:14016
    ds_read_b64_tr_b16 v[98:99], v13 offset:15168
    s_waitcnt lgkmcnt(10)
    v_mfma_f32_32x32x16_bf16 v[124:139], v[100:103], v[32:35], v[124:139]
    ds_read_b64_tr_b16 v[100:101], v13 offset:14048
    ds_read_b64_tr_b16 v[102:103], v13 offset:15200
    s_waitcnt lgkmcnt(10)
    v_mfma_f32_32x32x16_bf16 v[140:155], v[104:107], v[32:35], v[140:155]
    ds_read_b64_tr_b16 v[104:105], v13 offset:14080
    ds_read_b64_tr_b16 v[106:107], v13 offset:15232
    s_waitcnt lgkmcnt(10)
    v_mfma_f32_32x32x16_bf16 v[156:171], v[84:87], v[32:35], v[156:171]
    buffer_load_dwordx4 v[64:67], v12, s[28:31], s54 offen offset:3072
    s_waitcnt lgkmcnt(8)
    v_mfma_f32_32x32x16_bf16 v[172:187], v[88:91], v[32:35], v[172:187]
    s_waitcnt lgkmcnt(6)
    v_mfma_f32_32x32x16_bf16 v[188:203], v[92:95], v[32:35], v[188:203]
    s_waitcnt lgkmcnt(4)
    v_mfma_f32_32x32x16_bf16 v[204:219], v[96:99], v[32:35], v[204:219]
    s_waitcnt lgkmcnt(2)
    v_mfma_f32_32x32x16_bf16 v[220:235], v[100:103], v[32:35], v[220:235]
    s_waitcnt lgkmcnt(0)
    v_mfma_f32_32x32x16_bf16 v[236:251], v[104:107], v[32:35], v[236:251]
    s_waitcnt vmcnt(9)
    s_barrier
    ds_read_b64_tr_b16 v[84:85], v14 offset:0
    ds_read_b64_tr_b16 v[86:87], v14 offset:1152
    ds_read_b64_tr_b16 v[88:89], v14 offset:32
    ds_read_b64_tr_b16 v[90:91], v14 offset:1184
    ds_read_b64_tr_b16 v[92:93], v14 offset:64
    ds_read_b64_tr_b16 v[94:95], v14 offset:1216
    ds_read_b64_tr_b16 v[96:97], v14 offset:96
    ds_read_b64_tr_b16 v[98:99], v14 offset:1248
    ds_read_b64_tr_b16 v[100:101], v14 offset:128
    ds_read_b64_tr_b16 v[102:103], v14 offset:1280
    ds_read_b64_tr_b16 v[104:105], v14 offset:160
    ds_read_b64_tr_b16 v[106:107], v14 offset:1312
    s_waitcnt lgkmcnt(10)
    v_mfma_f32_32x32x16_bf16 v[108:123], v[84:87], v[36:39], v[108:123]
    ds_read_b64_tr_b16 v[84:85], v14 offset:192
    ds_read_b64_tr_b16 v[86:87], v14 offset:1344
    s_waitcnt lgkmcnt(10)
    v_mfma_f32_32x32x16_bf16 v[124:139], v[88:91], v[36:39], v[124:139]
    s_mul_i32 s79, s78, 589824
    s_add_u32 s79, s79, s77
    s_add_u32 s78, s78, 1
    s_cmp_ge_u32 s78, 9
    s_cselect_b32 s78, 0, s78
    s_add_u32 m0, s76, 0
    s_nop 0
    buffer_load_dwordx4 v7, s[12:15], s79 offen lds
    ds_read_b64_tr_b16 v[88:89], v14 offset:224
    ds_read_b64_tr_b16 v[90:91], v14 offset:1376
    s_waitcnt lgkmcnt(10)
    v_mfma_f32_32x32x16_bf16 v[140:155], v[92:95], v[36:39], v[140:155]
    ds_read_b64_tr_b16 v[92:93], v14 offset:256
    ds_read_b64_tr_b16 v[94:95], v14 offset:1408
    s_waitcnt lgkmcnt(10)
    v_mfma_f32_32x32x16_bf16 v[156:171], v[96:99], v[36:39], v[156:171]
    ds_read_b64_tr_b16 v[96:97], v14 offset:4608
    ds_read_b64_tr_b16 v[98:99], v14 offset:5760
    s_waitcnt lgkmcnt(10)
    v_mfma_f32_32x32x16_bf16 v[172:187], v[100:103], v[36:39], v[172:187]
    s_add_u32 m0, s76, 1024
    s_nop 0
    buffer_load_dwordx4 v8, s[12:15], s79 offen lds
    ds_read_b64_tr_b16 v[100:101], v14 offset:4640
    ds_read_b64_tr_b16 v[102:103], v14 offset:5792
    s_waitcnt lgkmcnt(10)
    v_mfma_f32_32x32x16_bf16 v[188:203], v[104:107], v[36:39], v[188:203]
    ds_read_b64_tr_b16 v[104:105], v14 offset:4672
    ds_read_b64_tr_b16 v[106:107], v14 offset:5824
    s_waitcnt lgkmcnt(10)
    v_mfma_f32_32x32x16_bf16 v[204:219], v[84:87], v[36:39], v[204:219]
    ds_read_b64_tr_b16 v[84:85], v14 offset:4704
    ds_read_b64_tr_b16 v[86:87], v14 offset:5856
    s_waitcnt lgkmcnt(10)
    v_mfma_f32_32x32x16_bf16 v[220:235], v[88:91], v[36:39], v[220:235]
    ds_read_b64_tr_b16 v[88:89], v14 offset:4736
    ds_read_b64_tr_b16 v[90:91], v14 offset:5888
    s_waitcnt lgkmcnt(10)
    v_mfma_f32_32x32x16_bf16 v[236:251], v[92:95], v[36:39], v[236:251]
    s_add_u32 m0, s76, 2048
    s_nop 0
    buffer_load_dwordx4 v9, s[12:15], s79 offen lds
    ds_read_b64_tr_b16 v[92:93], v14 offset:4768
    ds_read_b64_tr_b16 v[94:95], v14 offset:5920
    s_waitcnt lgkmcnt(10)
    v_mfma_f32_32x32x16_bf16 v[108:123], v[96:99], v[40:43], v[108:123]
    ds_read_b64_tr_b16 v[96:97], v14 offset:4800
    ds_read_b64_tr_b16 v[98:99], v14 offset:5952
    s_waitcnt lgkmcnt(10)
    v_mfma_f32_32x32x16_bf16 v[124:139], v[100:103], v[40:43], v[124:139]
    ds_read_b64_tr_b16 v[100:101], v14 offset:4832
    ds_read_b64_tr_b16 v[102:103], v14 offset:5984
    s_waitcnt lgkmcnt(10)
    v_mfma_f32_32x32x16_bf16 v[140:155], v[104:107], v[40:43], v[140:155]
    ds_read_b64_tr_b16 v[104:105], v14 offset:4864
    ds_read_b64_tr_b16 v[106:107], v14 offset:6016
    s_waitcnt lgkmcnt(10)
    v_mfma_f32_32x32x16_bf16 v[156:171], v[84:87], v[40:43], v[156:171]
    s_add_u32 m0, s76, 3072
    s_nop 0
    buffer_load_dwordx4 v10, s[12:15], s79 offen lds
    ds_read_b64_tr_b16 v[84:85], v14 offset:9216
    ds_read_b64_tr_b16 v[86:87], v14 offset:10368
    s_waitcnt lgkmcnt(10)
    v_mfma_f32_32x32x16_bf16 v[172:187], v[88:91], v[40:43], v[172:187]
    ds_read_b64_tr_b16 v[88:89], v14 offset:9248
    ds_read_b64_tr_b16 v[90:91], v14 offset:10400
    s_waitcnt lgkmcnt(10)
    v_mfma_f32_32x32x16_bf16 v[188:203], v[92:95], v[40:43], v[188:203]
    ds_read_b64_tr_b16 v[92:93], v14 offset:9280
    ds_read_b64_tr_b16 v[94:95], v14 offset:10432
    s_waitcnt lgkmcnt(10)
    v_mfma_f32_32x32x16_bf16 v[204:219], v[96:99], v[40:43], v[204:219]
    s_add_u32 m0, s76, 4096
    s_mov_b64 exec, 0xffffffff
    buffer_load_dwordx4 v11, s[12:15], s79 offen lds
    s_mov_b64 exec, -1
    ds_read_b64_tr_b16 v[96:97], v14 offset:9312
    ds_read_b64_tr_b16 v[98:99], v14 offset:10464
    s_waitcnt lgkmcnt(10)
    v_mfma_f32_32x32x16_bf16 v[220:235], v[100:103], v[40:43], v[220:235]
    ds_read_b64_tr_b16 v[100:101], v14 offset:9344
    ds_read_b64_tr_b16 v[102:103], v14 offset:10496
    s_waitcnt lgkmcnt(10)
    v_mfma_f32_32x32x16_bf16 v[236:251], v[104:107], v[40:43], v[236:251]
    ds_read_b64_tr_b16 v[104:105], v14 offset:9376
    ds_read_b64_tr_b16 v[106:107], v14 offset:10528
    s_waitcnt lgkmcnt(10)
    v_mfma_f32_32x32x16_bf16 v[108:123], v[84:87], v[44:47], v[108:123]
    ds_read_b64_tr_b16 v[84:85], v14 offset:9408
    ds_read_b64_tr_b16 v[86:87], v14 offset:10560
    s_waitcnt lgkmcnt(10)
    v_mfma_f32_32x32x16_bf16 v[124:139], v[88:91], v[44:47], v[124:139]
    s_lshl_b32 s55, s47, 12
    s_add_u32 s55, s55, s44
    s_add_u32 s47, s47, 1
    s_cmp_ge_u32 s47, 9
    s_cselect_b32 s47, 0, s47
    buffer_load_dwordx4 v[68:71], v12, s[28:31], s55 offen offset:0
    ds_read_b64_tr_b16 v[88:89], v14 offset:9440
    ds_read_b64_tr_b16 v[90:91], v14 offset:10592
    s_waitcnt lgkmcnt(10)
    v_mfma_f32_32x32x16_bf16 v[140:155], v[92:95], v[44:47], v[140:155]
    ds_read_b64_tr_b16 v[92:93], v14 offset:9472
    ds_read_b64_tr_b16 v[94:95], v14 offset:10624
    s_waitcnt lgkmcnt(10)
    v_mfma_f32_32x32x16_bf16 v[156:171], v[96:99], v[44:47], v[156:171]
    ds_read_b64_tr_b16 v[96:97], v14 offset:13824
    ds_read_b64_tr_b16 v[98:99], v14 offset:14976
    s_waitcnt lgkmcnt(10)
    v_mfma_f32_32x32x16_bf16 v[172:187], v[100:103], v[44:47], v[172:187]
    ds_read_b64_tr_b16 v[100:101], v14 offset:13856
    ds_read_b64_tr_b16 v[102:103], v14 offset:15008
    s_waitcnt lgkmcnt(10)
    v_mfma_f32_32x32x16_bf16 v[188:203], v[104:107], v[44:47], v[188:203]
    buffer_load_dwordx4 v[72:75], v12, s[28:31], s55 offen offset:1024
    ds_read_b64_tr_b16 v[104:105], v14 offset:13888
    ds_read_b64_tr_b16 v[106:107], v14 offset:15040
    s_waitcnt lgkmcnt(10)
    v_mfma_f32_32x32x16_bf16 v[204:219], v[84:87], v[44:47], v[204:219]
    ds_read_b64_tr_b16 v[84:85], v14 offset:13920
    ds_read_b64_tr_b16 v[86:87], v14 offset:15072
    s_waitcnt lgkmcnt(10)
    v_mfma_f32_32x32x16_bf16 v[220:235], v[88:91], v[44:47], v[220:235]
    ds_read_b64_tr_b16 v[88:89], v14 offset:13952
    ds_read_b64_tr_b16 v[90:91], v14 offset:15104
    s_waitcnt lgkmcnt(10)
    v_mfma_f32_32x32x16_bf16 v[236:251], v[92:95], v[44:47], v[236:251]
    buffer_load_dwordx4 v[76:79], v12, s[28:31], s55 offen offset:2048
    ds_read_b64_tr_b16 v[92:93], v14 offset:13984
    ds_read_b64_tr_b16 v[94:95], v14 offset:15136
    s_waitcnt lgkmcnt(10)
    v_mfma_f32_32x32x16_bf16 v[108:123], v[96:99], v[48:51], v[108:123]
    ds_read_b64_tr_b16 v[96:97], v14 offset:14016
    ds_read_b64_tr_b16 v[98:99], v14 offset:15168
    s_waitcnt lgkmcnt(10)
    v_mfma_f32_32x32x16_bf16 v[124:139], v[100:103], v[48:51], v[124:139]
    ds_read_b64_tr_b16 v[100:101], v14 offset:14048
    ds_read_b64_tr_b16 v[102:103], v14 offset:15200
    s_waitcnt lgkmcnt(10)
    v_mfma_f32_32x32x16_bf16 v[140:155], v[104:107], v[48:51], v[140:155]
    ds_read_b64_tr_b16 v[104:105], v14 offset:14080
    ds_read_b64_tr_b16 v[106:107], v14 offset:15232
    s_waitcnt lgkmcnt(10)
    v_mfma_f32_32x32x16_bf16 v[156:171], v[84:87], v[48:51], v[156:171]
    buffer_load_dwordx4 v[80:83], v12, s[28:31], s55 offen offset:3072
    ds_read_b64_tr_b16 v[84:85], v15 offset:0
    ds_read_b64_tr_b16 v[86:87], v15 offset:1152
    s_waitcnt lgkmcnt(10)
    v_mfma_f32_32x32x16_bf16 v[172:187], v[88:91], v[48:51], v[172:187]
    ds_read_b64_tr_b16 v[88:89], v15 offset:32
    ds_read_b64_tr_b16 v[90:91], v15 offset:1184
    s_waitcnt lgkmcnt(10)
    v_mfma_f32_32x32x16_bf16 v[188:203], v[92:95], v[48:51], v[188:203]
    ds_read_b64_tr_b16 v[92:93], v15 offset:64
    ds_read_b64_tr_b16 v[94:95], v15 offset:1216
    s_waitcnt lgkmcnt(10)
    v_mfma_f32_32x32x16_bf16 v[204:219], v[96:99], v[48:51], v[204:219]
    ds_read_b64_tr_b16 v[96:97], v15 offset:96
    ds_read_b64_tr_b16 v[98:99], v15 offset:1248
    s_waitcnt lgkmcnt(10)
    v_mfma_f32_32x32x16_bf16 v[220:235], v[100:103], v[48:51], v[220:235]
    ds_read_b64_tr_b16 v[100:101], v15 offset:128
    ds_read_b64_tr_b16 v[102:103], v15 offset:1280
    s_waitcnt lgkmcnt(10)
    v_mfma_f32_32x32x16_bf16 v[236:251], v[104:107], v[48:51], v[236:251]
    s_waitcnt vmcnt(9)
    s_barrier
    ds_read_b64_tr_b16 v[104:105], v15 offset:160
    ds_read_b64_tr_b16 v[106:107], v15 offset:1312
    s_waitcnt lgkmcnt(10)
    v_mfma_f32_32x32x16_bf16 v[108:123], v[84:87], v[52:55], v[108:123]
    ds_read_b64_tr_b16 v[84:85], v15 offset:192
    ds_read_b64_tr_b16 v[86:87], v15 offset:1344
    s_waitcnt lgkmcnt(10)
    v_mfma_f32_32x32x16_bf16 v[124:139], v[88:91], v[52:55], v[124:139]
    s_mul_i32 s79, s78, 589824
    s_add_u32 s79, s79, s77
    s_add_u32 s78, s78, 1
    s_cmp_ge_u32 s78, 9
    s_cselect_b32 s78, 0, s78
    s_add_u32 m0, s76, 36992
    s_nop 0
    buffer_load_dwordx4 v7, s[12:15], s79 offen lds
    ds_read_b64_tr_b16 v[88:89], v15 offset:224
    ds_read_b64_tr_b16 v[90:91], v15 offset:1376
    s_waitcnt lgkmcnt(10)
    v_mfma_f32_32x32x16_bf16 v[140:155], v[92:95], v[52:55], v[140:155]
    ds_read_b64_tr_b16 v[92:93], v15 offset:256
    ds_read_b64_tr_b16 v[94:95], v15 offset:1408
    s_waitcnt lgkmcnt(10)
    v_mfma_f32_32x32x16_bf16 v[156:171], v[96:99], v[52:55], v[156:171]
    ds_read_b64_tr_b16 v[96:97], v15 offset:4608
    ds_read_b64_tr_b16 v[98:99], v15 offset:5760
    s_waitcnt lgkmcnt(10)
    v_mfma_f32_32x32x16_bf16 v[172:187], v[100:103], v[52:55], v[172:187]
    s_add_u32 m0, s76, 38016
    s_nop 0
    buffer_load_dwordx4 v8, s[12:15], s79 offen lds
    ds_read_b64_tr_b16 v[100:101], v15 offset:4640
    ds_read_b64_tr_b16 v[102:103], v15 offset:5792
    s_waitcnt lgkmcnt(10)
    v_mfma_f32_32x32x16_bf16 v[188:203], v[104:107], v[52:55], v[188:203]
    ds_read_b64_tr_b16 v[104:105], v15 offset:4672
    ds_read_b64_tr_b16 v[106:107], v15 offset:5824
    s_waitcnt lgkmcnt(10)
    v_mfma_f32_32x32x16_bf16 v[204:219], v[84:87], v[52:55], v[204:219]
    ds_read_b64_tr_b16 v[84:85], v15 offset:4704
    ds_read_b64_tr_b16 v[86:87], v15 offset:5856
    s_waitcnt lgkmcnt(10)
    v_mfma_f32_32x32x16_bf16 v[220:235], v[88:91], v[52:55], v[220:235]
    ds_read_b64_tr_b16 v[88:89], v15 offset:4736
    ds_read_b64_tr_b16 v[90:91], v15 offset:5888
    s_waitcnt lgkmcnt(10)
    v_mfma_f32_32x32x16_bf16 v[236:251], v[92:95], v[52:55], v[236:251]
    s_add_u32 m0, s76, 39040
    s_nop 0
    buffer_load_dwordx4 v9, s[12:15], s79 offen lds
    ds_read_b64_tr_b16 v[92:93], v15 offset:4768
    ds_read_b64_tr_b16 v[94:95], v15 offset:5920
    s_waitcnt lgkmcnt(10)
    v_mfma_f32_32x32x16_bf16 v[108:123], v[96:99], v[56:59], v[108:123]
    ds_read_b64_tr_b16 v[96:97], v15 offset:4800
    ds_read_b64_tr_b16 v[98:99], v15 offset:5952
    s_waitcnt lgkmcnt(10)
    v_mfma_f32_32x32x16_bf16 v[124:139], v[100:103], v[56:59], v[124:139]
    ds_read_b64_tr_b16 v[100:101], v15 offset:4832
    ds_read_b64_tr_b16 v[102:103], v15 offset:5984
    s_waitcnt lgkmcnt(10)
    v_mfma_f32_32x32x16_bf16 v[140:155], v[104:107], v[56:59], v[140:155]
    ds_read_b64_tr_b16 v[104:105], v15 offset:4864
    ds_read_b64_tr_b16 v[106:107], v15 offset:6016
    s_waitcnt lgkmcnt(10)
    v_mfma_f32_32x32x16_bf16 v[156:171], v[84:87], v[56:59], v[156:171]
    s_add_u32 m0, s76, 40064
    s_nop 0
    buffer_load_dwordx4 v10, s[12:15], s79 offen lds
    ds_read_b64_tr_b16 v[84:85], v15 offset:9216
    ds_read_b64_tr_b16 v[86:87], v15 offset:10368
    s_waitcnt lgkmcnt(10)
    v_mfma_f32_32x32x16_bf16 v[172:187], v[88:91], v[56:59], v[172:187]
    ds_read_b64_tr_b16 v[88:89], v15 offset:9248
    ds_read_b64_tr_b16 v[90:91], v15 offset:10400
    s_waitcnt lgkmcnt(10)
    v_mfma_f32_32x32x16_bf16 v[188:203], v[92:95], v[56:59], v[188:203]
    ds_read_b64_tr_b16 v[92:93], v15 offset:9280
    ds_read_b64_tr_b16 v[94:95], v15 offset:10432
    s_waitcnt lgkmcnt(10)
    v_mfma_f32_32x32x16_bf16 v[204:219], v[96:99], v[56:59], v[204:219]
    s_add_u32 m0, s76, 41088
    s_mov_b64 exec, 0xffffffff
    buffer_load_dwordx4 v11, s[12:15], s79 offen lds
    s_mov_b64 exec, -1
    ds_read_b64_tr_b16 v[96:97], v15 offset:9312
    ds_read_b64_tr_b16 v[98:99], v15 offset:10464
    s_waitcnt lgkmcnt(10)
    v_mfma_f32_32x32x16_bf16 v[220:235], v[100:103], v[56:59], v[220:235]
    ds_read_b64_tr_b16 v[100:101], v15 offset:9344
    ds_read_b64_tr_b16 v[102:103], v15 offset:10496
    s_waitcnt lgkmcnt(10)
    v_mfma_f32_32x32x16_bf16 v[236:251], v[104:107], v[56:59], v[236:251]
    ds_read_b64_tr_b16 v[104:105], v15 offset:9376
    ds_read_b64_tr_b16 v[106:107], v15 offset:10528
    s_waitcnt lgkmcnt(10)
    v_mfma_f32_32x32x16_bf16 v[108:123], v[84:87], v[60:63], v[108:123]
    ds_read_b64_tr_b16 v[84:85], v15 offset:9408
    ds_read_b64_tr_b16 v[86:87], v15 offset:10560
    s_waitcnt lgkmcnt(10)
    v_mfma_f32_32x32x16_bf16 v[124:139], v[88:91], v[60:63], v[124:139]
    s_lshl_b32 s52, s47, 12
    s_add_u32 s52, s52, s44
    s_add_u32 s47, s47, 1
    s_cmp_ge_u32 s47, 9
    s_cselect_b32 s47, 0, s47
    buffer_load_dwordx4 v[20:23], v12, s[28:31], s52 offen offset:0
    ds_read_b64_tr_b16 v[88:89], v15 offset:9440
    ds_read_b64_tr_b16 v[90:91], v15 offset:10592
    s_waitcnt lgkmcnt(10)
    v_mfma_f32_32x32x16_bf16 v[140:155], v[92:95], v[60:63], v[140:155]
    ds_read_b64_tr_b16 v[92:93], v15 offset:9472
    ds_read_b64_tr_b16 v[94:95], v15 offset:10624
    s_waitcnt lgkmcnt(10)
    v_mfma_f32_32x32x16_bf16 v[156:171], v[96:99], v[60:63], v[156:171]
    ds_read_b64_tr_b16 v[96:97], v15 offset:13824
    ds_read_b64_tr_b16 v[98:99], v15 offset:14976
    s_waitcnt lgkmcnt(10)
    v_mfma_f32_32x32x16_bf16 v[172:187], v[100:103], v[60:63], v[172:187]
    ds_read_b64_tr_b16 v[100:101], v15 offset:13856
    ds_read_b64_tr_b16 v[102:103], v15 offset:15008
    s_waitcnt lgkmcnt(10)
    v_mfma_f32_32x32x16_bf16 v[188:203], v[104:107], v[60:63], v[188:203]
    buffer_load_dwordx4 v[24:27], v12, s[28:31], s52 offen offset:1024
    ds_read_b64_tr_b16 v[104:105], v15 offset:13888
    ds_read_b64_tr_b16 v[106:107], v15 offset:15040
    s_waitcnt lgkmcnt(10)
    v_mfma_f32_32x32x16_bf16 v[204:219], v[84:87], v[60:63], v[204:219]
    ds_read_b64_tr_b16 v[84:85], v15 offset:13920
    ds_read_b64_tr_b16 v[86:87], v15 offset:15072
    s_waitcnt lgkmcnt(10)
    v_mfma_f32_32x32x16_bf16 v[220:235], v[88:91], v[60:63], v[220:235]
    ds_read_b64_tr_b16 v[88:89], v15 offset:13952
    ds_read_b64_tr_b16 v[90:91], v15 offset:15104
    s_waitcnt lgkmcnt(10)
    v_mfma_f32_32x32x16_bf16 v[236:251], v[92:95], v[60:63], v[236:251]
    buffer_load_dwordx4 v[28:31], v12, s[28:31], s52 offen offset:2048
    ds_read_b64_tr_b16 v[92:93], v15 offset:13984
    ds_read_b64_tr_b16 v[94:95], v15 offset:15136
    s_waitcnt lgkmcnt(10)
    v_mfma_f32_32x32x16_bf16 v[108:123], v[96:99], v[64:67], v[108:123]
    ds_read_b64_tr_b16 v[96:97], v15 offset:14016
    ds_read_b64_tr_b16 v[98:99], v15 offset:15168
    s_waitcnt lgkmcnt(10)
    v_mfma_f32_32x32x16_bf16 v[124:139], v[100:103], v[64:67], v[124:139]
    ds_read_b64_tr_b16 v[100:101], v15 offset:14048
    ds_read_b64_tr_b16 v[102:103], v15 offset:15200
    s_waitcnt lgkmcnt(10)
    v_mfma_f32_32x32x16_bf16 v[140:155], v[104:107], v[64:67], v[140:155]
    ds_read_b64_tr_b16 v[104:105], v15 offset:14080
    ds_read_b64_tr_b16 v[106:107], v15 offset:15232
    s_waitcnt lgkmcnt(10)
    v_mfma_f32_32x32x16_bf16 v[156:171], v[84:87], v[64:67], v[156:171]
    buffer_load_dwordx4 v[32:35], v12, s[28:31], s52 offen offset:3072
    ds_read_b64_tr_b16 v[84:85], v16 offset:0
    ds_read_b64_tr_b16 v[86:87], v16 offset:1152
    s_waitcnt lgkmcnt(10)
    v_mfma_f32_32x32x16_bf16 v[172:187], v[88:91], v[64:67], v[172:187]
    ds_read_b64_tr_b16 v[88:89], v16 offset:32
    ds_read_b64_tr_b16 v[90:91], v16 offset:1184
    s_waitcnt lgkmcnt(10)
    v_mfma_f32_32x32x16_bf16 v[188:203], v[92:95], v[64:67], v[188:203]
    ds_read_b64_tr_b16 v[92:93], v16 offset:64
    ds_read_b64_tr_b16 v[94:95], v16 offset:1216
    s_waitcnt lgkmcnt(10)
    v_mfma_f32_32x32x16_bf16 v[204:219], v[96:99], v[64:67], v[204:219]
    ds_read_b64_tr_b16 v[96:97], v16 offset:96
    ds_read_b64_tr_b16 v[98:99], v16 offset:1248
    s_waitcnt lgkmcnt(10)
    v_mfma_f32_32x32x16_bf16 v[220:235], v[100:103], v[64:67], v[220:235]
    ds_read_b64_tr_b16 v[100:101], v16 offset:128
    ds_read_b64_tr_b16 v[102:103], v16 offset:1280
    s_waitcnt lgkmcnt(10)
    v_mfma_f32_32x32x16_bf16 v[236:251], v[104:107], v[64:67], v[236:251]
    s_waitcnt vmcnt(9)
    s_barrier
    ds_read_b64_tr_b16 v[104:105], v16 offset:160
    ds_read_b64_tr_b16 v[106:107], v16 offset:1312
    s_waitcnt lgkmcnt(10)
    v_mfma_f32_32x32x16_bf16 v[108:123], v[84:87], v[68:71], v[108:123]
    ds_read_b64_tr_b16 v[84:85], v16 offset:192
    ds_read_b64_tr_b16 v[86:87], v16 offset:1344
    s_waitcnt lgkmcnt(10)
    v_mfma_f32_32x32x16_bf16 v[124:139], v[88:91], v[68:71], v[124:139]
    s_mul_i32 s79, s78, 589824
    s_add_u32 s79, s79, s77
    s_add_u32 s78, s78, 1
    s_cmp_ge_u32 s78, 9
    s_cselect_b32 s78, 0, s78
    s_add_u32 m0, s76, 73984
    s_nop 0
    buffer_load_dwordx4 v7, s[12:15], s79 offen lds
    ds_read_b64_tr_b16 v[88:89], v16 offset:224
    ds_read_b64_tr_b16 v[90:91], v16 offset:1376
    s_waitcnt lgkmcnt(10)
    v_mfma_f32_32x32x16_bf16 v[140:155], v[92:95], v[68:71], v[140:155]
    ds_read_b64_tr_b16 v[92:93], v16 offset:256
    ds_read_b64_tr_b16 v[94:95], v16 offset:1408
    s_waitcnt lgkmcnt(10)
    v_mfma_f32_32x32x16_bf16 v[156:171], v[96:99], v[68:71], v[156:171]
    ds_read_b64_tr_b16 v[96:97], v16 offset:4608
    ds_read_b64_tr_b16 v[98:99], v16 offset:5760
    s_waitcnt lgkmcnt(10)
    v_mfma_f32_32x32x16_bf16 v[172:187], v[100:103], v[68:71], v[172:187]
    s_add_u32 m0, s76, 75008
    s_nop 0
    buffer_load_dwordx4 v8, s[12:15], s79 offen lds
    ds_read_b64_tr_b16 v[100:101], v16 offset:4640
    ds_read_b64_tr_b16 v[102:103], v16 offset:5792
    s_waitcnt lgkmcnt(10)
    v_mfma_f32_32x32x16_bf16 v[188:203], v[104:107], v[68:71], v[188:203]
    ds_read_b64_tr_b16 v[104:105], v16 offset:4672
    ds_read_b64_tr_b16 v[106:107], v16 offset:5824
    s_waitcnt lgkmcnt(10)
    v_mfma_f32_32x32x16_bf16 v[204:219], v[84:87], v[68:71], v[204:219]
    ds_read_b64_tr_b16 v[84:85], v16 offset:4704
    ds_read_b64_tr_b16 v[86:87], v16 offset:5856
    s_waitcnt lgkmcnt(10)
    v_mfma_f32_32x32x16_bf16 v[220:235], v[88:91], v[68:71], v[220:235]
    ds_read_b64_tr_b16 v[88:89], v16 offset:4736
    ds_read_b64_tr_b16 v[90:91], v16 offset:5888
    s_waitcnt lgkmcnt(10)
    v_mfma_f32_32x32x16_bf16 v[236:251], v[92:95], v[68:71], v[236:251]
    s_add_u32 m0, s76, 76032
    s_nop 0
    buffer_load_dwordx4 v9, s[12:15], s79 offen lds
    ds_read_b64_tr_b16 v[92:93], v16 offset:4768
    ds_read_b64_tr_b16 v[94:95], v16 offset:5920
    s_waitcnt lgkmcnt(10)
    v_mfma_f32_32x32x16_bf16 v[108:123], v[96:99], v[72:75], v[108:123]
    ds_read_b64_tr_b16 v[96:97], v16 offset:4800
    ds_read_b64_tr_b16 v[98:99], v16 offset:5952
    s_waitcnt lgkmcnt(10)
    v_mfma_f32_32x32x16_bf16 v[124:139], v[100:103], v[72:75], v[124:139]
    ds_read_b64_tr_b16 v[100:101], v16 offset:4832
    ds_read_b64_tr_b16 v[102:103], v16 offset:5984
    s_waitcnt lgkmcnt(10)
    v_mfma_f32_32x32x16_bf16 v[140:155], v[104:107], v[72:75], v[140:155]
    ds_read_b64_tr_b16 v[104:105], v16 offset:4864
    ds_read_b64_tr_b16 v[106:107], v16 offset:6016
    s_waitcnt lgkmcnt(10)
    v_mfma_f32_32x32x16_bf16 v[156:171], v[84:87], v[72:75], v[156:171]
    s_add_u32 m0, s76, 77056
    s_nop 0
    buffer_load_dwordx4 v10, s[12:15], s79 offen lds
    ds_read_b64_tr_b16 v[84:85], v16 offset:9216
    ds_read_b64_tr_b16 v[86:87], v16 offset:10368
    s_waitcnt lgkmcnt(10)
    v_mfma_f32_32x32x16_bf16 v[172:187], v[88:91], v[72:75], v[172:187]
    ds_read_b64_tr_b16 v[88:89], v16 offset:9248
    ds_read_b64_tr_b16 v[90:91], v16 offset:10400
    s_waitcnt lgkmcnt(10)
    v_mfma_f32_32x32x16_bf16 v[188:203], v[92:95], v[72:75], v[188:203]
    ds_read_b64_tr_b16 v[92:93], v16 offset:9280
    ds_read_b64_tr_b16 v[94:95], v16 offset:10432
    s_waitcnt lgkmcnt(10)
    v_mfma_f32_32x32x16_bf16 v[204:219], v[96:99], v[72:75], v[204:219]
    s_add_u32 m0, s76, 78080
    s_mov_b64 exec, 0xffffffff
    buffer_load_dwordx4 v11, s[12:15], s79 offen lds
    s_mov_b64 exec, -1
    ds_read_b64_tr_b16 v[96:97], v16 offset:9312
    ds_read_b64_tr_b16 v[98:99], v16 offset:10464
    s_waitcnt lgkmcnt(10)
    v_mfma_f32_32x32x16_bf16 v[220:235], v[100:103], v[72:75], v[220:235]
    ds_read_b64_tr_b16 v[100:101], v16 offset:9344
    ds_read_b64_tr_b16 v[102:103], v16 offset:10496
    s_waitcnt lgkmcnt(10)
    v_mfma_f32_32x32x16_bf16 v[236:251], v[104:107], v[72:75], v[236:251]
    ds_read_b64_tr_b16 v[104:105], v16 offset:9376
    ds_read_b64_tr_b16 v[106:107], v16 offset:10528
    s_waitcnt lgkmcnt(10)
    v_mfma_f32_32x32x16_bf16 v[108:123], v[84:87], v[76:79], v[108:123]
    ds_read_b64_tr_b16 v[84:85], v16 offset:9408
    ds_read_b64_tr_b16 v[86:87], v16 offset:10560
    s_waitcnt lgkmcnt(10)
    v_mfma_f32_32x32x16_bf16 v[124:139], v[88:91], v[76:79], v[124:139]
    s_lshl_b32 s53, s47, 12
    s_add_u32 s53, s53, s44
    s_add_u32 s47, s47, 1
    s_cmp_ge_u32 s47, 9
    s_cselect_b32 s47, 0, s47
    buffer_load_dwordx4 v[36:39], v12, s[28:31], s53 offen offset:0
    ds_read_b64_tr_b16 v[88:89], v16 offset:9440
    ds_read_b64_tr_b16 v[90:91], v16 offset:10592
    s_waitcnt lgkmcnt(10)
    v_mfma_f32_32x32x16_bf16 v[140:155], v[92:95], v[76:79], v[140:155]
    ds_read_b64_tr_b16 v[92:93], v16 offset:9472
    ds_read_b64_tr_b16 v[94:95], v16 offset:10624
    s_waitcnt lgkmcnt(10)
    v_mfma_f32_32x32x16_bf16 v[156:171], v[96:99], v[76:79], v[156:171]
    ds_read_b64_tr_b16 v[96:97], v16 offset:13824
    ds_read_b64_tr_b16 v[98:99], v16 offset:14976
    s_waitcnt lgkmcnt(10)
    v_mfma_f32_32x32x16_bf16 v[172:187], v[100:103], v[76:79], v[172:187]
    ds_read_b64_tr_b16 v[100:101], v16 offset:13856
    ds_read_b64_tr_b16 v[102:103], v16 offset:15008
    s_waitcnt lgkmcnt(10)
    v_mfma_f32_32x32x16_bf16 v[188:203], v[104:107], v[76:79], v[188:203]
    buffer_load_dwordx4 v[40:43], v12, s[28:31], s53 offen offset:1024
    ds_read_b64_tr_b16 v[104:105], v16 offset:13888
    ds_read_b64_tr_b16 v[106:107], v16 offset:15040
    s_waitcnt lgkmcnt(10)
    v_mfma_f32_32x32x16_bf16 v[204:219], v[84:87], v[76:79], v[204:219]
    ds_read_b64_tr_b16 v[84:85], v16 offset:13920
    ds_read_b64_tr_b16 v[86:87], v16 offset:15072
    s_waitcnt lgkmcnt(10)
    v_mfma_f32_32x32x16_bf16 v[220:235], v[88:91], v[76:79], v[220:235]
    ds_read_b64_tr_b16 v[88:89], v16 offset:13952
    ds_read_b64_tr_b16 v[90:91], v16 offset:15104
    s_waitcnt lgkmcnt(10)
    v_mfma_f32_32x32x16_bf16 v[236:251], v[92:95], v[76:79], v[236:251]
    buffer_load_dwordx4 v[44:47], v12, s[28:31], s53 offen offset:2048
    ds_read_b64_tr_b16 v[92:93], v16 offset:13984
    ds_read_b64_tr_b16 v[94:95], v16 offset:15136
    s_waitcnt lgkmcnt(10)
    v_mfma_f32_32x32x16_bf16 v[108:123], v[96:99], v[80:83], v[108:123]
    ds_read_b64_tr_b16 v[96:97], v16 offset:14016
    ds_read_b64_tr_b16 v[98:99], v16 offset:15168
    s_waitcnt lgkmcnt(10)
    v_mfma_f32_32x32x16_bf16 v[124:139], v[100:103], v[80:83], v[124:139]
    ds_read_b64_tr_b16 v[100:101], v16 offset:14048
    ds_read_b64_tr_b16 v[102:103], v16 offset:15200
    s_waitcnt lgkmcnt(10)
    v_mfma_f32_32x32x16_bf16 v[140:155], v[104:107], v[80:83], v[140:155]
    ds_read_b64_tr_b16 v[104:105], v16 offset:14080
    ds_read_b64_tr_b16 v[106:107], v16 offset:15232
    s_waitcnt lgkmcnt(10)
    v_mfma_f32_32x32x16_bf16 v[156:171], v[84:87], v[80:83], v[156:171]
    buffer_load_dwordx4 v[48:51], v12, s[28:31], s53 offen offset:3072
    ds_read_b64_tr_b16 v[84:85], v13 offset:0
    ds_read_b64_tr_b16 v[86:87], v13 offset:1152
    s_waitcnt lgkmcnt(10)
    v_mfma_f32_32x32x16_bf16 v[172:187], v[88:91], v[80:83], v[172:187]
    ds_read_b64_tr_b16 v[88:89], v13 offset:32
    ds_read_b64_tr_b16 v[90:91], v13 offset:1184
    s_waitcnt lgkmcnt(10)
    v_mfma_f32_32x32x16_bf16 v[188:203], v[92:95], v[80:83], v[188:203]
    ds_read_b64_tr_b16 v[92:93], v13 offset:64
    ds_read_b64_tr_b16 v[94:95], v13 offset:1216
    s_waitcnt lgkmcnt(10)
    v_mfma_f32_32x32x16_bf16 v[204:219], v[96:99], v[80:83], v[204:219]
    ds_read_b64_tr_b16 v[96:97], v13 offset:96
    ds_read_b64_tr_b16 v[98:99], v13 offset:1248
    s_waitcnt lgkmcnt(10)
    v_mfma_f32_32x32x16_bf16 v[220:235], v[100:103], v[80:83], v[220:235]
    ds_read_b64_tr_b16 v[100:101], v13 offset:128
    ds_read_b64_tr_b16 v[102:103], v13 offset:1280
    s_waitcnt lgkmcnt(10)
    v_mfma_f32_32x32x16_bf16 v[236:251], v[104:107], v[80:83], v[236:251]
    s_waitcnt vmcnt(9)
    s_barrier
    ds_read_b64_tr_b16 v[104:105], v13 offset:160
    ds_read_b64_tr_b16 v[106:107], v13 offset:1312
    s_waitcnt lgkmcnt(10)
    v_mfma_f32_32x32x16_bf16 v[108:123], v[84:87], v[20:23], v[108:123]
    ds_read_b64_tr_b16 v[84:85], v13 offset:192
    ds_read_b64_tr_b16 v[86:87], v13 offset:1344
    s_waitcnt lgkmcnt(10)
    v_mfma_f32_32x32x16_bf16 v[124:139], v[88:91], v[20:23], v[124:139]
    s_mul_i32 s79, s78, 589824
    s_add_u32 s79, s79, s77
    s_add_u32 s78, s78, 1
    s_cmp_ge_u32 s78, 9
    s_cselect_b32 s78, 0, s78
    s_add_u32 m0, s76, 110976
    s_nop 0
    buffer_load_dwordx4 v7, s[12:15], s79 offen lds
    ds_read_b64_tr_b16 v[88:89], v13 offset:224
    ds_read_b64_tr_b16 v[90:91], v13 offset:1376
    s_waitcnt lgkmcnt(10)
    v_mfma_f32_32x32x16_bf16 v[140:155], v[92:95], v[20:23], v[140:155]
    ds_read_b64_tr_b16 v[92:93], v13 offset:256
    ds_read_b64_tr_b16 v[94:95], v13 offset:1408
    s_waitcnt lgkmcnt(10)
    v_mfma_f32_32x32x16_bf16 v[156:171], v[96:99], v[20:23], v[156:171]
    s_add_u32 m0, s76, 112000
    s_nop 0
    buffer_load_dwordx4 v8, s[12:15], s79 offen lds
    ds_read_b64_tr_b16 v[96:97], v13 offset:4608
    ds_read_b64_tr_b16 v[98:99], v13 offset:5760
    s_waitcnt lgkmcnt(10)
    v_mfma_f32_32x32x16_bf16 v[172:187], v[100:103], v[20:23], v[172:187]
    ds_read_b64_tr_b16 v[100:101], v13 offset:4640
    ds_read_b64_tr_b16 v[102:103], v13 offset:5792
    s_waitcnt lgkmcnt(10)
    v_mfma_f32_32x32x16_bf16 v[188:203], v[104:107], v[20:23], v[188:203]
    ds_read_b64_tr_b16 v[104:105], v13 offset:4672
    ds_read_b64_tr_b16 v[106:107], v13 offset:5824
    s_waitcnt lgkmcnt(10)
    v_mfma_f32_32x32x16_bf16 v[204:219], v[84:87], v[20:23], v[204:219]
    s_add_u32 m0, s76, 113024
    s_nop 0
    buffer_load_dwordx4 v9, s[12:15], s79 offen lds
    ds_read_b64_tr_b16 v[84:85], v13 offset:4704
    ds_read_b64_tr_b16 v[86:87], v13 offset:5856
    s_waitcnt lgkmcnt(10)
    v_mfma_f32_32x32x16_bf16 v[220:235], v[88:91], v[20:23], v[220:235]
    ds_read_b64_tr_b16 v[88:89], v13 offset:4736
    ds_read_b64_tr_b16 v[90:91], v13 offset:5888
    s_waitcnt lgkmcnt(10)
    v_mfma_f32_32x32x16_bf16 v[236:251], v[92:95], v[20:23], v[236:251]
    s_add_u32 m0, s76, 114048
    s_nop 0
    buffer_load_dwordx4 v10, s[12:15], s79 offen lds
    ds_read_b64_tr_b16 v[92:93], v13 offset:4768
    ds_read_b64_tr_b16 v[94:95], v13 offset:5920
    s_waitcnt lgkmcnt(10)
    v_mfma_f32_32x32x16_bf16 v[108:123], v[96:99], v[24:27], v[108:123]
    ds_read_b64_tr_b16 v[96:97], v13 offset:4800
    ds_read_b64_tr_b16 v[98:99], v13 offset:5952
    s_waitcnt lgkmcnt(10)
    v_mfma_f32_32x32x16_bf16 v[124:139], v[100:103], v[24:27], v[124:139]
    ds_read_b64_tr_b16 v[100:101], v13 offset:4832
    ds_read_b64_tr_b16 v[102:103], v13 offset:5984
    s_waitcnt lgkmcnt(10)
    v_mfma_f32_32x32x16_bf16 v[140:155], v[104:107], v[24:27], v[140:155]
    s_add_u32 m0, s76, 115072
    s_mov_b64 exec, 0xffffffff
    buffer_load_dwordx4 v11, s[12:15], s79 offen lds
    s_mov_b64 exec, -1
    ds_read_b64_tr_b16 v[104:105], v13 offset:4864
    ds_read_b64_tr_b16 v[106:107], v13 offset:6016
    s_waitcnt lgkmcnt(10)
    v_mfma_f32_32x32x16_bf16 v[156:171], v[84:87], v[24:27], v[156:171]
    ds_read_b64_tr_b16 v[84:85], v13 offset:9216
    ds_read_b64_tr_b16 v[86:87], v13 offset:10368
    s_waitcnt lgkmcnt(10)
    v_mfma_f32_32x32x16_bf16 v[172:187], v[88:91], v[24:27], v[172:187]
    s_lshl_b32 s54, s47, 12
    s_add_u32 s54, s54, s44
    s_add_u32 s47, s47, 1
    s_cmp_ge_u32 s47, 9
    s_cselect_b32 s47, 0, s47
    buffer_load_dwordx4 v[52:55], v12, s[28:31], s54 offen offset:0
    ds_read_b64_tr_b16 v[88:89], v13 offset:9248
    ds_read_b64_tr_b16 v[90:91], v13 offset:10400
    s_waitcnt lgkmcnt(10)
    v_mfma_f32_32x32x16_bf16 v[188:203], v[92:95], v[24:27], v[188:203]
    ds_read_b64_tr_b16 v[92:93], v13 offset:9280
    ds_read_b64_tr_b16 v[94:95], v13 offset:10432
    s_waitcnt lgkmcnt(10)
    v_mfma_f32_32x32x16_bf16 v[204:219], v[96:99], v[24:27], v[204:219]
    ds_read_b64_tr_b16 v[96:97], v13 offset:9312
    ds_read_b64_tr_b16 v[98:99], v13 offset:10464
    s_waitcnt lgkmcnt(10)
    v_mfma_f32_32x32x16_bf16 v[220:235], v[100:103], v[24:27], v[220:235]
    buffer_load_dwordx4 v[56:59], v12, s[28:31], s54 offen offset:1024
    ds_read_b64_tr_b16 v[100:101], v13 offset:9344
    ds_read_b64_tr_b16 v[102:103], v13 offset:10496
    s_waitcnt lgkmcnt(10)
    v_mfma_f32_32x32x16_bf16 v[236:251], v[104:107], v[24:27], v[236:251]
    ds_read_b64_tr_b16 v[104:105], v13 offset:9376
    ds_read_b64_tr_b16 v[106:107], v13 offset:10528
    s_waitcnt lgkmcnt(10)
    v_mfma_f32_32x32x16_bf16 v[108:123], v[84:87], v[28:31], v[108:123]
    buffer_load_dwordx4 v[60:63], v12, s[28:31], s54 offen offset:2048
    ds_read_b64_tr_b16 v[84:85], v13 offset:9408
    ds_read_b64_tr_b16 v[86:87], v13 offset:10560
    s_waitcnt lgkmcnt(10)
    v_mfma_f32_32x32x16_bf16 v[124:139], v[88:91], v[28:31], v[124:139]
    ds_read_b64_tr_b16 v[88:89], v13 offset:9440
    ds_read_b64_tr_b16 v[90:91], v13 offset:10592
    s_waitcnt lgkmcnt(10)
    v_mfma_f32_32x32x16_bf16 v[140:155], v[92:95], v[28:31], v[140:155]
    ds_read_b64_tr_b16 v[92:93], v13 offset:9472
    ds_read_b64_tr_b16 v[94:95], v13 offset:10624
    s_waitcnt lgkmcnt(10)
    v_mfma_f32_32x32x16_bf16 v[156:171], v[96:99], v[28:31], v[156:171]
    buffer_load_dwordx4 v[64:67], v12, s[28:31], s54 offen offset:3072
    ds_read_b64_tr_b16 v[96:97], v13 offset:13824
    ds_read_b64_tr_b16 v[98:99], v13 offset:14976
    s_waitcnt lgkmcnt(10)
    v_mfma_f32_32x32x16_bf16 v[172:187], v[100:103], v[28:31], v[172:187]
    ds_read_b64_tr_b16 v[100:101], v13 offset:13856
    ds_read_b64_tr_b16 v[102:103], v13 offset:15008
    s_waitcnt lgkmcnt(10)
    v_mfma_f32_32x32x16_bf16 v[188:203], v[104:107], v[28:31], v[188:203]
    s_lshl_b32 s55, s47, 12
    s_add_u32 s55, s55, s44
    s_add_u32 s47, s47, 1
    s_cmp_ge_u32 s47, 9
    s_cselect_b32 s47, 0, s47
    buffer_load_dwordx4 v[68:71], v12, s[28:31], s55 offen offset:0
    ds_read_b64_tr_b16 v[104:105], v13 offset:13888
    ds_read_b64_tr_b16 v[106:107], v13 offset:15040
    s_waitcnt lgkmcnt(10)
    v_mfma_f32_32x32x16_bf16 v[204:219], v[84:87], v[28:31], v[204:219]
    ds_read_b64_tr_b16 v[84:85], v13 offset:13920
    ds_read_b64_tr_b16 v[86:87], v13 offset:15072
    s_waitcnt lgkmcnt(10)
    v_mfma_f32_32x32x16_bf16 v[220:235], v[88:91], v[28:31], v[220:235]
    ds_read_b64_tr_b16 v[88:89], v13 offset:13952
    ds_read_b64_tr_b16 v[90:91], v13 offset:15104
    s_waitcnt lgkmcnt(10)
    v_mfma_f32_32x32x16_bf16 v[236:251], v[92:95], v[28:31], v[236:251]
    buffer_load_dwordx4 v[72:75], v12, s[28:31], s55 offen offset:1024
    ds_read_b64_tr_b16 v[92:93], v13 offset:13984
    ds_read_b64_tr_b16 v[94:95], v13 offset:15136
    s_waitcnt lgkmcnt(10)
    v_mfma_f32_32x32x16_bf16 v[108:123], v[96:99], v[32:35], v[108:123]
    ds_read_b64_tr_b16 v[96:97], v13 offset:14016
    ds_read_b64_tr_b16 v[98:99], v13 offset:15168
    s_waitcnt lgkmcnt(10)
    v_mfma_f32_32x32x16_bf16 v[124:139], v[100:103], v[32:35], v[124:139]
    buffer_load_dwordx4 v[76:79], v12, s[28:31], s55 offen offset:2048
    ds_read_b64_tr_b16 v[100:101], v13 offset:14048
    ds_read_b64_tr_b16 v[102:103], v13 offset:15200
    s_waitcnt lgkmcnt(10)
    v_mfma_f32_32x32x16_bf16 v[140:155], v[104:107], v[32:35], v[140:155]
    ds_read_b64_tr_b16 v[104:105], v13 offset:14080
    ds_read_b64_tr_b16 v[106:107], v13 offset:15232
    s_waitcnt lgkmcnt(10)
    v_mfma_f32_32x32x16_bf16 v[156:171], v[84:87], v[32:35], v[156:171]
    ds_read_b64_tr_b16 v[84:85], v14 offset:0
    ds_read_b64_tr_b16 v[86:87], v14 offset:1152
    s_waitcnt lgkmcnt(10)
    v_mfma_f32_32x32x16_bf16 v[172:187], v[88:91], v[32:35], v[172:187]
    buffer_load_dwordx4 v[80:83], v12, s[28:31], s55 offen offset:3072
    ds_read_b64_tr_b16 v[88:89], v14 offset:32
    ds_read_b64_tr_b16 v[90:91], v14 offset:1184
    s_waitcnt lgkmcnt(10)
    v_mfma_f32_32x32x16_bf16 v[188:203], v[92:95], v[32:35], v[188:203]
    ds_read_b64_tr_b16 v[92:93], v14 offset:64
    ds_read_b64_tr_b16 v[94:95], v14 offset:1216
    s_waitcnt lgkmcnt(10)
    v_mfma_f32_32x32x16_bf16 v[204:219], v[96:99], v[32:35], v[204:219]
    ds_read_b64_tr_b16 v[96:97], v14 offset:96
    ds_read_b64_tr_b16 v[98:99], v14 offset:1248
    s_waitcnt lgkmcnt(10)
    v_mfma_f32_32x32x16_bf16 v[220:235], v[100:103], v[32:35], v[220:235]
    ds_read_b64_tr_b16 v[100:101], v14 offset:128
    ds_read_b64_tr_b16 v[102:103], v14 offset:1280
    s_waitcnt lgkmcnt(10)
    v_mfma_f32_32x32x16_bf16 v[236:251], v[104:107], v[32:35], v[236:251]
    s_waitcnt vmcnt(13)
    s_barrier
    ds_read_b64_tr_b16 v[104:105], v14 offset:160
    ds_read_b64_tr_b16 v[106:107], v14 offset:1312
    s_waitcnt lgkmcnt(10)
    v_mfma_f32_32x32x16_bf16 v[108:123], v[84:87], v[36:39], v[108:123]
    ds_read_b64_tr_b16 v[84:85], v14 offset:192
    ds_read_b64_tr_b16 v[86:87], v14 offset:1344
    s_waitcnt lgkmcnt(10)
    v_mfma_f32_32x32x16_bf16 v[124:139], v[88:91], v[36:39], v[124:139]
    s_mul_i32 s79, s78, 589824
    s_add_u32 s79, s79, s77
    s_add_u32 s78, s78, 1
    s_cmp_ge_u32 s78, 9
    s_cselect_b32 s78, 0, s78
    s_add_u32 m0, s76, 0
    s_nop 0
    buffer_load_dwordx4 v7, s[12:15], s79 offen lds
    ds_read_b64_tr_b16 v[88:89], v14 offset:224
    ds_read_b64_tr_b16 v[90:91], v14 offset:1376
    s_waitcnt lgkmcnt(10)
    v_mfma_f32_32x32x16_bf16 v[140:155], v[92:95], v[36:39], v[140:155]
    ds_read_b64_tr_b16 v[92:93], v14 offset:256
    ds_read_b64_tr_b16 v[94:95], v14 offset:1408
    s_waitcnt lgkmcnt(10)
    v_mfma_f32_32x32x16_bf16 v[156:171], v[96:99], v[36:39], v[156:171]
    ds_read_b64_tr_b16 v[96:97], v14 offset:4608
    ds_read_b64_tr_b16 v[98:99], v14 offset:5760
    s_waitcnt lgkmcnt(10)
    v_mfma_f32_32x32x16_bf16 v[172:187], v[100:103], v[36:39], v[172:187]
    s_add_u32 m0, s76, 1024
    s_nop 0
    buffer_load_dwordx4 v8, s[12:15], s79 offen lds
    ds_read_b64_tr_b16 v[100:101], v14 offset:4640
    ds_read_b64_tr_b16 v[102:103], v14 offset:5792
    s_waitcnt lgkmcnt(10)
    v_mfma_f32_32x32x16_bf16 v[188:203], v[104:107], v[36:39], v[188:203]
    ds_read_b64_tr_b16 v[104:105], v14 offset:4672
    ds_read_b64_tr_b16 v[106:107], v14 offset:5824
    s_waitcnt lgkmcnt(10)
    v_mfma_f32_32x32x16_bf16 v[204:219], v[84:87], v[36:39], v[204:219]
    ds_read_b64_tr_b16 v[84:85], v14 offset:4704
    ds_read_b64_tr_b16 v[86:87], v14 offset:5856
    s_waitcnt lgkmcnt(10)
    v_mfma_f32_32x32x16_bf16 v[220:235], v[88:91], v[36:39], v[220:235]
    ds_read_b64_tr_b16 v[88:89], v14 offset:4736
    ds_read_b64_tr_b16 v[90:91], v14 offset:5888
    s_waitcnt lgkmcnt(10)
    v_mfma_f32_32x32x16_bf16 v[236:251], v[92:95], v[36:39], v[236:251]
    s_add_u32 m0, s76, 2048
    s_nop 0
    buffer_load_dwordx4 v9, s[12:15], s79 offen lds
    ds_read_b64_tr_b16 v[92:93], v14 offset:4768
    ds_read_b64_tr_b16 v[94:95], v14 offset:5920
    s_waitcnt lgkmcnt(10)
    v_mfma_f32_32x32x16_bf16 v[108:123], v[96:99], v[40:43], v[108:123]
    ds_read_b64_tr_b16 v[96:97], v14 offset:4800
    ds_read_b64_tr_b16 v[98:99], v14 offset:5952
    s_waitcnt lgkmcnt(10)
    v_mfma_f32_32x32x16_bf16 v[124:139], v[100:103], v[40:43], v[124:139]
    ds_read_b64_tr_b16 v[100:101], v14 offset:4832
    ds_read_b64_tr_b16 v[102:103], v14 offset:5984
    s_waitcnt lgkmcnt(10)
    v_mfma_f32_32x32x16_bf16 v[140:155], v[104:107], v[40:43], v[140:155]
    ds_read_b64_tr_b16 v[104:105], v14 offset:4864
    ds_read_b64_tr_b16 v[106:107], v14 offset:6016
    s_waitcnt lgkmcnt(10)
    v_mfma_f32_32x32x16_bf16 v[156:171], v[84:87], v[40:43], v[156:171]
    s_add_u32 m0, s76, 3072
    s_nop 0
    buffer_load_dwordx4 v10, s[12:15], s79 offen lds
    ds_read_b64_tr_b16 v[84:85], v14 offset:9216
    ds_read_b64_tr_b16 v[86:87], v14 offset:10368
    s_waitcnt lgkmcnt(10)
    v_mfma_f32_32x32x16_bf16 v[172:187], v[88:91], v[40:43], v[172:187]
    ds_read_b64_tr_b16 v[88:89], v14 offset:9248
    ds_read_b64_tr_b16 v[90:91], v14 offset:10400
    s_waitcnt lgkmcnt(10)
    v_mfma_f32_32x32x16_bf16 v[188:203], v[92:95], v[40:43], v[188:203]
    ds_read_b64_tr_b16 v[92:93], v14 offset:9280
    ds_read_b64_tr_b16 v[94:95], v14 offset:10432
    s_waitcnt lgkmcnt(10)
    v_mfma_f32_32x32x16_bf16 v[204:219], v[96:99], v[40:43], v[204:219]
    s_add_u32 m0, s76, 4096
    s_mov_b64 exec, 0xffffffff
    buffer_load_dwordx4 v11, s[12:15], s79 offen lds
    s_mov_b64 exec, -1
    ds_read_b64_tr_b16 v[96:97], v14 offset:9312
    ds_read_b64_tr_b16 v[98:99], v14 offset:10464
    s_waitcnt lgkmcnt(10)
    v_mfma_f32_32x32x16_bf16 v[220:235], v[100:103], v[40:43], v[220:235]
    ds_read_b64_tr_b16 v[100:101], v14 offset:9344
    ds_read_b64_tr_b16 v[102:103], v14 offset:10496
    s_waitcnt lgkmcnt(10)
    v_mfma_f32_32x32x16_bf16 v[236:251], v[104:107], v[40:43], v[236:251]
    ds_read_b64_tr_b16 v[104:105], v14 offset:9376
    ds_read_b64_tr_b16 v[106:107], v14 offset:10528
    s_waitcnt lgkmcnt(10)
    v_mfma_f32_32x32x16_bf16 v[108:123], v[84:87], v[44:47], v[108:123]
    ds_read_b64_tr_b16 v[84:85], v14 offset:9408
    ds_read_b64_tr_b16 v[86:87], v14 offset:10560
    s_waitcnt lgkmcnt(10)
    v_mfma_f32_32x32x16_bf16 v[124:139], v[88:91], v[44:47], v[124:139]
    s_lshl_b32 s52, s47, 12
    s_add_u32 s52, s52, s44
    s_add_u32 s47, s47, 1
    s_cmp_ge_u32 s47, 9
    s_cselect_b32 s47, 0, s47
    buffer_load_dwordx4 v[20:23], v12, s[28:31], s52 offen offset:0
    ds_read_b64_tr_b16 v[88:89], v14 offset:9440
    ds_read_b64_tr_b16 v[90:91], v14 offset:10592
    s_waitcnt lgkmcnt(10)
    v_mfma_f32_32x32x16_bf16 v[140:155], v[92:95], v[44:47], v[140:155]
    ds_read_b64_tr_b16 v[92:93], v14 offset:9472
    ds_read_b64_tr_b16 v[94:95], v14 offset:10624
    s_waitcnt lgkmcnt(10)
    v_mfma_f32_32x32x16_bf16 v[156:171], v[96:99], v[44:47], v[156:171]
    ds_read_b64_tr_b16 v[96:97], v14 offset:13824
    ds_read_b64_tr_b16 v[98:99], v14 offset:14976
    s_waitcnt lgkmcnt(10)
    v_mfma_f32_32x32x16_bf16 v[172:187], v[100:103], v[44:47], v[172:187]
    ds_read_b64_tr_b16 v[100:101], v14 offset:13856
    ds_read_b64_tr_b16 v[102:103], v14 offset:15008
    s_waitcnt lgkmcnt(10)
    v_mfma_f32_32x32x16_bf16 v[188:203], v[104:107], v[44:47], v[188:203]
    buffer_load_dwordx4 v[24:27], v12, s[28:31], s52 offen offset:1024
    ds_read_b64_tr_b16 v[104:105], v14 offset:13888
    ds_read_b64_tr_b16 v[106:107], v14 offset:15040
    s_waitcnt lgkmcnt(10)
    v_mfma_f32_32x32x16_bf16 v[204:219], v[84:87], v[44:47], v[204:219]
    ds_read_b64_tr_b16 v[84:85], v14 offset:13920
    ds_read_b64_tr_b16 v[86:87], v14 offset:15072
    s_waitcnt lgkmcnt(10)
    v_mfma_f32_32x32x16_bf16 v[220:235], v[88:91], v[44:47], v[220:235]
    ds_read_b64_tr_b16 v[88:89], v14 offset:13952
    ds_read_b64_tr_b16 v[90:91], v14 offset:15104
    s_waitcnt lgkmcnt(10)
    v_mfma_f32_32x32x16_bf16 v[236:251], v[92:95], v[44:47], v[236:251]
    buffer_load_dwordx4 v[28:31], v12, s[28:31], s52 offen offset:2048
    ds_read_b64_tr_b16 v[92:93], v14 offset:13984
    ds_read_b64_tr_b16 v[94:95], v14 offset:15136
    s_waitcnt lgkmcnt(10)
    v_mfma_f32_32x32x16_bf16 v[108:123], v[96:99], v[48:51], v[108:123]
    ds_read_b64_tr_b16 v[96:97], v14 offset:14016
    ds_read_b64_tr_b16 v[98:99], v14 offset:15168
    s_waitcnt lgkmcnt(10)
    v_mfma_f32_32x32x16_bf16 v[124:139], v[100:103], v[48:51], v[124:139]
    ds_read_b64_tr_b16 v[100:101], v14 offset:14048
    ds_read_b64_tr_b16 v[102:103], v14 offset:15200
    s_waitcnt lgkmcnt(10)
    v_mfma_f32_32x32x16_bf16 v[140:155], v[104:107], v[48:51], v[140:155]
    ds_read_b64_tr_b16 v[104:105], v14 offset:14080
    ds_read_b64_tr_b16 v[106:107], v14 offset:15232
    s_waitcnt lgkmcnt(10)
    v_mfma_f32_32x32x16_bf16 v[156:171], v[84:87], v[48:51], v[156:171]
    buffer_load_dwordx4 v[32:35], v12, s[28:31], s52 offen offset:3072
    ds_read_b64_tr_b16 v[84:85], v15 offset:0
    ds_read_b64_tr_b16 v[86:87], v15 offset:1152
    s_waitcnt lgkmcnt(10)
    v_mfma_f32_32x32x16_bf16 v[172:187], v[88:91], v[48:51], v[172:187]
    ds_read_b64_tr_b16 v[88:89], v15 offset:4608
    ds_read_b64_tr_b16 v[90:91], v15 offset:5760
    s_waitcnt lgkmcnt(10)
    v_mfma_f32_32x32x16_bf16 v[188:203], v[92:95], v[48:51], v[188:203]
    ds_read_b64_tr_b16 v[92:93], v15 offset:9216
    ds_read_b64_tr_b16 v[94:95], v15 offset:10368
    s_waitcnt lgkmcnt(10)
    v_mfma_f32_32x32x16_bf16 v[204:219], v[96:99], v[48:51], v[204:219]
    ds_read_b64_tr_b16 v[96:97], v15 offset:13824
    ds_read_b64_tr_b16 v[98:99], v15 offset:14976
    s_waitcnt lgkmcnt(10)
    v_mfma_f32_32x32x16_bf16 v[220:235], v[100:103], v[48:51], v[220:235]
    ds_read_b64_tr_b16 v[100:101], v16 offset:0
    ds_read_b64_tr_b16 v[102:103], v16 offset:1152
    s_waitcnt lgkmcnt(10)
    v_mfma_f32_32x32x16_bf16 v[236:251], v[104:107], v[48:51], v[236:251]
    s_waitcnt vmcnt(0)
    s_barrier
    ds_read_b64_tr_b16 v[104:105], v16 offset:4608
    ds_read_b64_tr_b16 v[106:107], v16 offset:5760
    s_waitcnt lgkmcnt(10)
    v_mfma_f32_32x32x16_bf16 v[108:123], v[84:87], v[52:55], v[108:123]
    ds_read_b64_tr_b16 v[84:85], v16 offset:9216
    ds_read_b64_tr_b16 v[86:87], v16 offset:10368
    s_waitcnt lgkmcnt(10)
    v_mfma_f32_32x32x16_bf16 v[108:123], v[88:91], v[56:59], v[108:123]
    v_add_u32 v1, 0, v0
    v_mul_u32_u24 v2, 3641, v1
    v_lshrrev_b32 v2, 16, v2
    v_mul_u32_u24 v7, 18, v2
    v_sub_u32 v1, v1, v7
    v_mul_u32_u24 v7, 1152, v2
    v_lshl_add_u32 v7, v1, 4, v7
    v_add_u32 v1, 64, v0
    v_mul_u32_u24 v2, 3641, v1
    v_lshrrev_b32 v2, 16, v2
    v_mul_u32_u24 v8, 18, v2
    v_sub_u32 v1, v1, v8
    v_mul_u32_u24 v8, 1152, v2
    v_lshl_add_u32 v8, v1, 4, v8
    v_add_u32 v1, 128, v0
    v_mul_u32_u24 v2, 3641, v1
    v_lshrrev_b32 v2, 16, v2
    v_mul_u32_u24 v9, 18, v2
    v_sub_u32 v1, v1, v9
    v_mul_u32_u24 v9, 1152, v2
    v_lshl_add_u32 v9, v1, 4, v9
    v_add_u32 v1, 192, v0
    v_mul_u32_u24 v2, 3641, v1
    v_lshrrev_b32 v2, 16, v2
    v_mul_u32_u24 v10, 18, v2
    v_sub_u32 v1, v1, v10
    v_mul_u32_u24 v10, 1152, v2
    v_lshl_add_u32 v10, v1, 4, v10
    v_add_u32 v1, 256, v0
    v_mul_u32_u24 v2, 3641, v1
    v_lshrrev_b32 v2, 16, v2
    v_mul_u32_u24 v11, 18, v2
    v_sub_u32 v1, v1, v11
    v_mul_u32_u24 v11, 1152, v2
    v_lshl_add_u32 v11, v1, 4, v11
    s_lshr_b32 s83, s24, 2
    s_mul_i32 s80, s83, 18432
    s_and_b32 s82, s24, 3
    s_mul_i32 s81, s82, 4608
    s_add_u32 s80, s80, s81
    s_bfe_u32 s81, s2, 0x20001
    s_mul_i32 s81, s81, 1152
    s_mul_i32 s83, s83, 576
    s_add_u32 s81, s81, s83
    s_lshl_b32 s82, s82, 4
    s_add_u32 s81, s81, s82
    s_mul_i32 s81, s81, 1152
    s_lshr_b32 s82, s2, 6
    s_mul_i32 s83, s82, 288
    s_add_u32 s81, s81, s83
    s_lshl_b32 s82, s82, 1
    s_bfe_u32 s83, s2, 0x30003
    s_add_u32 s82, s82, s83
    s_cmp_ge_u32 s82, 9
    s_cselect_b32 s83, 9, 0
    s_sub_u32 s82, s82, s83
    s_bfe_u32 s82, s2, 0x30003
    s_mov_b32 s25, s82
    ds_read_b64_tr_b16 v[88:89], v16 offset:13824
    ds_read_b64_tr_b16 v[90:91], v16 offset:14976
    s_waitcnt lgkmcnt(10)
    v_mfma_f32_32x32x16_bf16 v[108:123], v[92:95], v[60:63], v[108:123]
    ds_read_b64_tr_b16 v[92:93], v13 offset:0
    ds_read_b64_tr_b16 v[94:95], v13 offset:1152
    s_waitcnt lgkmcnt(10)
    v_mfma_f32_32x32x16_bf16 v[108:123], v[96:99], v[64:67], v[108:123]
    s_mul_i32 s83, s82, 73728
    s_add_u32 s83, s83, s81
    s_add_u32 s82, s82, 1
    s_cmp_ge_u32 s82, 9
    s_cselect_b32 s82, 0, s82
    s_add_u32 m0, s80, 36992
    s_nop 0
    buffer_load_dwordx4 v7, s[16:19], s83 offen lds
    ds_read_b64_tr_b16 v[96:97], v13 offset:4608
    ds_read_b64_tr_b16 v[98:99], v13 offset:5760
    s_waitcnt lgkmcnt(10)
    v_mfma_f32_32x32x16_bf16 v[108:123], v[100:103], v[68:71], v[108:123]
    ds_read_b64_tr_b16 v[100:101], v13 offset:9216
    ds_read_b64_tr_b16 v[102:103], v13 offset:10368
    s_waitcnt lgkmcnt(10)
    v_mfma_f32_32x32x16_bf16 v[108:123], v[104:107], v[72:75], v[108:123]
    s_add_u32 m0, s80, 38016
    s_nop 0
    buffer_load_dwordx4 v8, s[16:19], s83 offen lds
    ds_read_b64_tr_b16 v[104:105], v13 offset:13824
    ds_read_b64_tr_b16 v[106:107], v13 offset:14976
    s_waitcnt lgkmcnt(10)
    v_mfma_f32_32x32x16_bf16 v[108:123], v[84:87], v[76:79], v[108:123]
    ds_read_b64_tr_b16 v[84:85], v15 offset:32
    ds_read_b64_tr_b16 v[86:87], v15 offset:1184
    s_waitcnt lgkmcnt(10)
    v_mfma_f32_32x32x16_bf16 v[108:123], v[88:91], v[80:83], v[108:123]
    s_add_u32 m0, s80, 39040
    s_nop 0
    buffer_load_dwordx4 v9, s[16:19], s83 offen lds
    ds_read_b64_tr_b16 v[88:89], v15 offset:4640
    ds_read_b64_tr_b16 v[90:91], v15 offset:5792
    s_waitcnt lgkmcnt(10)
    v_mfma_f32_32x32x16_bf16 v[108:123], v[92:95], v[20:23], v[108:123]
    ds_read_b64_tr_b16 v[92:93], v15 offset:9248
    ds_read_b64_tr_b16 v[94:95], v15 offset:10400
    s_waitcnt lgkmcnt(10)
    v_mfma_f32_32x32x16_bf16 v[108:123], v[96:99], v[24:27], v[108:123]
    s_add_u32 m0, s80, 40064
    s_nop 0
    buffer_load_dwordx4 v10, s[16:19], s83 offen lds
    ds_read_b64_tr_b16 v[96:97], v15 offset:13856
    ds_read_b64_tr_b16 v[98:99], v15 offset:15008
    s_waitcnt lgkmcnt(10)
    v_mfma_f32_32x32x16_bf16 v[108:123], v[100:103], v[28:31], v[108:123]
    ds_read_b64_tr_b16 v[100:101], v16 offset:32
    ds_read_b64_tr_b16 v[102:103], v16 offset:1184
    s_waitcnt lgkmcnt(10)
    v_mfma_f32_32x32x16_bf16 v[108:123], v[104:107], v[32:35], v[108:123]
    s_add_u32 m0, s80, 41088
    s_mov_b64 exec, 0xffffffff
    buffer_load_dwordx4 v11, s[16:19], s83 offen lds
    s_mov_b64 exec, -1
    ds_read_b64_tr_b16 v[104:105], v16 offset:4640
    ds_read_b64_tr_b16 v[106:107], v16 offset:5792
    s_waitcnt lgkmcnt(10)
    v_mfma_f32_32x32x16_bf16 v[124:139], v[84:87], v[52:55], v[124:139]
    ds_read_b64_tr_b16 v[84:85], v16 offset:9248
    ds_read_b64_tr_b16 v[86:87], v16 offset:10400
    s_waitcnt lgkmcnt(10)
    v_mfma_f32_32x32x16_bf16 v[124:139], v[88:91], v[56:59], v[124:139]
    ds_read_b64_tr_b16 v[88:89], v16 offset:13856
    ds_read_b64_tr_b16 v[90:91], v16 offset:15008
    s_waitcnt lgkmcnt(10)
    v_mfma_f32_32x32x16_bf16 v[124:139], v[92:95], v[60:63], v[124:139]
    ds_read_b64_tr_b16 v[92:93], v13 offset:32
    ds_read_b64_tr_b16 v[94:95], v13 offset:1184
    s_waitcnt lgkmcnt(10)
    v_mfma_f32_32x32x16_bf16 v[124:139], v[96:99], v[64:67], v[124:139]
    v_mul_f32 v1, 3216550459, v108
    v_mul_f32 v2, 3216550459, v109
    v_exp_f32 v1, v1
    v_exp_f32 v2, v2
    v_mul_f32 v108, v108, v112
    v_mul_f32 v109, v109, v113
    v_add_f32 v1, 1.0, v1
    v_add_f32 v2, 1.0, v2
    v_rcp_f32 v1, v1
    v_rcp_f32 v2, v2
    s_nop 0
    v_mul_f32 v108, v108, v1
    v_mul_f32 v109, v109, v2
    v_cvt_pk_bf16_f32 v112, v108, v109
    ds_read_b64_tr_b16 v[96:97], v13 offset:4640
    ds_read_b64_tr_b16 v[98:99], v13 offset:5792
    s_waitcnt lgkmcnt(10)
    v_mfma_f32_32x32x16_bf16 v[124:139], v[100:103], v[68:71], v[124:139]
    ds_read_b64_tr_b16 v[100:101], v13 offset:9248
    ds_read_b64_tr_b16 v[102:103], v13 offset:10400
    s_waitcnt lgkmcnt(10)
    v_mfma_f32_32x32x16_bf16 v[124:139], v[104:107], v[72:75], v[124:139]
    v_mul_f32 v1, 3216550459, v110
    v_mul_f32 v2, 3216550459, v111
    v_exp_f32 v1, v1
    v_exp_f32 v2, v2
    v_mul_f32 v110, v110, v114
    v_mul_f32 v111, v111, v115
    v_add_f32 v1, 1.0, v1
    v_add_f32 v2, 1.0, v2
    v_rcp_f32 v1, v1
    v_rcp_f32 v2, v2
    s_nop 0
    v_mul_f32 v110, v110, v1
    v_mul_f32 v111, v111, v2
    v_cvt_pk_bf16_f32 v113, v110, v111
    ds_read_b64_tr_b16 v[104:105], v13 offset:13856
    ds_read_b64_tr_b16 v[106:107], v13 offset:15008
    s_waitcnt lgkmcnt(10)
    v_mfma_f32_32x32x16_bf16 v[124:139], v[84:87], v[76:79], v[124:139]
    ds_read_b64_tr_b16 v[84:85], v15 offset:64
    ds_read_b64_tr_b16 v[86:87], v15 offset:1216
    s_waitcnt lgkmcnt(10)
    v_mfma_f32_32x32x16_bf16 v[124:139], v[88:91], v[80:83], v[124:139]
    v_mul_f32 v1, 3216550459, v116
    v_mul_f32 v2, 3216550459, v117
    v_exp_f32 v1, v1
    v_exp_f32 v2, v2
    v_mul_f32 v116, v116, v120
    v_mul_f32 v117, v117, v121
    v_add_f32 v1, 1.0, v1
    v_add_f32 v2, 1.0, v2
    v_rcp_f32 v1, v1
    v_rcp_f32 v2, v2
    s_nop 0
    v_mul_f32 v116, v116, v1
    v_mul_f32 v117, v117, v2
    v_cvt_pk_bf16_f32 v114, v116, v117
    ds_read_b64_tr_b16 v[88:89], v15 offset:4672
    ds_read_b64_tr_b16 v[90:91], v15 offset:5824
    s_waitcnt lgkmcnt(10)
    v_mfma_f32_32x32x16_bf16 v[124:139], v[92:95], v[20:23], v[124:139]
    ds_read_b64_tr_b16 v[92:93], v15 offset:9280
    ds_read_b64_tr_b16 v[94:95], v15 offset:10432
    s_waitcnt lgkmcnt(10)
    v_mfma_f32_32x32x16_bf16 v[124:139], v[96:99], v[24:27], v[124:139]
    v_mul_f32 v1, 3216550459, v118
    v_mul_f32 v2, 3216550459, v119
    v_exp_f32 v1, v1
    v_exp_f32 v2, v2
    v_mul_f32 v118, v118, v122
    v_mul_f32 v119, v119, v123
    v_add_f32 v1, 1.0, v1
    v_add_f32 v2, 1.0, v2
    v_rcp_f32 v1, v1
    v_rcp_f32 v2, v2
    s_nop 0
    v_mul_f32 v118, v118, v1
    v_mul_f32 v119, v119, v2
    v_cvt_pk_bf16_f32 v115, v118, v119
    ds_read_b64_tr_b16 v[96:97], v15 offset:13888
    ds_read_b64_tr_b16 v[98:99], v15 offset:15040
    s_waitcnt lgkmcnt(10)
    v_mfma_f32_32x32x16_bf16 v[124:139], v[100:103], v[28:31], v[124:139]
    ds_read_b64_tr_b16 v[100:101], v16 offset:64
    ds_read_b64_tr_b16 v[102:103], v16 offset:1216
    s_waitcnt lgkmcnt(10)
    v_mfma_f32_32x32x16_bf16 v[124:139], v[104:107], v[32:35], v[124:139]
    s_add_u32 s48, s50, 0
    s_lshr_b32 s49, s48, 1
    s_lshl_b32 s49, s49, 17
    s_and_b32 s48, s48, 1
    s_lshl_b32 s48, s48, 9
    s_add_u32 s49, s49, s48
    s_add_u32 s49, s49, s51
    buffer_store_dwordx4 v[112:115], v17, s[28:31], s49 offen sc1
    ds_read_b64_tr_b16 v[104:105], v16 offset:4672
    ds_read_b64_tr_b16 v[106:107], v16 offset:5824
    s_waitcnt lgkmcnt(10)
    v_mfma_f32_32x32x16_bf16 v[140:155], v[84:87], v[52:55], v[140:155]
    ds_read_b64_tr_b16 v[84:85], v16 offset:9280
    ds_read_b64_tr_b16 v[86:87], v16 offset:10432
    s_waitcnt lgkmcnt(10)
    v_mfma_f32_32x32x16_bf16 v[140:155], v[88:91], v[56:59], v[140:155]
    ds_read_b64_tr_b16 v[88:89], v16 offset:13888
    ds_read_b64_tr_b16 v[90:91], v16 offset:15040
    s_waitcnt lgkmcnt(10)
    v_mfma_f32_32x32x16_bf16 v[140:155], v[92:95], v[60:63], v[140:155]
    ds_read_b64_tr_b16 v[92:93], v13 offset:64
    ds_read_b64_tr_b16 v[94:95], v13 offset:1216
    s_waitcnt lgkmcnt(10)
    v_mfma_f32_32x32x16_bf16 v[140:155], v[96:99], v[64:67], v[140:155]
    v_mul_f32 v1, 3216550459, v124
    v_mul_f32 v2, 3216550459, v125
    v_exp_f32 v1, v1
    v_exp_f32 v2, v2
    v_mul_f32 v124, v124, v128
    v_mul_f32 v125, v125, v129
    v_add_f32 v1, 1.0, v1
    v_add_f32 v2, 1.0, v2
    v_rcp_f32 v1, v1
    v_rcp_f32 v2, v2
    s_nop 0
    v_mul_f32 v124, v124, v1
    v_mul_f32 v125, v125, v2
    v_cvt_pk_bf16_f32 v128, v124, v125
    ds_read_b64_tr_b16 v[96:97], v13 offset:4672
    ds_read_b64_tr_b16 v[98:99], v13 offset:5824
    s_waitcnt lgkmcnt(10)
    v_mfma_f32_32x32x16_bf16 v[140:155], v[100:103], v[68:71], v[140:155]
    ds_read_b64_tr_b16 v[100:101], v13 offset:9280
    ds_read_b64_tr_b16 v[102:103], v13 offset:10432
    s_waitcnt lgkmcnt(10)
    v_mfma_f32_32x32x16_bf16 v[140:155], v[104:107], v[72:75], v[140:155]
    v_mul_f32 v1, 3216550459, v126
    v_mul_f32 v2, 3216550459, v127
    v_exp_f32 v1, v1
    v_exp_f32 v2, v2
    v_mul_f32 v126, v126, v130
    v_mul_f32 v127, v127, v131
    v_add_f32 v1, 1.0, v1
    v_add_f32 v2, 1.0, v2
    v_rcp_f32 v1, v1
    v_rcp_f32 v2, v2
    s_nop 0
    v_mul_f32 v126, v126, v1
    v_mul_f32 v127, v127, v2
    v_cvt_pk_bf16_f32 v129, v126, v127
    ds_read_b64_tr_b16 v[104:105], v13 offset:13888
    ds_read_b64_tr_b16 v[106:107], v13 offset:15040
    s_waitcnt lgkmcnt(10)
    v_mfma_f32_32x32x16_bf16 v[140:155], v[84:87], v[76:79], v[140:155]
    ds_read_b64_tr_b16 v[84:85], v15 offset:96
    ds_read_b64_tr_b16 v[86:87], v15 offset:1248
    s_waitcnt lgkmcnt(10)
    v_mfma_f32_32x32x16_bf16 v[140:155], v[88:91], v[80:83], v[140:155]
    v_mul_f32 v1, 3216550459, v132
    v_mul_f32 v2, 3216550459, v133
    v_exp_f32 v1, v1
    v_exp_f32 v2, v2
    v_mul_f32 v132, v132, v136
    v_mul_f32 v133, v133, v137
    v_add_f32 v1, 1.0, v1
    v_add_f32 v2, 1.0, v2
    v_rcp_f32 v1, v1
    v_rcp_f32 v2, v2
    s_nop 0
    v_mul_f32 v132, v132, v1
    v_mul_f32 v133, v133, v2
    v_cvt_pk_bf16_f32 v130, v132, v133
    ds_read_b64_tr_b16 v[88:89], v15 offset:4704
    ds_read_b64_tr_b16 v[90:91], v15 offset:5856
    s_waitcnt lgkmcnt(10)
    v_mfma_f32_32x32x16_bf16 v[140:155], v[92:95], v[20:23], v[140:155]
    ds_read_b64_tr_b16 v[92:93], v15 offset:9312
    ds_read_b64_tr_b16 v[94:95], v15 offset:10464
    s_waitcnt lgkmcnt(10)
    v_mfma_f32_32x32x16_bf16 v[140:155], v[96:99], v[24:27], v[140:155]
    v_mul_f32 v1, 3216550459, v134
    v_mul_f32 v2, 3216550459, v135
    v_exp_f32 v1, v1
    v_exp_f32 v2, v2
    v_mul_f32 v134, v134, v138
    v_mul_f32 v135, v135, v139
    v_add_f32 v1, 1.0, v1
    v_add_f32 v2, 1.0, v2
    v_rcp_f32 v1, v1
    v_rcp_f32 v2, v2
    s_nop 0
    v_mul_f32 v134, v134, v1
    v_mul_f32 v135, v135, v2
    v_cvt_pk_bf16_f32 v131, v134, v135
    ds_read_b64_tr_b16 v[96:97], v15 offset:13920
    ds_read_b64_tr_b16 v[98:99], v15 offset:15072
    s_waitcnt lgkmcnt(10)
    v_mfma_f32_32x32x16_bf16 v[140:155], v[100:103], v[28:31], v[140:155]
    ds_read_b64_tr_b16 v[100:101], v16 offset:96
    ds_read_b64_tr_b16 v[102:103], v16 offset:1248
    s_waitcnt lgkmcnt(10)
    v_mfma_f32_32x32x16_bf16 v[140:155], v[104:107], v[32:35], v[140:155]
    s_add_u32 s48, s50, 1
    s_lshr_b32 s49, s48, 1
    s_lshl_b32 s49, s49, 17
    s_and_b32 s48, s48, 1
    s_lshl_b32 s48, s48, 9
    s_add_u32 s49, s49, s48
    s_add_u32 s49, s49, s51
    buffer_store_dwordx4 v[128:131], v17, s[28:31], s49 offen sc1
    ds_read_b64_tr_b16 v[104:105], v16 offset:4704
    ds_read_b64_tr_b16 v[106:107], v16 offset:5856
    s_waitcnt lgkmcnt(10)
    v_mfma_f32_32x32x16_bf16 v[156:171], v[84:87], v[52:55], v[156:171]
    ds_read_b64_tr_b16 v[84:85], v16 offset:9312
    ds_read_b64_tr_b16 v[86:87], v16 offset:10464
    s_waitcnt lgkmcnt(10)
    v_mfma_f32_32x32x16_bf16 v[156:171], v[88:91], v[56:59], v[156:171]
    ds_read_b64_tr_b16 v[88:89], v16 offset:13920
    ds_read_b64_tr_b16 v[90:91], v16 offset:15072
    s_waitcnt lgkmcnt(10)
    v_mfma_f32_32x32x16_bf16 v[156:171], v[92:95], v[60:63], v[156:171]
    ds_read_b64_tr_b16 v[92:93], v13 offset:96
    ds_read_b64_tr_b16 v[94:95], v13 offset:1248
    s_waitcnt lgkmcnt(10)
    v_mfma_f32_32x32x16_bf16 v[156:171], v[96:99], v[64:67], v[156:171]
    v_mul_f32 v1, 3216550459, v140
    v_mul_f32 v2, 3216550459, v141
    v_exp_f32 v1, v1
    v_exp_f32 v2, v2
    v_mul_f32 v140, v140, v144
    v_mul_f32 v141, v141, v145
    v_add_f32 v1, 1.0, v1
    v_add_f32 v2, 1.0, v2
    v_rcp_f32 v1, v1
    v_rcp_f32 v2, v2
    s_nop 0
    v_mul_f32 v140, v140, v1
    v_mul_f32 v141, v141, v2
    v_cvt_pk_bf16_f32 v144, v140, v141
    ds_read_b64_tr_b16 v[96:97], v13 offset:4704
    ds_read_b64_tr_b16 v[98:99], v13 offset:5856
    s_waitcnt lgkmcnt(10)
    v_mfma_f32_32x32x16_bf16 v[156:171], v[100:103], v[68:71], v[156:171]
    ds_read_b64_tr_b16 v[100:101], v13 offset:9312
    ds_read_b64_tr_b16 v[102:103], v13 offset:10464
    s_waitcnt lgkmcnt(10)
    v_mfma_f32_32x32x16_bf16 v[156:171], v[104:107], v[72:75], v[156:171]
    v_mul_f32 v1, 3216550459, v142
    v_mul_f32 v2, 3216550459, v143
    v_exp_f32 v1, v1
    v_exp_f32 v2, v2
    v_mul_f32 v142, v142, v146
    v_mul_f32 v143, v143, v147
    v_add_f32 v1, 1.0, v1
    v_add_f32 v2, 1.0, v2
    v_rcp_f32 v1, v1
    v_rcp_f32 v2, v2
    s_nop 0
    v_mul_f32 v142, v142, v1
    v_mul_f32 v143, v143, v2
    v_cvt_pk_bf16_f32 v145, v142, v143
    ds_read_b64_tr_b16 v[104:105], v13 offset:13920
    ds_read_b64_tr_b16 v[106:107], v13 offset:15072
    s_waitcnt lgkmcnt(10)
    v_mfma_f32_32x32x16_bf16 v[156:171], v[84:87], v[76:79], v[156:171]
    ds_read_b64_tr_b16 v[84:85], v15 offset:128
    ds_read_b64_tr_b16 v[86:87], v15 offset:1280
    s_waitcnt lgkmcnt(10)
    v_mfma_f32_32x32x16_bf16 v[156:171], v[88:91], v[80:83], v[156:171]
    v_mul_f32 v1, 3216550459, v148
    v_mul_f32 v2, 3216550459, v149
    v_exp_f32 v1, v1
    v_exp_f32 v2, v2
    v_mul_f32 v148, v148, v152
    v_mul_f32 v149, v149, v153
    v_add_f32 v1, 1.0, v1
    v_add_f32 v2, 1.0, v2
    v_rcp_f32 v1, v1
    v_rcp_f32 v2, v2
    s_nop 0
    v_mul_f32 v148, v148, v1
    v_mul_f32 v149, v149, v2
    v_cvt_pk_bf16_f32 v146, v148, v149
    ds_read_b64_tr_b16 v[88:89], v15 offset:4736
    ds_read_b64_tr_b16 v[90:91], v15 offset:5888
    s_waitcnt lgkmcnt(10)
    v_mfma_f32_32x32x16_bf16 v[156:171], v[92:95], v[20:23], v[156:171]
    ds_read_b64_tr_b16 v[92:93], v15 offset:9344
    ds_read_b64_tr_b16 v[94:95], v15 offset:10496
    s_waitcnt lgkmcnt(10)
    v_mfma_f32_32x32x16_bf16 v[156:171], v[96:99], v[24:27], v[156:171]
    v_mul_f32 v1, 3216550459, v150
    v_mul_f32 v2, 3216550459, v151
    v_exp_f32 v1, v1
    v_exp_f32 v2, v2
    v_mul_f32 v150, v150, v154
    v_mul_f32 v151, v151, v155
    v_add_f32 v1, 1.0, v1
    v_add_f32 v2, 1.0, v2
    v_rcp_f32 v1, v1
    v_rcp_f32 v2, v2
    s_nop 0
    v_mul_f32 v150, v150, v1
    v_mul_f32 v151, v151, v2
    v_cvt_pk_bf16_f32 v147, v150, v151
    ds_read_b64_tr_b16 v[96:97], v15 offset:13952
    ds_read_b64_tr_b16 v[98:99], v15 offset:15104
    s_waitcnt lgkmcnt(10)
    v_mfma_f32_32x32x16_bf16 v[156:171], v[100:103], v[28:31], v[156:171]
    ds_read_b64_tr_b16 v[100:101], v16 offset:128
    ds_read_b64_tr_b16 v[102:103], v16 offset:1280
    s_waitcnt lgkmcnt(10)
    v_mfma_f32_32x32x16_bf16 v[156:171], v[104:107], v[32:35], v[156:171]
    s_add_u32 s48, s50, 2
    s_lshr_b32 s49, s48, 1
    s_lshl_b32 s49, s49, 17
    s_and_b32 s48, s48, 1
    s_lshl_b32 s48, s48, 9
    s_add_u32 s49, s49, s48
    s_add_u32 s49, s49, s51
    buffer_store_dwordx4 v[144:147], v17, s[28:31], s49 offen sc1
    ds_read_b64_tr_b16 v[104:105], v16 offset:4736
    ds_read_b64_tr_b16 v[106:107], v16 offset:5888
    s_waitcnt lgkmcnt(10)
    v_mfma_f32_32x32x16_bf16 v[172:187], v[84:87], v[52:55], v[172:187]
    ds_read_b64_tr_b16 v[84:85], v16 offset:9344
    ds_read_b64_tr_b16 v[86:87], v16 offset:10496
    s_waitcnt lgkmcnt(10)
    v_mfma_f32_32x32x16_bf16 v[172:187], v[88:91], v[56:59], v[172:187]
    ds_read_b64_tr_b16 v[88:89], v16 offset:13952
    ds_read_b64_tr_b16 v[90:91], v16 offset:15104
    s_waitcnt lgkmcnt(10)
    v_mfma_f32_32x32x16_bf16 v[172:187], v[92:95], v[60:63], v[172:187]
    ds_read_b64_tr_b16 v[92:93], v13 offset:128
    ds_read_b64_tr_b16 v[94:95], v13 offset:1280
    s_waitcnt lgkmcnt(10)
    v_mfma_f32_32x32x16_bf16 v[172:187], v[96:99], v[64:67], v[172:187]
    v_mul_f32 v1, 3216550459, v156
    v_mul_f32 v2, 3216550459, v157
    v_exp_f32 v1, v1
    v_exp_f32 v2, v2
    v_mul_f32 v156, v156, v160
    v_mul_f32 v157, v157, v161
    v_add_f32 v1, 1.0, v1
    v_add_f32 v2, 1.0, v2
    v_rcp_f32 v1, v1
    v_rcp_f32 v2, v2
    s_nop 0
    v_mul_f32 v156, v156, v1
    v_mul_f32 v157, v157, v2
    v_cvt_pk_bf16_f32 v160, v156, v157
    ds_read_b64_tr_b16 v[96:97], v13 offset:4736
    ds_read_b64_tr_b16 v[98:99], v13 offset:5888
    s_waitcnt lgkmcnt(10)
    v_mfma_f32_32x32x16_bf16 v[172:187], v[100:103], v[68:71], v[172:187]
    ds_read_b64_tr_b16 v[100:101], v13 offset:9344
    ds_read_b64_tr_b16 v[102:103], v13 offset:10496
    s_waitcnt lgkmcnt(10)
    v_mfma_f32_32x32x16_bf16 v[172:187], v[104:107], v[72:75], v[172:187]
    v_mul_f32 v1, 3216550459, v158
    v_mul_f32 v2, 3216550459, v159
    v_exp_f32 v1, v1
    v_exp_f32 v2, v2
    v_mul_f32 v158, v158, v162
    v_mul_f32 v159, v159, v163
    v_add_f32 v1, 1.0, v1
    v_add_f32 v2, 1.0, v2
    v_rcp_f32 v1, v1
    v_rcp_f32 v2, v2
    s_nop 0
    v_mul_f32 v158, v158, v1
    v_mul_f32 v159, v159, v2
    v_cvt_pk_bf16_f32 v161, v158, v159
    ds_read_b64_tr_b16 v[104:105], v13 offset:13952
    ds_read_b64_tr_b16 v[106:107], v13 offset:15104
    s_waitcnt lgkmcnt(10)
    v_mfma_f32_32x32x16_bf16 v[172:187], v[84:87], v[76:79], v[172:187]
    ds_read_b64_tr_b16 v[84:85], v15 offset:160
    ds_read_b64_tr_b16 v[86:87], v15 offset:1312
    s_waitcnt lgkmcnt(10)
    v_mfma_f32_32x32x16_bf16 v[172:187], v[88:91], v[80:83], v[172:187]
    v_mul_f32 v1, 3216550459, v164
    v_mul_f32 v2, 3216550459, v165
    v_exp_f32 v1, v1
    v_exp_f32 v2, v2
    v_mul_f32 v164, v164, v168
    v_mul_f32 v165, v165, v169
    v_add_f32 v1, 1.0, v1
    v_add_f32 v2, 1.0, v2
    v_rcp_f32 v1, v1
    v_rcp_f32 v2, v2
    s_nop 0
    v_mul_f32 v164, v164, v1
    v_mul_f32 v165, v165, v2
    v_cvt_pk_bf16_f32 v162, v164, v165
    ds_read_b64_tr_b16 v[88:89], v15 offset:4768
    ds_read_b64_tr_b16 v[90:91], v15 offset:5920
    s_waitcnt lgkmcnt(10)
    v_mfma_f32_32x32x16_bf16 v[172:187], v[92:95], v[20:23], v[172:187]
    ds_read_b64_tr_b16 v[92:93], v15 offset:9376
    ds_read_b64_tr_b16 v[94:95], v15 offset:10528
    s_waitcnt lgkmcnt(10)
    v_mfma_f32_32x32x16_bf16 v[172:187], v[96:99], v[24:27], v[172:187]
    v_mul_f32 v1, 3216550459, v166
    v_mul_f32 v2, 3216550459, v167
    v_exp_f32 v1, v1
    v_exp_f32 v2, v2
    v_mul_f32 v166, v166, v170
    v_mul_f32 v167, v167, v171
    v_add_f32 v1, 1.0, v1
    v_add_f32 v2, 1.0, v2
    v_rcp_f32 v1, v1
    v_rcp_f32 v2, v2
    s_nop 0
    v_mul_f32 v166, v166, v1
    v_mul_f32 v167, v167, v2
    v_cvt_pk_bf16_f32 v163, v166, v167
    ds_read_b64_tr_b16 v[96:97], v15 offset:13984
    ds_read_b64_tr_b16 v[98:99], v15 offset:15136
    s_waitcnt lgkmcnt(10)
    v_mfma_f32_32x32x16_bf16 v[172:187], v[100:103], v[28:31], v[172:187]
    ds_read_b64_tr_b16 v[100:101], v16 offset:160
    ds_read_b64_tr_b16 v[102:103], v16 offset:1312
    s_waitcnt lgkmcnt(10)
    v_mfma_f32_32x32x16_bf16 v[172:187], v[104:107], v[32:35], v[172:187]
    s_add_u32 s48, s50, 3
    s_lshr_b32 s49, s48, 1
    s_lshl_b32 s49, s49, 17
    s_and_b32 s48, s48, 1
    s_lshl_b32 s48, s48, 9
    s_add_u32 s49, s49, s48
    s_add_u32 s49, s49, s51
    buffer_store_dwordx4 v[160:163], v17, s[28:31], s49 offen sc1
    ds_read_b64_tr_b16 v[104:105], v16 offset:4768
    ds_read_b64_tr_b16 v[106:107], v16 offset:5920
    s_waitcnt lgkmcnt(10)
    v_mfma_f32_32x32x16_bf16 v[188:203], v[84:87], v[52:55], v[188:203]
    ds_read_b64_tr_b16 v[84:85], v16 offset:9376
    ds_read_b64_tr_b16 v[86:87], v16 offset:10528
    s_waitcnt lgkmcnt(10)
    v_mfma_f32_32x32x16_bf16 v[188:203], v[88:91], v[56:59], v[188:203]
    ds_read_b64_tr_b16 v[88:89], v16 offset:13984
    ds_read_b64_tr_b16 v[90:91], v16 offset:15136
    s_waitcnt lgkmcnt(10)
    v_mfma_f32_32x32x16_bf16 v[188:203], v[92:95], v[60:63], v[188:203]
    ds_read_b64_tr_b16 v[92:93], v13 offset:160
    ds_read_b64_tr_b16 v[94:95], v13 offset:1312
    s_waitcnt lgkmcnt(10)
    v_mfma_f32_32x32x16_bf16 v[188:203], v[96:99], v[64:67], v[188:203]
    v_mul_f32 v1, 3216550459, v172
    v_mul_f32 v2, 3216550459, v173
    v_exp_f32 v1, v1
    v_exp_f32 v2, v2
    v_mul_f32 v172, v172, v176
    v_mul_f32 v173, v173, v177
    v_add_f32 v1, 1.0, v1
    v_add_f32 v2, 1.0, v2
    v_rcp_f32 v1, v1
    v_rcp_f32 v2, v2
    s_nop 0
    v_mul_f32 v172, v172, v1
    v_mul_f32 v173, v173, v2
    v_cvt_pk_bf16_f32 v176, v172, v173
    ds_read_b64_tr_b16 v[96:97], v13 offset:4768
    ds_read_b64_tr_b16 v[98:99], v13 offset:5920
    s_waitcnt lgkmcnt(10)
    v_mfma_f32_32x32x16_bf16 v[188:203], v[100:103], v[68:71], v[188:203]
    ds_read_b64_tr_b16 v[100:101], v13 offset:9376
    ds_read_b64_tr_b16 v[102:103], v13 offset:10528
    s_waitcnt lgkmcnt(10)
    v_mfma_f32_32x32x16_bf16 v[188:203], v[104:107], v[72:75], v[188:203]
    v_mul_f32 v1, 3216550459, v174
    v_mul_f32 v2, 3216550459, v175
    v_exp_f32 v1, v1
    v_exp_f32 v2, v2
    v_mul_f32 v174, v174, v178
    v_mul_f32 v175, v175, v179
    v_add_f32 v1, 1.0, v1
    v_add_f32 v2, 1.0, v2
    v_rcp_f32 v1, v1
    v_rcp_f32 v2, v2
    s_nop 0
    v_mul_f32 v174, v174, v1
    v_mul_f32 v175, v175, v2
    v_cvt_pk_bf16_f32 v177, v174, v175
    ds_read_b64_tr_b16 v[104:105], v13 offset:13984
    ds_read_b64_tr_b16 v[106:107], v13 offset:15136
    s_waitcnt lgkmcnt(10)
    v_mfma_f32_32x32x16_bf16 v[188:203], v[84:87], v[76:79], v[188:203]
    ds_read_b64_tr_b16 v[84:85], v15 offset:192
    ds_read_b64_tr_b16 v[86:87], v15 offset:1344
    s_waitcnt lgkmcnt(10)
    v_mfma_f32_32x32x16_bf16 v[188:203], v[88:91], v[80:83], v[188:203]
    v_mul_f32 v1, 3216550459, v180
    v_mul_f32 v2, 3216550459, v181
    v_exp_f32 v1, v1
    v_exp_f32 v2, v2
    v_mul_f32 v180, v180, v184
    v_mul_f32 v181, v181, v185
    v_add_f32 v1, 1.0, v1
    v_add_f32 v2, 1.0, v2
    v_rcp_f32 v1, v1
    v_rcp_f32 v2, v2
    s_nop 0
    v_mul_f32 v180, v180, v1
    v_mul_f32 v181, v181, v2
    v_cvt_pk_bf16_f32 v178, v180, v181
    ds_read_b64_tr_b16 v[88:89], v15 offset:4800
    ds_read_b64_tr_b16 v[90:91], v15 offset:5952
    s_waitcnt lgkmcnt(10)
    v_mfma_f32_32x32x16_bf16 v[188:203], v[92:95], v[20:23], v[188:203]
    ds_read_b64_tr_b16 v[92:93], v15 offset:9408
    ds_read_b64_tr_b16 v[94:95], v15 offset:10560
    s_waitcnt lgkmcnt(10)
    v_mfma_f32_32x32x16_bf16 v[188:203], v[96:99], v[24:27], v[188:203]
    v_mul_f32 v1, 3216550459, v182
    v_mul_f32 v2, 3216550459, v183
    v_exp_f32 v1, v1
    v_exp_f32 v2, v2
    v_mul_f32 v182, v182, v186
    v_mul_f32 v183, v183, v187
    v_add_f32 v1, 1.0, v1
    v_add_f32 v2, 1.0, v2
    v_rcp_f32 v1, v1
    v_rcp_f32 v2, v2
    s_nop 0
    v_mul_f32 v182, v182, v1
    v_mul_f32 v183, v183, v2
    v_cvt_pk_bf16_f32 v179, v182, v183
    ds_read_b64_tr_b16 v[96:97], v15 offset:14016
    ds_read_b64_tr_b16 v[98:99], v15 offset:15168
    s_waitcnt lgkmcnt(10)
    v_mfma_f32_32x32x16_bf16 v[188:203], v[100:103], v[28:31], v[188:203]
    ds_read_b64_tr_b16 v[100:101], v16 offset:192
    ds_read_b64_tr_b16 v[102:103], v16 offset:1344
    s_waitcnt lgkmcnt(10)
    v_mfma_f32_32x32x16_bf16 v[188:203], v[104:107], v[32:35], v[188:203]
    s_add_u32 s48, s50, 4
    s_lshr_b32 s49, s48, 1
    s_lshl_b32 s49, s49, 17
    s_and_b32 s48, s48, 1
    s_lshl_b32 s48, s48, 9
    s_add_u32 s49, s49, s48
    s_add_u32 s49, s49, s51
    buffer_store_dwordx4 v[176:179], v17, s[28:31], s49 offen sc1
    ds_read_b64_tr_b16 v[104:105], v16 offset:4800
    ds_read_b64_tr_b16 v[106:107], v16 offset:5952
    s_waitcnt lgkmcnt(10)
    v_mfma_f32_32x32x16_bf16 v[204:219], v[84:87], v[52:55], v[204:219]
    ds_read_b64_tr_b16 v[84:85], v16 offset:9408
    ds_read_b64_tr_b16 v[86:87], v16 offset:10560
    s_waitcnt lgkmcnt(10)
    v_mfma_f32_32x32x16_bf16 v[204:219], v[88:91], v[56:59], v[204:219]
    ds_read_b64_tr_b16 v[88:89], v16 offset:14016
    ds_read_b64_tr_b16 v[90:91], v16 offset:15168
    s_waitcnt lgkmcnt(10)
    v_mfma_f32_32x32x16_bf16 v[204:219], v[92:95], v[60:63], v[204:219]
    ds_read_b64_tr_b16 v[92:93], v13 offset:192
    ds_read_b64_tr_b16 v[94:95], v13 offset:1344
    s_waitcnt lgkmcnt(10)
    v_mfma_f32_32x32x16_bf16 v[204:219], v[96:99], v[64:67], v[204:219]
    v_mul_f32 v1, 3216550459, v188
    v_mul_f32 v2, 3216550459, v189
    v_exp_f32 v1, v1
    v_exp_f32 v2, v2
    v_mul_f32 v188, v188, v192
    v_mul_f32 v189, v189, v193
    v_add_f32 v1, 1.0, v1
    v_add_f32 v2, 1.0, v2
    v_rcp_f32 v1, v1
    v_rcp_f32 v2, v2
    s_nop 0
    v_mul_f32 v188, v188, v1
    v_mul_f32 v189, v189, v2
    v_cvt_pk_bf16_f32 v192, v188, v189
    ds_read_b64_tr_b16 v[96:97], v13 offset:4800
    ds_read_b64_tr_b16 v[98:99], v13 offset:5952
    s_waitcnt lgkmcnt(10)
    v_mfma_f32_32x32x16_bf16 v[204:219], v[100:103], v[68:71], v[204:219]
    ds_read_b64_tr_b16 v[100:101], v13 offset:9408
    ds_read_b64_tr_b16 v[102:103], v13 offset:10560
    s_waitcnt lgkmcnt(10)
    v_mfma_f32_32x32x16_bf16 v[204:219], v[104:107], v[72:75], v[204:219]
    v_mul_f32 v1, 3216550459, v190
    v_mul_f32 v2, 3216550459, v191
    v_exp_f32 v1, v1
    v_exp_f32 v2, v2
    v_mul_f32 v190, v190, v194
    v_mul_f32 v191, v191, v195
    v_add_f32 v1, 1.0, v1
    v_add_f32 v2, 1.0, v2
    v_rcp_f32 v1, v1
    v_rcp_f32 v2, v2
    s_nop 0
    v_mul_f32 v190, v190, v1
    v_mul_f32 v191, v191, v2
    v_cvt_pk_bf16_f32 v193, v190, v191
    ds_read_b64_tr_b16 v[104:105], v13 offset:14016
    ds_read_b64_tr_b16 v[106:107], v13 offset:15168
    s_waitcnt lgkmcnt(10)
    v_mfma_f32_32x32x16_bf16 v[204:219], v[84:87], v[76:79], v[204:219]
    ds_read_b64_tr_b16 v[84:85], v15 offset:224
    ds_read_b64_tr_b16 v[86:87], v15 offset:1376
    s_waitcnt lgkmcnt(10)
    v_mfma_f32_32x32x16_bf16 v[204:219], v[88:91], v[80:83], v[204:219]
    v_mul_f32 v1, 3216550459, v196
    v_mul_f32 v2, 3216550459, v197
    v_exp_f32 v1, v1
    v_exp_f32 v2, v2
    v_mul_f32 v196, v196, v200
    v_mul_f32 v197, v197, v201
    v_add_f32 v1, 1.0, v1
    v_add_f32 v2, 1.0, v2
    v_rcp_f32 v1, v1
    v_rcp_f32 v2, v2
    s_nop 0
    v_mul_f32 v196, v196, v1
    v_mul_f32 v197, v197, v2
    v_cvt_pk_bf16_f32 v194, v196, v197
    ds_read_b64_tr_b16 v[88:89], v15 offset:4832
    ds_read_b64_tr_b16 v[90:91], v15 offset:5984
    s_waitcnt lgkmcnt(10)
    v_mfma_f32_32x32x16_bf16 v[204:219], v[92:95], v[20:23], v[204:219]
    ds_read_b64_tr_b16 v[92:93], v15 offset:9440
    ds_read_b64_tr_b16 v[94:95], v15 offset:10592
    s_waitcnt lgkmcnt(10)
    v_mfma_f32_32x32x16_bf16 v[204:219], v[96:99], v[24:27], v[204:219]
    v_mul_f32 v1, 3216550459, v198
    v_mul_f32 v2, 3216550459, v199
    v_exp_f32 v1, v1
    v_exp_f32 v2, v2
    v_mul_f32 v198, v198, v202
    v_mul_f32 v199, v199, v203
    v_add_f32 v1, 1.0, v1
    v_add_f32 v2, 1.0, v2
    v_rcp_f32 v1, v1
    v_rcp_f32 v2, v2
    s_nop 0
    v_mul_f32 v198, v198, v1
    v_mul_f32 v199, v199, v2
    v_cvt_pk_bf16_f32 v195, v198, v199
    ds_read_b64_tr_b16 v[96:97], v15 offset:14048
    ds_read_b64_tr_b16 v[98:99], v15 offset:15200
    s_waitcnt lgkmcnt(10)
    v_mfma_f32_32x32x16_bf16 v[204:219], v[100:103], v[28:31], v[204:219]
    ds_read_b64_tr_b16 v[100:101], v16 offset:224
    ds_read_b64_tr_b16 v[102:103], v16 offset:1376
    s_waitcnt lgkmcnt(10)
    v_mfma_f32_32x32x16_bf16 v[204:219], v[104:107], v[32:35], v[204:219]
    s_add_u32 s48, s50, 5
    s_lshr_b32 s49, s48, 1
    s_lshl_b32 s49, s49, 17
    s_and_b32 s48, s48, 1
    s_lshl_b32 s48, s48, 9
    s_add_u32 s49, s49, s48
    s_add_u32 s49, s49, s51
    buffer_store_dwordx4 v[192:195], v17, s[28:31], s49 offen sc1
    ds_read_b64_tr_b16 v[104:105], v16 offset:4832
    ds_read_b64_tr_b16 v[106:107], v16 offset:5984
    s_waitcnt lgkmcnt(10)
    v_mfma_f32_32x32x16_bf16 v[220:235], v[84:87], v[52:55], v[220:235]
    ds_read_b64_tr_b16 v[84:85], v16 offset:9440
    ds_read_b64_tr_b16 v[86:87], v16 offset:10592
    s_waitcnt lgkmcnt(10)
    v_mfma_f32_32x32x16_bf16 v[220:235], v[88:91], v[56:59], v[220:235]
    ds_read_b64_tr_b16 v[88:89], v16 offset:14048
    ds_read_b64_tr_b16 v[90:91], v16 offset:15200
    s_waitcnt lgkmcnt(10)
    v_mfma_f32_32x32x16_bf16 v[220:235], v[92:95], v[60:63], v[220:235]
    ds_read_b64_tr_b16 v[92:93], v13 offset:224
    ds_read_b64_tr_b16 v[94:95], v13 offset:1376
    s_waitcnt lgkmcnt(10)
    v_mfma_f32_32x32x16_bf16 v[220:235], v[96:99], v[64:67], v[220:235]
    v_mul_f32 v1, 3216550459, v204
    v_mul_f32 v2, 3216550459, v205
    v_exp_f32 v1, v1
    v_exp_f32 v2, v2
    v_mul_f32 v204, v204, v208
    v_mul_f32 v205, v205, v209
    v_add_f32 v1, 1.0, v1
    v_add_f32 v2, 1.0, v2
    v_rcp_f32 v1, v1
    v_rcp_f32 v2, v2
    s_nop 0
    v_mul_f32 v204, v204, v1
    v_mul_f32 v205, v205, v2
    v_cvt_pk_bf16_f32 v208, v204, v205
    ds_read_b64_tr_b16 v[96:97], v13 offset:4832
    ds_read_b64_tr_b16 v[98:99], v13 offset:5984
    s_waitcnt lgkmcnt(10)
    v_mfma_f32_32x32x16_bf16 v[220:235], v[100:103], v[68:71], v[220:235]
    ds_read_b64_tr_b16 v[100:101], v13 offset:9440
    ds_read_b64_tr_b16 v[102:103], v13 offset:10592
    s_waitcnt lgkmcnt(10)
    v_mfma_f32_32x32x16_bf16 v[220:235], v[104:107], v[72:75], v[220:235]
    v_mul_f32 v1, 3216550459, v206
    v_mul_f32 v2, 3216550459, v207
    v_exp_f32 v1, v1
    v_exp_f32 v2, v2
    v_mul_f32 v206, v206, v210
    v_mul_f32 v207, v207, v211
    v_add_f32 v1, 1.0, v1
    v_add_f32 v2, 1.0, v2
    v_rcp_f32 v1, v1
    v_rcp_f32 v2, v2
    s_nop 0
    v_mul_f32 v206, v206, v1
    v_mul_f32 v207, v207, v2
    v_cvt_pk_bf16_f32 v209, v206, v207
    ds_read_b64_tr_b16 v[104:105], v13 offset:14048
    ds_read_b64_tr_b16 v[106:107], v13 offset:15200
    s_waitcnt lgkmcnt(10)
    v_mfma_f32_32x32x16_bf16 v[220:235], v[84:87], v[76:79], v[220:235]
    ds_read_b64_tr_b16 v[84:85], v15 offset:256
    ds_read_b64_tr_b16 v[86:87], v15 offset:1408
    s_waitcnt lgkmcnt(10)
    v_mfma_f32_32x32x16_bf16 v[220:235], v[88:91], v[80:83], v[220:235]
    v_mul_f32 v1, 3216550459, v212
    v_mul_f32 v2, 3216550459, v213
    v_exp_f32 v1, v1
    v_exp_f32 v2, v2
    v_mul_f32 v212, v212, v216
    v_mul_f32 v213, v213, v217
    v_add_f32 v1, 1.0, v1
    v_add_f32 v2, 1.0, v2
    v_rcp_f32 v1, v1
    v_rcp_f32 v2, v2
    s_nop 0
    v_mul_f32 v212, v212, v1
    v_mul_f32 v213, v213, v2
    v_cvt_pk_bf16_f32 v210, v212, v213
    ds_read_b64_tr_b16 v[88:89], v15 offset:4864
    ds_read_b64_tr_b16 v[90:91], v15 offset:6016
    s_waitcnt lgkmcnt(10)
    v_mfma_f32_32x32x16_bf16 v[220:235], v[92:95], v[20:23], v[220:235]
    ds_read_b64_tr_b16 v[92:93], v15 offset:9472
    ds_read_b64_tr_b16 v[94:95], v15 offset:10624
    s_waitcnt lgkmcnt(10)
    v_mfma_f32_32x32x16_bf16 v[220:235], v[96:99], v[24:27], v[220:235]
    v_mul_f32 v1, 3216550459, v214
    v_mul_f32 v2, 3216550459, v215
    v_exp_f32 v1, v1
    v_exp_f32 v2, v2
    v_mul_f32 v214, v214, v218
    v_mul_f32 v215, v215, v219
    v_add_f32 v1, 1.0, v1
    v_add_f32 v2, 1.0, v2
    v_rcp_f32 v1, v1
    v_rcp_f32 v2, v2
    s_nop 0
    v_mul_f32 v214, v214, v1
    v_mul_f32 v215, v215, v2
    v_cvt_pk_bf16_f32 v211, v214, v215
    ds_read_b64_tr_b16 v[96:97], v15 offset:14080
    ds_read_b64_tr_b16 v[98:99], v15 offset:15232
    s_waitcnt lgkmcnt(10)
    v_mfma_f32_32x32x16_bf16 v[220:235], v[100:103], v[28:31], v[220:235]
    ds_read_b64_tr_b16 v[100:101], v16 offset:256
    ds_read_b64_tr_b16 v[102:103], v16 offset:1408
    s_waitcnt lgkmcnt(10)
    v_mfma_f32_32x32x16_bf16 v[220:235], v[104:107], v[32:35], v[220:235]
    s_add_u32 s48, s50, 6
    s_lshr_b32 s49, s48, 1
    s_lshl_b32 s49, s49, 17
    s_and_b32 s48, s48, 1
    s_lshl_b32 s48, s48, 9
    s_add_u32 s49, s49, s48
    s_add_u32 s49, s49, s51
    buffer_store_dwordx4 v[208:211], v17, s[28:31], s49 offen sc1
    ds_read_b64_tr_b16 v[104:105], v16 offset:4864
    ds_read_b64_tr_b16 v[106:107], v16 offset:6016
    s_waitcnt lgkmcnt(10)
    v_mfma_f32_32x32x16_bf16 v[236:251], v[84:87], v[52:55], v[236:251]
    ds_read_b64_tr_b16 v[84:85], v16 offset:9472
    ds_read_b64_tr_b16 v[86:87], v16 offset:10624
    s_waitcnt lgkmcnt(10)
    v_mfma_f32_32x32x16_bf16 v[236:251], v[88:91], v[56:59], v[236:251]
    ds_read_b64_tr_b16 v[88:89], v16 offset:14080
    ds_read_b64_tr_b16 v[90:91], v16 offset:15232
    s_waitcnt lgkmcnt(10)
    v_mfma_f32_32x32x16_bf16 v[236:251], v[92:95], v[60:63], v[236:251]
    ds_read_b64_tr_b16 v[92:93], v13 offset:256
    ds_read_b64_tr_b16 v[94:95], v13 offset:1408
    s_waitcnt lgkmcnt(10)
    v_mfma_f32_32x32x16_bf16 v[236:251], v[96:99], v[64:67], v[236:251]
    v_mul_f32 v1, 3216550459, v220
    v_mul_f32 v2, 3216550459, v221
    v_exp_f32 v1, v1
    v_exp_f32 v2, v2
    v_mul_f32 v220, v220, v224
    v_mul_f32 v221, v221, v225
    v_add_f32 v1, 1.0, v1
    v_add_f32 v2, 1.0, v2
    v_rcp_f32 v1, v1
    v_rcp_f32 v2, v2
    s_nop 0
    v_mul_f32 v220, v220, v1
    v_mul_f32 v221, v221, v2
    v_cvt_pk_bf16_f32 v224, v220, v221
    ds_read_b64_tr_b16 v[96:97], v13 offset:4864
    ds_read_b64_tr_b16 v[98:99], v13 offset:6016
    s_waitcnt lgkmcnt(10)
    v_mfma_f32_32x32x16_bf16 v[236:251], v[100:103], v[68:71], v[236:251]
    ds_read_b64_tr_b16 v[100:101], v13 offset:9472
    ds_read_b64_tr_b16 v[102:103], v13 offset:10624
    s_waitcnt lgkmcnt(10)
    v_mfma_f32_32x32x16_bf16 v[236:251], v[104:107], v[72:75], v[236:251]
    v_mul_f32 v1, 3216550459, v222
    v_mul_f32 v2, 3216550459, v223
    v_exp_f32 v1, v1
    v_exp_f32 v2, v2
    v_mul_f32 v222, v222, v226
    v_mul_f32 v223, v223, v227
    v_add_f32 v1, 1.0, v1
    v_add_f32 v2, 1.0, v2
    v_rcp_f32 v1, v1
    v_rcp_f32 v2, v2
    s_nop 0
    v_mul_f32 v222, v222, v1
    v_mul_f32 v223, v223, v2
    v_cvt_pk_bf16_f32 v225, v222, v223
    ds_read_b64_tr_b16 v[104:105], v13 offset:14080
    ds_read_b64_tr_b16 v[106:107], v13 offset:15232
    s_waitcnt lgkmcnt(10)
    v_mfma_f32_32x32x16_bf16 v[236:251], v[84:87], v[76:79], v[236:251]
    s_waitcnt lgkmcnt(8)
    v_mfma_f32_32x32x16_bf16 v[236:251], v[88:91], v[80:83], v[236:251]
    v_mul_f32 v1, 3216550459, v228
    v_mul_f32 v2, 3216550459, v229
    v_exp_f32 v1, v1
    v_exp_f32 v2, v2
    v_mul_f32 v228, v228, v232
    v_mul_f32 v229, v229, v233
    v_add_f32 v1, 1.0, v1
    v_add_f32 v2, 1.0, v2
    v_rcp_f32 v1, v1
    v_rcp_f32 v2, v2
    s_nop 0
    v_mul_f32 v228, v228, v1
    v_mul_f32 v229, v229, v2
    v_cvt_pk_bf16_f32 v226, v228, v229
    s_waitcnt lgkmcnt(6)
    v_mfma_f32_32x32x16_bf16 v[236:251], v[92:95], v[20:23], v[236:251]
    s_waitcnt lgkmcnt(4)
    v_mfma_f32_32x32x16_bf16 v[236:251], v[96:99], v[24:27], v[236:251]
    v_mul_f32 v1, 3216550459, v230
    v_mul_f32 v2, 3216550459, v231
    v_exp_f32 v1, v1
    v_exp_f32 v2, v2
    v_mul_f32 v230, v230, v234
    v_mul_f32 v231, v231, v235
    v_add_f32 v1, 1.0, v1
    v_add_f32 v2, 1.0, v2
    v_rcp_f32 v1, v1
    v_rcp_f32 v2, v2
    s_nop 0
    v_mul_f32 v230, v230, v1
    v_mul_f32 v231, v231, v2
    v_cvt_pk_bf16_f32 v227, v230, v231
    s_waitcnt lgkmcnt(2)
    v_mfma_f32_32x32x16_bf16 v[236:251], v[100:103], v[28:31], v[236:251]
    s_waitcnt lgkmcnt(0)
    v_mfma_f32_32x32x16_bf16 v[236:251], v[104:107], v[32:35], v[236:251]
    s_add_u32 s48, s50, 7
    s_lshr_b32 s49, s48, 1
    s_lshl_b32 s49, s49, 17
    s_and_b32 s48, s48, 1
    s_lshl_b32 s48, s48, 9
    s_add_u32 s49, s49, s48
    s_add_u32 s49, s49, s51
    buffer_store_dwordx4 v[224:227], v17, s[28:31], s49 offen sc1
    s_nop 11
    v_mul_f32 v1, 3216550459, v236
    v_mul_f32 v2, 3216550459, v237
    v_exp_f32 v1, v1
    v_exp_f32 v2, v2
    v_mul_f32 v236, v236, v240
    v_mul_f32 v237, v237, v241
    v_add_f32 v1, 1.0, v1
    v_add_f32 v2, 1.0, v2
    v_rcp_f32 v1, v1
    v_rcp_f32 v2, v2
    s_nop 0
    v_mul_f32 v236, v236, v1
    v_mul_f32 v237, v237, v2
    v_cvt_pk_bf16_f32 v240, v236, v237
    v_mul_f32 v1, 3216550459, v238
    v_mul_f32 v2, 3216550459, v239
    v_exp_f32 v1, v1
    v_exp_f32 v2, v2
    v_mul_f32 v238, v238, v242
    v_mul_f32 v239, v239, v243
    v_add_f32 v1, 1.0, v1
    v_add_f32 v2, 1.0, v2
    v_rcp_f32 v1, v1
    v_rcp_f32 v2, v2
    s_nop 0
    v_mul_f32 v238, v238, v1
    v_mul_f32 v239, v239, v2
    v_cvt_pk_bf16_f32 v241, v238, v239
    v_mul_f32 v1, 3216550459, v244
    v_mul_f32 v2, 3216550459, v245
    v_exp_f32 v1, v1
    v_exp_f32 v2, v2
    v_mul_f32 v244, v244, v248
    v_mul_f32 v245, v245, v249
    v_add_f32 v1, 1.0, v1
    v_add_f32 v2, 1.0, v2
    v_rcp_f32 v1, v1
    v_rcp_f32 v2, v2
    s_nop 0
    v_mul_f32 v244, v244, v1
    v_mul_f32 v245, v245, v2
    v_cvt_pk_bf16_f32 v242, v244, v245
    v_mul_f32 v1, 3216550459, v246
    v_mul_f32 v2, 3216550459, v247
    v_exp_f32 v1, v1
    v_exp_f32 v2, v2
    v_mul_f32 v246, v246, v250
    v_mul_f32 v247, v247, v251
    v_add_f32 v1, 1.0, v1
    v_add_f32 v2, 1.0, v2
    v_rcp_f32 v1, v1
    v_rcp_f32 v2, v2
    s_nop 0
    v_mul_f32 v246, v246, v1
    v_mul_f32 v247, v247, v2
    v_cvt_pk_bf16_f32 v243, v246, v247
    s_add_u32 s48, s50, 8
    s_lshr_b32 s49, s48, 1
    s_lshl_b32 s49, s49, 17
    s_and_b32 s48, s48, 1
    s_lshl_b32 s48, s48, 9
    s_add_u32 s49, s49, s48
    s_add_u32 s49, s49, s51
    buffer_store_dwordx4 v[240:243], v17, s[28:31], s49 offen sc1
    s_lshl_b32 s45, s37, 2
    s_lshr_b32 s46, s36, 3
    s_add_u32 s45, s45, s46
    s_lshl_b32 s45, s45, 6
    s_add_u32 s45, s45, 8704
    s_waitcnt vmcnt(0)
    s_barrier
    s_cmp_lg_u32 s24, 0
    s_cbranch_scc1 SIG_29
    v_mov_b32 v1, 1
    s_mov_b64 exec, 1
    buffer_atomic_add v1, off, s[28:31], s45 sc1
    s_mov_b64 exec, -1
SIG_29:
    s_bfe_u32 s36, s2, 0x20001
    s_and_b32 s37, s2, 1
    s_lshl_b32 s37, s37, 3
    s_bfe_u32 s38, s2, 0x30003
    s_add_u32 s37, s37, s38
    s_lshr_b32 s39, s2, 6
    s_and_b32 s40, s24, 3
    s_lshr_b32 s41, s24, 2
    v_lshlrev_b32 v12, 4, v0
    s_mul_i32 s46, s36, 36
    s_mul_i32 s47, s41, 18
    s_add_u32 s46, s46, s47
    s_lshl_b32 s46, s46, 7
    s_lshl_b32 s47, s37, 3
    s_add_u32 s46, s46, s47
    s_lshl_b32 s47, s40, 1
    s_add_u32 s46, s46, s47
    s_add_u32 s47, s46, s41
    s_xor_b32 s48, s41, 1
    s_add_u32 s48, s46, s48
    s_lshl_b32 s47, s47, 10
    s_lshl_b32 s48, s48, 10
    s_add_u32 s47, s47, 18874368
    s_add_u32 s48, s48, 18874368
    s_mov_b32 s50, s25
    s_mul_i32 s83, s82, 73728
    s_add_u32 s83, s83, s81
    s_add_u32 s82, s82, 1
    s_cmp_ge_u32 s82, 9
    s_cselect_b32 s82, 0, s82
    s_add_u32 m0, s80, 73984
    s_nop 0
    buffer_load_dwordx4 v7, s[16:19], s83 offen lds
    s_add_u32 m0, s80, 75008
    s_nop 0
    buffer_load_dwordx4 v8, s[16:19], s83 offen lds
    s_add_u32 m0, s80, 76032
    s_nop 0
    buffer_load_dwordx4 v9, s[16:19], s83 offen lds
    s_add_u32 m0, s80, 77056
    s_nop 0
    buffer_load_dwordx4 v10, s[16:19], s83 offen lds
    s_add_u32 m0, s80, 78080
    s_mov_b64 exec, 0xffffffff
    buffer_load_dwordx4 v11, s[16:19], s83 offen lds
    s_mov_b64 exec, -1
    s_mul_i32 s83, s82, 73728
    s_add_u32 s83, s83, s81
    s_add_u32 s82, s82, 1
    s_cmp_ge_u32 s82, 9
    s_cselect_b32 s82, 0, s82
    s_add_u32 m0, s80, 110976
    s_nop 0
    buffer_load_dwordx4 v7, s[16:19], s83 offen lds
    s_add_u32 m0, s80, 112000
    s_nop 0
    buffer_load_dwordx4 v8, s[16:19], s83 offen lds
    s_add_u32 m0, s80, 113024
    s_nop 0
    buffer_load_dwordx4 v9, s[16:19], s83 offen lds
    s_add_u32 m0, s80, 114048
    s_nop 0
    buffer_load_dwordx4 v10, s[16:19], s83 offen lds
    s_add_u32 m0, s80, 115072
    s_mov_b64 exec, 0xffffffff
    buffer_load_dwordx4 v11, s[16:19], s83 offen lds
    s_mov_b64 exec, -1
    v_lshrrev_b32 v1, 5, v0
    v_lshlrev_b32 v1, 4, v1
    v_bfe_u32 v2, v0, 2, 3
    v_add_u32 v1, v1, v2
    v_mul_u32_u24 v1, 288, v1
    v_and_b32 v2, 3, v0
    v_lshl_add_u32 v1, v2, 3, v1
    s_mul_i32 s52, s41, 18432
    v_add_u32 v13, s52, v1
    v_add_u32 v14, 36992, v13
    v_add_u32 v15, 73984, v13
    v_add_u32 v16, 110976, v13
    s_lshr_b32 s45, s37, 1
    s_lshl_b32 s45, s45, 2
    s_add_u32 s45, s45, s36
    s_lshl_b32 s45, s45, 6
    s_add_u32 s45, s45, 8704
    s_lshr_b32 s53, s37, 1
    s_lshl_b32 s53, s53, 6
    s_add_u32 s53, s53, 8192
    s_cmp_lg_u32 s24, 0
    s_cbranch_scc1 WDONE_30
    s_mov_b32 s56, 0
WLOOP_31:
    buffer_load_dword v1, off, s[28:31], s45 sc1
    buffer_load_dword v2, off, s[28:31], s53 sc1
    s_waitcnt vmcnt(0)
    v_readfirstlane_b32 s57, v1
    v_readfirstlane_b32 s58, v2
    s_add_u32 s56, s56, 1
    s_cmp_lt_u32 s57, 8
    s_cbranch_scc1 WMORE_32
    s_cmp_ge_u32 s58, 32
    s_cbranch_scc1 WDONE_30
WMORE_32:
    s_cmp_gt_u32 s56, 0x400000
    s_cbranch_scc1 WDONE_30
    s_sleep 1
    s_branch WLOOP_31
WDONE_30:
    s_barrier
    s_lshl_b32 s51, s50, 18
    s_add_u32 s50, s50, 1
    s_cmp_ge_u32 s50, 9
    s_cselect_b32 s50, 0, s50
    s_add_u32 s52, s47, s51
    buffer_load_dwordx4 v[20:23], v12, s[28:31], s52 offen
    s_add_u32 s52, s48, s51
    buffer_load_dwordx4 v[24:27], v12, s[28:31], s52 offen
    s_add_u32 s52, s47, s51
    s_add_u32 s52, s52, 131072
    buffer_load_dwordx4 v[28:31], v12, s[28:31], s52 offen
    s_add_u32 s52, s48, s51
    s_add_u32 s52, s52, 131072
    buffer_load_dwordx4 v[32:35], v12, s[28:31], s52 offen
    s_lshl_b32 s51, s50, 18
    s_add_u32 s50, s50, 1
    s_cmp_ge_u32 s50, 9
    s_cselect_b32 s50, 0, s50
    s_add_u32 s52, s47, s51
    buffer_load_dwordx4 v[36:39], v12, s[28:31], s52 offen
    s_add_u32 s52, s48, s51
    buffer_load_dwordx4 v[40:43], v12, s[28:31], s52 offen
    s_add_u32 s52, s47, s51
    s_add_u32 s52, s52, 131072
    buffer_load_dwordx4 v[44:47], v12, s[28:31], s52 offen
    s_add_u32 s52, s48, s51
    s_add_u32 s52, s52, 131072
    buffer_load_dwordx4 v[48:51], v12, s[28:31], s52 offen
    s_waitcnt vmcnt(4)
    s_barrier
    ds_read_b64_tr_b16 v[68:69], v14 offset:0
    ds_read_b64_tr_b16 v[70:71], v14 offset:2304
    ds_read_b64_tr_b16 v[72:73], v14 offset:32
    ds_read_b64_tr_b16 v[74:75], v14 offset:2336
    ds_read_b64_tr_b16 v[76:77], v14 offset:64
    ds_read_b64_tr_b16 v[78:79], v14 offset:2368
    ds_read_b64_tr_b16 v[80:81], v14 offset:96
    ds_read_b64_tr_b16 v[82:83], v14 offset:2400
    ds_read_b64_tr_b16 v[84:85], v14 offset:128
    ds_read_b64_tr_b16 v[86:87], v14 offset:2432
    ds_read_b64_tr_b16 v[88:89], v14 offset:160
    ds_read_b64_tr_b16 v[90:91], v14 offset:2464
    ds_read_b64_tr_b16 v[92:93], v14 offset:192
    ds_read_b64_tr_b16 v[94:95], v14 offset:2496
    s_waitcnt lgkmcnt(12)
    v_mfma_f32_16x16x32_bf16 v[100:103], v[68:71], v[20:23], 0
    v_mfma_f32_16x16x32_bf16 v[136:139], v[68:71], v[24:27], 0
    ds_read_b64_tr_b16 v[96:97], v14 offset:224
    ds_read_b64_tr_b16 v[98:99], v14 offset:2528
    s_waitcnt lgkmcnt(12)
    v_mfma_f32_16x16x32_bf16 v[104:107], v[72:75], v[20:23], 0
    v_mfma_f32_16x16x32_bf16 v[140:143], v[72:75], v[24:27], 0
    s_lshl_b32 s51, s50, 18
    s_add_u32 s50, s50, 1
    s_cmp_ge_u32 s50, 9
    s_cselect_b32 s50, 0, s50
    s_add_u32 s52, s47, s51
    buffer_load_dwordx4 v[52:55], v12, s[28:31], s52 offen
    ds_read_b64_tr_b16 v[68:69], v14 offset:256
    ds_read_b64_tr_b16 v[70:71], v14 offset:2560
    s_waitcnt lgkmcnt(12)
    v_mfma_f32_16x16x32_bf16 v[108:111], v[76:79], v[20:23], 0
    v_mfma_f32_16x16x32_bf16 v[144:147], v[76:79], v[24:27], 0
    s_add_u32 s52, s48, s51
    buffer_load_dwordx4 v[56:59], v12, s[28:31], s52 offen
    ds_read_b64_tr_b16 v[72:73], v14 offset:9216
    ds_read_b64_tr_b16 v[74:75], v14 offset:11520
    s_waitcnt lgkmcnt(12)
    v_mfma_f32_16x16x32_bf16 v[112:115], v[80:83], v[20:23], 0
    v_mfma_f32_16x16x32_bf16 v[148:151], v[80:83], v[24:27], 0
    ds_read_b64_tr_b16 v[76:77], v14 offset:9248
    ds_read_b64_tr_b16 v[78:79], v14 offset:11552
    s_waitcnt lgkmcnt(12)
    v_mfma_f32_16x16x32_bf16 v[116:119], v[84:87], v[20:23], 0
    v_mfma_f32_16x16x32_bf16 v[152:155], v[84:87], v[24:27], 0
    s_add_u32 s52, s47, s51
    s_add_u32 s52, s52, 131072
    buffer_load_dwordx4 v[60:63], v12, s[28:31], s52 offen
    ds_read_b64_tr_b16 v[80:81], v14 offset:9280
    ds_read_b64_tr_b16 v[82:83], v14 offset:11584
    s_waitcnt lgkmcnt(12)
    v_mfma_f32_16x16x32_bf16 v[120:123], v[88:91], v[20:23], 0
    v_mfma_f32_16x16x32_bf16 v[156:159], v[88:91], v[24:27], 0
    ds_read_b64_tr_b16 v[84:85], v14 offset:9312
    ds_read_b64_tr_b16 v[86:87], v14 offset:11616
    s_waitcnt lgkmcnt(12)
    v_mfma_f32_16x16x32_bf16 v[124:127], v[92:95], v[20:23], 0
    v_mfma_f32_16x16x32_bf16 v[160:163], v[92:95], v[24:27], 0
    s_add_u32 s52, s48, s51
    s_add_u32 s52, s52, 131072
    buffer_load_dwordx4 v[64:67], v12, s[28:31], s52 offen
    ds_read_b64_tr_b16 v[88:89], v14 offset:9344
    ds_read_b64_tr_b16 v[90:91], v14 offset:11648
    s_waitcnt lgkmcnt(12)
    v_mfma_f32_16x16x32_bf16 v[128:131], v[96:99], v[20:23], 0
    v_mfma_f32_16x16x32_bf16 v[164:167], v[96:99], v[24:27], 0
    s_mul_i32 s83, s82, 73728
    s_add_u32 s83, s83, s81
    s_add_u32 s82, s82, 1
    s_cmp_ge_u32 s82, 9
    s_cselect_b32 s82, 0, s82
    s_add_u32 m0, s80, 0
    s_nop 0
    buffer_load_dwordx4 v7, s[16:19], s83 offen lds
    ds_read_b64_tr_b16 v[92:93], v14 offset:9376
    ds_read_b64_tr_b16 v[94:95], v14 offset:11680
    s_waitcnt lgkmcnt(12)
    v_mfma_f32_16x16x32_bf16 v[132:135], v[68:71], v[20:23], 0
    v_mfma_f32_16x16x32_bf16 v[168:171], v[68:71], v[24:27], 0
    ds_read_b64_tr_b16 v[96:97], v14 offset:9408
    ds_read_b64_tr_b16 v[98:99], v14 offset:11712
    s_waitcnt lgkmcnt(12)
    v_mfma_f32_16x16x32_bf16 v[100:103], v[72:75], v[28:31], v[100:103]
    v_mfma_f32_16x16x32_bf16 v[136:139], v[72:75], v[32:35], v[136:139]
    s_add_u32 m0, s80, 1024
    s_nop 0
    buffer_load_dwordx4 v8, s[16:19], s83 offen lds
    ds_read_b64_tr_b16 v[68:69], v14 offset:9440
    ds_read_b64_tr_b16 v[70:71], v14 offset:11744
    s_waitcnt lgkmcnt(12)
    v_mfma_f32_16x16x32_bf16 v[104:107], v[76:79], v[28:31], v[104:107]
    v_mfma_f32_16x16x32_bf16 v[140:143], v[76:79], v[32:35], v[140:143]
    ds_read_b64_tr_b16 v[72:73], v14 offset:9472
    ds_read_b64_tr_b16 v[74:75], v14 offset:11776
    s_waitcnt lgkmcnt(12)
    v_mfma_f32_16x16x32_bf16 v[108:111], v[80:83], v[28:31], v[108:111]
    v_mfma_f32_16x16x32_bf16 v[144:147], v[80:83], v[32:35], v[144:147]
    s_add_u32 m0, s80, 2048
    s_nop 0
    buffer_load_dwordx4 v9, s[16:19], s83 offen lds
    s_waitcnt lgkmcnt(10)
    v_mfma_f32_16x16x32_bf16 v[112:115], v[84:87], v[28:31], v[112:115]
    v_mfma_f32_16x16x32_bf16 v[148:151], v[84:87], v[32:35], v[148:151]
    s_add_u32 m0, s80, 3072
    s_nop 0
    buffer_load_dwordx4 v10, s[16:19], s83 offen lds
    s_waitcnt lgkmcnt(8)
    v_mfma_f32_16x16x32_bf16 v[116:119], v[88:91], v[28:31], v[116:119]
    v_mfma_f32_16x16x32_bf16 v[152:155], v[88:91], v[32:35], v[152:155]
    s_waitcnt lgkmcnt(6)
    v_mfma_f32_16x16x32_bf16 v[120:123], v[92:95], v[28:31], v[120:123]
    v_mfma_f32_16x16x32_bf16 v[156:159], v[92:95], v[32:35], v[156:159]
    s_add_u32 m0, s80, 4096
    s_mov_b64 exec, 0xffffffff
    buffer_load_dwordx4 v11, s[16:19], s83 offen lds
    s_mov_b64 exec, -1
    s_waitcnt lgkmcnt(4)
    v_mfma_f32_16x16x32_bf16 v[124:127], v[96:99], v[28:31], v[124:127]
    v_mfma_f32_16x16x32_bf16 v[160:163], v[96:99], v[32:35], v[160:163]
    s_waitcnt lgkmcnt(2)
    v_mfma_f32_16x16x32_bf16 v[128:131], v[68:71], v[28:31], v[128:131]
    v_mfma_f32_16x16x32_bf16 v[164:167], v[68:71], v[32:35], v[164:167]
    s_waitcnt lgkmcnt(0)
    v_mfma_f32_16x16x32_bf16 v[132:135], v[72:75], v[28:31], v[132:135]
    v_mfma_f32_16x16x32_bf16 v[168:171], v[72:75], v[32:35], v[168:171]
    s_waitcnt vmcnt(9)
    s_barrier
    ds_read_b64_tr_b16 v[76:77], v15 offset:0
    ds_read_b64_tr_b16 v[78:79], v15 offset:2304
    ds_read_b64_tr_b16 v[80:81], v15 offset:32
    ds_read_b64_tr_b16 v[82:83], v15 offset:2336
    ds_read_b64_tr_b16 v[84:85], v15 offset:64
    ds_read_b64_tr_b16 v[86:87], v15 offset:2368
    ds_read_b64_tr_b16 v[88:89], v15 offset:96
    ds_read_b64_tr_b16 v[90:91], v15 offset:2400
    ds_read_b64_tr_b16 v[92:93], v15 offset:128
    ds_read_b64_tr_b16 v[94:95], v15 offset:2432
    ds_read_b64_tr_b16 v[96:97], v15 offset:160
    ds_read_b64_tr_b16 v[98:99], v15 offset:2464
    ds_read_b64_tr_b16 v[68:69], v15 offset:192
    ds_read_b64_tr_b16 v[70:71], v15 offset:2496
    s_waitcnt lgkmcnt(12)
    v_mfma_f32_16x16x32_bf16 v[100:103], v[76:79], v[36:39], v[100:103]
    v_mfma_f32_16x16x32_bf16 v[136:139], v[76:79], v[40:43], v[136:139]
    ds_read_b64_tr_b16 v[72:73], v15 offset:224
    ds_read_b64_tr_b16 v[74:75], v15 offset:2528
    s_waitcnt lgkmcnt(12)
    v_mfma_f32_16x16x32_bf16 v[104:107], v[80:83], v[36:39], v[104:107]
    v_mfma_f32_16x16x32_bf16 v[140:143], v[80:83], v[40:43], v[140:143]
    s_lshl_b32 s51, s50, 18
    s_add_u32 s50, s50, 1
    s_cmp_ge_u32 s50, 9
    s_cselect_b32 s50, 0, s50
    s_add_u32 s52, s47, s51
    buffer_load_dwordx4 v[20:23], v12, s[28:31], s52 offen
    ds_read_b64_tr_b16 v[76:77], v15 offset:256
    ds_read_b64_tr_b16 v[78:79], v15 offset:2560
    s_waitcnt lgkmcnt(12)
    v_mfma_f32_16x16x32_bf16 v[108:111], v[84:87], v[36:39], v[108:111]
    v_mfma_f32_16x16x32_bf16 v[144:147], v[84:87], v[40:43], v[144:147]
    s_add_u32 s52, s48, s51
    buffer_load_dwordx4 v[24:27], v12, s[28:31], s52 offen
    ds_read_b64_tr_b16 v[80:81], v15 offset:9216
    ds_read_b64_tr_b16 v[82:83], v15 offset:11520
    s_waitcnt lgkmcnt(12)
    v_mfma_f32_16x16x32_bf16 v[112:115], v[88:91], v[36:39], v[112:115]
    v_mfma_f32_16x16x32_bf16 v[148:151], v[88:91], v[40:43], v[148:151]
    ds_read_b64_tr_b16 v[84:85], v15 offset:9248
    ds_read_b64_tr_b16 v[86:87], v15 offset:11552
    s_waitcnt lgkmcnt(12)
    v_mfma_f32_16x16x32_bf16 v[116:119], v[92:95], v[36:39], v[116:119]
    v_mfma_f32_16x16x32_bf16 v[152:155], v[92:95], v[40:43], v[152:155]
    s_add_u32 s52, s47, s51
    s_add_u32 s52, s52, 131072
    buffer_load_dwordx4 v[28:31], v12, s[28:31], s52 offen
    ds_read_b64_tr_b16 v[88:89], v15 offset:9280
    ds_read_b64_tr_b16 v[90:91], v15 offset:11584
    s_waitcnt lgkmcnt(12)
    v_mfma_f32_16x16x32_bf16 v[120:123], v[96:99], v[36:39], v[120:123]
    v_mfma_f32_16x16x32_bf16 v[156:159], v[96:99], v[40:43], v[156:159]
    ds_read_b64_tr_b16 v[92:93], v15 offset:9312
    ds_read_b64_tr_b16 v[94:95], v15 offset:11616
    s_waitcnt lgkmcnt(12)
    v_mfma_f32_16x16x32_bf16 v[124:127], v[68:71], v[36:39], v[124:127]
    v_mfma_f32_16x16x32_bf16 v[160:163], v[68:71], v[40:43], v[160:163]
    s_add_u32 s52, s48, s51
    s_add_u32 s52, s52, 131072
    buffer_load_dwordx4 v[32:35], v12, s[28:31], s52 offen
    ds_read_b64_tr_b16 v[96:97], v15 offset:9344
    ds_read_b64_tr_b16 v[98:99], v15 offset:11648
    s_waitcnt lgkmcnt(12)
    v_mfma_f32_16x16x32_bf16 v[128:131], v[72:75], v[36:39], v[128:131]
    v_mfma_f32_16x16x32_bf16 v[164:167], v[72:75], v[40:43], v[164:167]
    s_mul_i32 s83, s82, 73728
    s_add_u32 s83, s83, s81
    s_add_u32 s82, s82, 1
    s_cmp_ge_u32 s82, 9
    s_cselect_b32 s82, 0, s82
    s_add_u32 m0, s80, 36992
    s_nop 0
    buffer_load_dwordx4 v7, s[16:19], s83 offen lds
    ds_read_b64_tr_b16 v[68:69], v15 offset:9376
    ds_read_b64_tr_b16 v[70:71], v15 offset:11680
    s_waitcnt lgkmcnt(12)
    v_mfma_f32_16x16x32_bf16 v[132:135], v[76:79], v[36:39], v[132:135]
    v_mfma_f32_16x16x32_bf16 v[168:171], v[76:79], v[40:43], v[168:171]
    ds_read_b64_tr_b16 v[72:73], v15 offset:9408
    ds_read_b64_tr_b16 v[74:75], v15 offset:11712
    s_waitcnt lgkmcnt(12)
    v_mfma_f32_16x16x32_bf16 v[100:103], v[80:83], v[44:47], v[100:103]
    v_mfma_f32_16x16x32_bf16 v[136:139], v[80:83], v[48:51], v[136:139]
    s_add_u32 m0, s80, 38016
    s_nop 0
    buffer_load_dwordx4 v8, s[16:19], s83 offen lds
    ds_read_b64_tr_b16 v[76:77], v15 offset:9440
    ds_read_b64_tr_b16 v[78:79], v15 offset:11744
    s_waitcnt lgkmcnt(12)
    v_mfma_f32_16x16x32_bf16 v[104:107], v[84:87], v[44:47], v[104:107]
    v_mfma_f32_16x16x32_bf16 v[140:143], v[84:87], v[48:51], v[140:143]
    ds_read_b64_tr_b16 v[80:81], v15 offset:9472
    ds_read_b64_tr_b16 v[82:83], v15 offset:11776
    s_waitcnt lgkmcnt(12)
    v_mfma_f32_16x16x32_bf16 v[108:111], v[88:91], v[44:47], v[108:111]
    v_mfma_f32_16x16x32_bf16 v[144:147], v[88:91], v[48:51], v[144:147]
    s_add_u32 m0, s80, 39040
    s_nop 0
    buffer_load_dwordx4 v9, s[16:19], s83 offen lds
    ds_read_b64_tr_b16 v[84:85], v16 offset:0
    ds_read_b64_tr_b16 v[86:87], v16 offset:2304
    s_waitcnt lgkmcnt(12)
    v_mfma_f32_16x16x32_bf16 v[112:115], v[92:95], v[44:47], v[112:115]
    v_mfma_f32_16x16x32_bf16 v[148:151], v[92:95], v[48:51], v[148:151]
    s_add_u32 m0, s80, 40064
    s_nop 0
    buffer_load_dwordx4 v10, s[16:19], s83 offen lds
    ds_read_b64_tr_b16 v[88:89], v16 offset:32
    ds_read_b64_tr_b16 v[90:91], v16 offset:2336
    s_waitcnt lgkmcnt(12)
    v_mfma_f32_16x16x32_bf16 v[116:119], v[96:99], v[44:47], v[116:119]
    v_mfma_f32_16x16x32_bf16 v[152:155], v[96:99], v[48:51], v[152:155]
    ds_read_b64_tr_b16 v[92:93], v16 offset:64
    ds_read_b64_tr_b16 v[94:95], v16 offset:2368
    s_waitcnt lgkmcnt(12)
    v_mfma_f32_16x16x32_bf16 v[120:123], v[68:71], v[44:47], v[120:123]
    v_mfma_f32_16x16x32_bf16 v[156:159], v[68:71], v[48:51], v[156:159]
    s_add_u32 m0, s80, 41088
    s_mov_b64 exec, 0xffffffff
    buffer_load_dwordx4 v11, s[16:19], s83 offen lds
    s_mov_b64 exec, -1
    ds_read_b64_tr_b16 v[96:97], v16 offset:96
    ds_read_b64_tr_b16 v[98:99], v16 offset:2400
    s_waitcnt lgkmcnt(12)
    v_mfma_f32_16x16x32_bf16 v[124:127], v[72:75], v[44:47], v[124:127]
    v_mfma_f32_16x16x32_bf16 v[160:163], v[72:75], v[48:51], v[160:163]
    ds_read_b64_tr_b16 v[68:69], v16 offset:128
    ds_read_b64_tr_b16 v[70:71], v16 offset:2432
    s_waitcnt lgkmcnt(12)
    v_mfma_f32_16x16x32_bf16 v[128:131], v[76:79], v[44:47], v[128:131]
    v_mfma_f32_16x16x32_bf16 v[164:167], v[76:79], v[48:51], v[164:167]
    ds_read_b64_tr_b16 v[72:73], v16 offset:160
    ds_read_b64_tr_b16 v[74:75], v16 offset:2464
    s_waitcnt lgkmcnt(12)
    v_mfma_f32_16x16x32_bf16 v[132:135], v[80:83], v[44:47], v[132:135]
    v_mfma_f32_16x16x32_bf16 v[168:171], v[80:83], v[48:51], v[168:171]
    s_waitcnt vmcnt(9)
    s_barrier
    ds_read_b64_tr_b16 v[76:77], v16 offset:192
    ds_read_b64_tr_b16 v[78:79], v16 offset:2496
    s_waitcnt lgkmcnt(12)
    v_mfma_f32_16x16x32_bf16 v[100:103], v[84:87], v[52:55], v[100:103]
    v_mfma_f32_16x16x32_bf16 v[136:139], v[84:87], v[56:59], v[136:139]
    ds_read_b64_tr_b16 v[80:81], v16 offset:224
    ds_read_b64_tr_b16 v[82:83], v16 offset:2528
    s_waitcnt lgkmcnt(12)
    v_mfma_f32_16x16x32_bf16 v[104:107], v[88:91], v[52:55], v[104:107]
    v_mfma_f32_16x16x32_bf16 v[140:143], v[88:91], v[56:59], v[140:143]
    s_lshl_b32 s51, s50, 18
    s_add_u32 s50, s50, 1
    s_cmp_ge_u32 s50, 9
    s_cselect_b32 s50, 0, s50
    s_add_u32 s52, s47, s51
    buffer_load_dwordx4 v[36:39], v12, s[28:31], s52 offen
    ds_read_b64_tr_b16 v[84:85], v16 offset:256
    ds_read_b64_tr_b16 v[86:87], v16 offset:2560
    s_waitcnt lgkmcnt(12)
    v_mfma_f32_16x16x32_bf16 v[108:111], v[92:95], v[52:55], v[108:111]
    v_mfma_f32_16x16x32_bf16 v[144:147], v[92:95], v[56:59], v[144:147]
    s_add_u32 s52, s48, s51
    buffer_load_dwordx4 v[40:43], v12, s[28:31], s52 offen
    ds_read_b64_tr_b16 v[88:89], v16 offset:9216
    ds_read_b64_tr_b16 v[90:91], v16 offset:11520
    s_waitcnt lgkmcnt(12)
    v_mfma_f32_16x16x32_bf16 v[112:115], v[96:99], v[52:55], v[112:115]
    v_mfma_f32_16x16x32_bf16 v[148:151], v[96:99], v[56:59], v[148:151]
    ds_read_b64_tr_b16 v[92:93], v16 offset:9248
    ds_read_b64_tr_b16 v[94:95], v16 offset:11552
    s_waitcnt lgkmcnt(12)
    v_mfma_f32_16x16x32_bf16 v[116:119], v[68:71], v[52:55], v[116:119]
    v_mfma_f32_16x16x32_bf16 v[152:155], v[68:71], v[56:59], v[152:155]
    s_add_u32 s52, s47, s51
    s_add_u32 s52, s52, 131072
    buffer_load_dwordx4 v[44:47], v12, s[28:31], s52 offen
    ds_read_b64_tr_b16 v[96:97], v16 offset:9280
    ds_read_b64_tr_b16 v[98:99], v16 offset:11584
    s_waitcnt lgkmcnt(12)
    v_mfma_f32_16x16x32_bf16 v[120:123], v[72:75], v[52:55], v[120:123]
    v_mfma_f32_16x16x32_bf16 v[156:159], v[72:75], v[56:59], v[156:159]
    ds_read_b64_tr_b16 v[68:69], v16 offset:9312
    ds_read_b64_tr_b16 v[70:71], v16 offset:11616
    s_waitcnt lgkmcnt(12)
    v_mfma_f32_16x16x32_bf16 v[124:127], v[76:79], v[52:55], v[124:127]
    v_mfma_f32_16x16x32_bf16 v[160:163], v[76:79], v[56:59], v[160:163]
    s_add_u32 s52, s48, s51
    s_add_u32 s52, s52, 131072
    buffer_load_dwordx4 v[48:51], v12, s[28:31], s52 offen
    ds_read_b64_tr_b16 v[72:73], v16 offset:9344
    ds_read_b64_tr_b16 v[74:75], v16 offset:11648
    s_waitcnt lgkmcnt(12)
    v_mfma_f32_16x16x32_bf16 v[128:131], v[80:83], v[52:55], v[128:131]
    v_mfma_f32_16x16x32_bf16 v[164:167], v[80:83], v[56:59], v[164:167]
    s_mul_i32 s83, s82, 73728
    s_add_u32 s83, s83, s81
    s_add_u32 s82, s82, 1
    s_cmp_ge_u32 s82, 9
    s_cselect_b32 s82, 0, s82
    s_add_u32 m0, s80, 73984
    s_nop 0
    buffer_load_dwordx4 v7, s[16:19], s83 offen lds
    ds_read_b64_tr_b16 v[76:77], v16 offset:9376
    ds_read_b64_tr_b16 v[78:79], v16 offset:11680
    s_waitcnt lgkmcnt(12)
    v_mfma_f32_16x16x32_bf16 v[132:135], v[84:87], v[52:55], v[132:135]
    v_mfma_f32_16x16x32_bf16 v[168:171], v[84:87], v[56:59], v[168:171]
    ds_read_b64_tr_b16 v[80:81], v16 offset:9408
    ds_read_b64_tr_b16 v[82:83], v16 offset:11712
    s_waitcnt lgkmcnt(12)
    v_mfma_f32_16x16x32_bf16 v[100:103], v[88:91], v[60:63], v[100:103]
    v_mfma_f32_16x16x32_bf16 v[136:139], v[88:91], v[64:67], v[136:139]
    s_add_u32 m0, s80, 75008
    s_nop 0
    buffer_load_dwordx4 v8, s[16:19], s83 offen lds
    ds_read_b64_tr_b16 v[84:85], v16 offset:9440
    ds_read_b64_tr_b16 v[86:87], v16 offset:11744
    s_waitcnt lgkmcnt(12)
    v_mfma_f32_16x16x32_bf16 v[104:107], v[92:95], v[60:63], v[104:107]
    v_mfma_f32_16x16x32_bf16 v[140:143], v[92:95], v[64:67], v[140:143]
    ds_read_b64_tr_b16 v[88:89], v16 offset:9472
    ds_read_b64_tr_b16 v[90:91], v16 offset:11776
    s_waitcnt lgkmcnt(12)
    v_mfma_f32_16x16x32_bf16 v[108:111], v[96:99], v[60:63], v[108:111]
    v_mfma_f32_16x16x32_bf16 v[144:147], v[96:99], v[64:67], v[144:147]
    s_add_u32 m0, s80, 76032
    s_nop 0
    buffer_load_dwordx4 v9, s[16:19], s83 offen lds
    ds_read_b64_tr_b16 v[92:93], v13 offset:0
    ds_read_b64_tr_b16 v[94:95], v13 offset:2304
    s_waitcnt lgkmcnt(12)
    v_mfma_f32_16x16x32_bf16 v[112:115], v[68:71], v[60:63], v[112:115]
    v_mfma_f32_16x16x32_bf16 v[148:151], v[68:71], v[64:67], v[148:151]
    s_add_u32 m0, s80, 77056
    s_nop 0
    buffer_load_dwordx4 v10, s[16:19], s83 offen lds
    ds_read_b64_tr_b16 v[96:97], v13 offset:32
    ds_read_b64_tr_b16 v[98:99], v13 offset:2336
    s_waitcnt lgkmcnt(12)
    v_mfma_f32_16x16x32_bf16 v[116:119], v[72:75], v[60:63], v[116:119]
    v_mfma_f32_16x16x32_bf16 v[152:155], v[72:75], v[64:67], v[152:155]
    ds_read_b64_tr_b16 v[68:69], v13 offset:64
    ds_read_b64_tr_b16 v[70:71], v13 offset:2368
    s_waitcnt lgkmcnt(12)
    v_mfma_f32_16x16x32_bf16 v[120:123], v[76:79], v[60:63], v[120:123]
    v_mfma_f32_16x16x32_bf16 v[156:159], v[76:79], v[64:67], v[156:159]
    s_add_u32 m0, s80, 78080
    s_mov_b64 exec, 0xffffffff
    buffer_load_dwordx4 v11, s[16:19], s83 offen lds
    s_mov_b64 exec, -1
    ds_read_b64_tr_b16 v[72:73], v13 offset:96
    ds_read_b64_tr_b16 v[74:75], v13 offset:2400
    s_waitcnt lgkmcnt(12)
    v_mfma_f32_16x16x32_bf16 v[124:127], v[80:83], v[60:63], v[124:127]
    v_mfma_f32_16x16x32_bf16 v[160:163], v[80:83], v[64:67], v[160:163]
    ds_read_b64_tr_b16 v[76:77], v13 offset:128
    ds_read_b64_tr_b16 v[78:79], v13 offset:2432
    s_waitcnt lgkmcnt(12)
    v_mfma_f32_16x16x32_bf16 v[128:131], v[84:87], v[60:63], v[128:131]
    v_mfma_f32_16x16x32_bf16 v[164:167], v[84:87], v[64:67], v[164:167]
    ds_read_b64_tr_b16 v[80:81], v13 offset:160
    ds_read_b64_tr_b16 v[82:83], v13 offset:2464
    s_waitcnt lgkmcnt(12)
    v_mfma_f32_16x16x32_bf16 v[132:135], v[88:91], v[60:63], v[132:135]
    v_mfma_f32_16x16x32_bf16 v[168:171], v[88:91], v[64:67], v[168:171]
    s_waitcnt vmcnt(9)
    s_barrier
    ds_read_b64_tr_b16 v[84:85], v13 offset:192
    ds_read_b64_tr_b16 v[86:87], v13 offset:2496
    s_waitcnt lgkmcnt(12)
    v_mfma_f32_16x16x32_bf16 v[100:103], v[92:95], v[20:23], v[100:103]
    v_mfma_f32_16x16x32_bf16 v[136:139], v[92:95], v[24:27], v[136:139]
    ds_read_b64_tr_b16 v[88:89], v13 offset:224
    ds_read_b64_tr_b16 v[90:91], v13 offset:2528
    s_waitcnt lgkmcnt(12)
    v_mfma_f32_16x16x32_bf16 v[104:107], v[96:99], v[20:23], v[104:107]
    v_mfma_f32_16x16x32_bf16 v[140:143], v[96:99], v[24:27], v[140:143]
    s_lshl_b32 s51, s50, 18
    s_add_u32 s50, s50, 1
    s_cmp_ge_u32 s50, 9
    s_cselect_b32 s50, 0, s50
    s_add_u32 s52, s47, s51
    buffer_load_dwordx4 v[52:55], v12, s[28:31], s52 offen
    ds_read_b64_tr_b16 v[92:93], v13 offset:256
    ds_read_b64_tr_b16 v[94:95], v13 offset:2560
    s_waitcnt lgkmcnt(12)
    v_mfma_f32_16x16x32_bf16 v[108:111], v[68:71], v[20:23], v[108:111]
    v_mfma_f32_16x16x32_bf16 v[144:147], v[68:71], v[24:27], v[144:147]
    s_add_u32 s52, s48, s51
    buffer_load_dwordx4 v[56:59], v12, s[28:31], s52 offen
    ds_read_b64_tr_b16 v[96:97], v13 offset:9216
    ds_read_b64_tr_b16 v[98:99], v13 offset:11520
    s_waitcnt lgkmcnt(12)
    v_mfma_f32_16x16x32_bf16 v[112:115], v[72:75], v[20:23], v[112:115]
    v_mfma_f32_16x16x32_bf16 v[148:151], v[72:75], v[24:27], v[148:151]
    ds_read_b64_tr_b16 v[68:69], v13 offset:9248
    ds_read_b64_tr_b16 v[70:71], v13 offset:11552
    s_waitcnt lgkmcnt(12)
    v_mfma_f32_16x16x32_bf16 v[116:119], v[76:79], v[20:23], v[116:119]
    v_mfma_f32_16x16x32_bf16 v[152:155], v[76:79], v[24:27], v[152:155]
    s_add_u32 s52, s47, s51
    s_add_u32 s52, s52, 131072
    buffer_load_dwordx4 v[60:63], v12, s[28:31], s52 offen
    ds_read_b64_tr_b16 v[72:73], v13 offset:9280
    ds_read_b64_tr_b16 v[74:75], v13 offset:11584
    s_waitcnt lgkmcnt(12)
    v_mfma_f32_16x16x32_bf16 v[120:123], v[80:83], v[20:23], v[120:123]
    v_mfma_f32_16x16x32_bf16 v[156:159], v[80:83], v[24:27], v[156:159]
    ds_read_b64_tr_b16 v[76:77], v13 offset:9312
    ds_read_b64_tr_b16 v[78:79], v13 offset:11616
    s_waitcnt lgkmcnt(12)
    v_mfma_f32_16x16x32_bf16 v[124:127], v[84:87], v[20:23], v[124:127]
    v_mfma_f32_16x16x32_bf16 v[160:163], v[84:87], v[24:27], v[160:163]
    s_add_u32 s52, s48, s51
    s_add_u32 s52, s52, 131072
    buffer_load_dwordx4 v[64:67], v12, s[28:31], s52 offen
    ds_read_b64_tr_b16 v[80:81], v13 offset:9344
    ds_read_b64_tr_b16 v[82:83], v13 offset:11648
    s_waitcnt lgkmcnt(12)
    v_mfma_f32_16x16x32_bf16 v[128:131], v[88:91], v[20:23], v[128:131]
    v_mfma_f32_16x16x32_bf16 v[164:167], v[88:91], v[24:27], v[164:167]
    s_mul_i32 s83, s82, 73728
    s_add_u32 s83, s83, s81
    s_add_u32 s82, s82, 1
    s_cmp_ge_u32 s82, 9
    s_cselect_b32 s82, 0, s82
    s_add_u32 m0, s80, 110976
    s_nop 0
    buffer_load_dwordx4 v7, s[16:19], s83 offen lds
    ds_read_b64_tr_b16 v[84:85], v13 offset:9376
    ds_read_b64_tr_b16 v[86:87], v13 offset:11680
    s_waitcnt lgkmcnt(12)
    v_mfma_f32_16x16x32_bf16 v[132:135], v[92:95], v[20:23], v[132:135]
    v_mfma_f32_16x16x32_bf16 v[168:171], v[92:95], v[24:27], v[168:171]
    ds_read_b64_tr_b16 v[88:89], v13 offset:9408
    ds_read_b64_tr_b16 v[90:91], v13 offset:11712
    s_waitcnt lgkmcnt(12)
    v_mfma_f32_16x16x32_bf16 v[100:103], v[96:99], v[28:31], v[100:103]
    v_mfma_f32_16x16x32_bf16 v[136:139], v[96:99], v[32:35], v[136:139]
    s_add_u32 m0, s80, 112000
    s_nop 0
    buffer_load_dwordx4 v8, s[16:19], s83 offen lds
    ds_read_b64_tr_b16 v[92:93], v13 offset:9440
    ds_read_b64_tr_b16 v[94:95], v13 offset:11744
    s_waitcnt lgkmcnt(12)
    v_mfma_f32_16x16x32_bf16 v[104:107], v[68:71], v[28:31], v[104:107]
    v_mfma_f32_16x16x32_bf16 v[140:143], v[68:71], v[32:35], v[140:143]
    ds_read_b64_tr_b16 v[96:97], v13 offset:9472
    ds_read_b64_tr_b16 v[98:99], v13 offset:11776
    s_waitcnt lgkmcnt(12)
    v_mfma_f32_16x16x32_bf16 v[108:111], v[72:75], v[28:31], v[108:111]
    v_mfma_f32_16x16x32_bf16 v[144:147], v[72:75], v[32:35], v[144:147]
    s_add_u32 m0, s80, 113024
    s_nop 0
    buffer_load_dwordx4 v9, s[16:19], s83 offen lds
    ds_read_b64_tr_b16 v[68:69], v14 offset:0
    ds_read_b64_tr_b16 v[70:71], v14 offset:2304
    s_waitcnt lgkmcnt(12)
    v_mfma_f32_16x16x32_bf16 v[112:115], v[76:79], v[28:31], v[112:115]
    v_mfma_f32_16x16x32_bf16 v[148:151], v[76:79], v[32:35], v[148:151]
    s_add_u32 m0, s80, 114048
    s_nop 0
    buffer_load_dwordx4 v10, s[16:19], s83 offen lds
    ds_read_b64_tr_b16 v[72:73], v14 offset:32
    ds_read_b64_tr_b16 v[74:75], v14 offset:2336
    s_waitcnt lgkmcnt(12)
    v_mfma_f32_16x16x32_bf16 v[116:119], v[80:83], v[28:31], v[116:119]
    v_mfma_f32_16x16x32_bf16 v[152:155], v[80:83], v[32:35], v[152:155]
    ds_read_b64_tr_b16 v[76:77], v14 offset:64
    ds_read_b64_tr_b16 v[78:79], v14 offset:2368
    s_waitcnt lgkmcnt(12)
    v_mfma_f32_16x16x32_bf16 v[120:123], v[84:87], v[28:31], v[120:123]
    v_mfma_f32_16x16x32_bf16 v[156:159], v[84:87], v[32:35], v[156:159]
    s_add_u32 m0, s80, 115072
    s_mov_b64 exec, 0xffffffff
    buffer_load_dwordx4 v11, s[16:19], s83 offen lds
    s_mov_b64 exec, -1
    ds_read_b64_tr_b16 v[80:81], v14 offset:96
    ds_read_b64_tr_b16 v[82:83], v14 offset:2400
    s_waitcnt lgkmcnt(12)
    v_mfma_f32_16x16x32_bf16 v[124:127], v[88:91], v[28:31], v[124:127]
    v_mfma_f32_16x16x32_bf16 v[160:163], v[88:91], v[32:35], v[160:163]
    ds_read_b64_tr_b16 v[84:85], v14 offset:128
    ds_read_b64_tr_b16 v[86:87], v14 offset:2432
    s_waitcnt lgkmcnt(12)
    v_mfma_f32_16x16x32_bf16 v[128:131], v[92:95], v[28:31], v[128:131]
    v_mfma_f32_16x16x32_bf16 v[164:167], v[92:95], v[32:35], v[164:167]
    ds_read_b64_tr_b16 v[88:89], v14 offset:160
    ds_read_b64_tr_b16 v[90:91], v14 offset:2464
    s_waitcnt lgkmcnt(12)
    v_mfma_f32_16x16x32_bf16 v[132:135], v[96:99], v[28:31], v[132:135]
    v_mfma_f32_16x16x32_bf16 v[168:171], v[96:99], v[32:35], v[168:171]
    s_waitcnt vmcnt(9)
    s_barrier
    ds_read_b64_tr_b16 v[92:93], v14 offset:192
    ds_read_b64_tr_b16 v[94:95], v14 offset:2496
    s_waitcnt lgkmcnt(12)
    v_mfma_f32_16x16x32_bf16 v[100:103], v[68:71], v[36:39], v[100:103]
    v_mfma_f32_16x16x32_bf16 v[136:139], v[68:71], v[40:43], v[136:139]
    ds_read_b64_tr_b16 v[96:97], v14 offset:224
    ds_read_b64_tr_b16 v[98:99], v14 offset:2528
    s_waitcnt lgkmcnt(12)
    v_mfma_f32_16x16x32_bf16 v[104:107], v[72:75], v[36:39], v[104:107]
    v_mfma_f32_16x16x32_bf16 v[140:143], v[72:75], v[40:43], v[140:143]
    s_lshl_b32 s51, s50, 18
    s_add_u32 s50, s50, 1
    s_cmp_ge_u32 s50, 9
    s_cselect_b32 s50, 0, s50
    s_add_u32 s52, s47, s51
    buffer_load_dwordx4 v[20:23], v12, s[28:31], s52 offen
    ds_read_b64_tr_b16 v[68:69], v14 offset:256
    ds_read_b64_tr_b16 v[70:71], v14 offset:2560
    s_waitcnt lgkmcnt(12)
    v_mfma_f32_16x16x32_bf16 v[108:111], v[76:79], v[36:39], v[108:111]
    v_mfma_f32_16x16x32_bf16 v[144:147], v[76:79], v[40:43], v[144:147]
    s_add_u32 s52, s48, s51
    buffer_load_dwordx4 v[24:27], v12, s[28:31], s52 offen
    ds_read_b64_tr_b16 v[72:73], v14 offset:9216
    ds_read_b64_tr_b16 v[74:75], v14 offset:11520
    s_waitcnt lgkmcnt(12)
    v_mfma_f32_16x16x32_bf16 v[112:115], v[80:83], v[36:39], v[112:115]
    v_mfma_f32_16x16x32_bf16 v[148:151], v[80:83], v[40:43], v[148:151]
    ds_read_b64_tr_b16 v[76:77], v14 offset:9248
    ds_read_b64_tr_b16 v[78:79], v14 offset:11552
    s_waitcnt lgkmcnt(12)
    v_mfma_f32_16x16x32_bf16 v[116:119], v[84:87], v[36:39], v[116:119]
    v_mfma_f32_16x16x32_bf16 v[152:155], v[84:87], v[40:43], v[152:155]
    s_add_u32 s52, s47, s51
    s_add_u32 s52, s52, 131072
    buffer_load_dwordx4 v[28:31], v12, s[28:31], s52 offen
    ds_read_b64_tr_b16 v[80:81], v14 offset:9280
    ds_read_b64_tr_b16 v[82:83], v14 offset:11584
    s_waitcnt lgkmcnt(12)
    v_mfma_f32_16x16x32_bf16 v[120:123], v[88:91], v[36:39], v[120:123]
    v_mfma_f32_16x16x32_bf16 v[156:159], v[88:91], v[40:43], v[156:159]
    ds_read_b64_tr_b16 v[84:85], v14 offset:9312
    ds_read_b64_tr_b16 v[86:87], v14 offset:11616
    s_waitcnt lgkmcnt(12)
    v_mfma_f32_16x16x32_bf16 v[124:127], v[92:95], v[36:39], v[124:127]
    v_mfma_f32_16x16x32_bf16 v[160:163], v[92:95], v[40:43], v[160:163]
    s_add_u32 s52, s48, s51
    s_add_u32 s52, s52, 131072
    buffer_load_dwordx4 v[32:35], v12, s[28:31], s52 offen
    ds_read_b64_tr_b16 v[88:89], v14 offset:9344
    ds_read_b64_tr_b16 v[90:91], v14 offset:11648
    s_waitcnt lgkmcnt(12)
    v_mfma_f32_16x16x32_bf16 v[128:131], v[96:99], v[36:39], v[128:131]
    v_mfma_f32_16x16x32_bf16 v[164:167], v[96:99], v[40:43], v[164:167]
    s_mul_i32 s83, s82, 73728
    s_add_u32 s83, s83, s81
    s_add_u32 s82, s82, 1
    s_cmp_ge_u32 s82, 9
    s_cselect_b32 s82, 0, s82
    s_add_u32 m0, s80, 0
    s_nop 0
    buffer_load_dwordx4 v7, s[16:19], s83 offen lds
    ds_read_b64_tr_b16 v[92:93], v14 offset:9376
    ds_read_b64_tr_b16 v[94:95], v14 offset:11680
    s_waitcnt lgkmcnt(12)
    v_mfma_f32_16x16x32_bf16 v[132:135], v[68:71], v[36:39], v[132:135]
    v_mfma_f32_16x16x32_bf16 v[168:171], v[68:71], v[40:43], v[168:171]
    ds_read_b64_tr_b16 v[96:97], v14 offset:9408
    ds_read_b64_tr_b16 v[98:99], v14 offset:11712
    s_waitcnt lgkmcnt(12)
    v_mfma_f32_16x16x32_bf16 v[100:103], v[72:75], v[44:47], v[100:103]
    v_mfma_f32_16x16x32_bf16 v[136:139], v[72:75], v[48:51], v[136:139]
    s_add_u32 m0, s80, 1024
    s_nop 0
    buffer_load_dwordx4 v8, s[16:19], s83 offen lds
    ds_read_b64_tr_b16 v[68:69], v14 offset:9440
    ds_read_b64_tr_b16 v[70:71], v14 offset:11744
    s_waitcnt lgkmcnt(12)
    v_mfma_f32_16x16x32_bf16 v[104:107], v[76:79], v[44:47], v[104:107]
    v_mfma_f32_16x16x32_bf16 v[140:143], v[76:79], v[48:51], v[140:143]
    ds_read_b64_tr_b16 v[72:73], v14 offset:9472
    ds_read_b64_tr_b16 v[74:75], v14 offset:11776
    s_waitcnt lgkmcnt(12)
    v_mfma_f32_16x16x32_bf16 v[108:111], v[80:83], v[44:47], v[108:111]
    v_mfma_f32_16x16x32_bf16 v[144:147], v[80:83], v[48:51], v[144:147]
    s_add_u32 m0, s80, 2048
    s_nop 0
    buffer_load_dwordx4 v9, s[16:19], s83 offen lds
    ds_read_b64_tr_b16 v[76:77], v15 offset:0
    ds_read_b64_tr_b16 v[78:79], v15 offset:2304
    s_waitcnt lgkmcnt(12)
    v_mfma_f32_16x16x32_bf16 v[112:115], v[84:87], v[44:47], v[112:115]
    v_mfma_f32_16x16x32_bf16 v[148:151], v[84:87], v[48:51], v[148:151]
    s_add_u32 m0, s80, 3072
    s_nop 0
    buffer_load_dwordx4 v10, s[16:19], s83 offen lds
    ds_read_b64_tr_b16 v[80:81], v15 offset:32
    ds_read_b64_tr_b16 v[82:83], v15 offset:2336
    s_waitcnt lgkmcnt(12)
    v_mfma_f32_16x16x32_bf16 v[116:119], v[88:91], v[44:47], v[116:119]
    v_mfma_f32_16x16x32_bf16 v[152:155], v[88:91], v[48:51], v[152:155]
    ds_read_b64_tr_b16 v[84:85], v15 offset:64
    ds_read_b64_tr_b16 v[86:87], v15 offset:2368
    s_waitcnt lgkmcnt(12)
    v_mfma_f32_16x16x32_bf16 v[120:123], v[92:95], v[44:47], v[120:123]
    v_mfma_f32_16x16x32_bf16 v[156:159], v[92:95], v[48:51], v[156:159]
    s_add_u32 m0, s80, 4096
    s_mov_b64 exec, 0xffffffff
    buffer_load_dwordx4 v11, s[16:19], s83 offen lds
    s_mov_b64 exec, -1
    ds_read_b64_tr_b16 v[88:89], v15 offset:96
    ds_read_b64_tr_b16 v[90:91], v15 offset:2400
    s_waitcnt lgkmcnt(12)
    v_mfma_f32_16x16x32_bf16 v[124:127], v[96:99], v[44:47], v[124:127]
    v_mfma_f32_16x16x32_bf16 v[160:163], v[96:99], v[48:51], v[160:163]
    ds_read_b64_tr_b16 v[92:93], v15 offset:128
    ds_read_b64_tr_b16 v[94:95], v15 offset:2432
    s_waitcnt lgkmcnt(12)
    v_mfma_f32_16x16x32_bf16 v[128:131], v[68:71], v[44:47], v[128:131]
    v_mfma_f32_16x16x32_bf16 v[164:167], v[68:71], v[48:51], v[164:167]
    ds_read_b64_tr_b16 v[96:97], v15 offset:160
    ds_read_b64_tr_b16 v[98:99], v15 offset:2464
    s_waitcnt lgkmcnt(12)
    v_mfma_f32_16x16x32_bf16 v[132:135], v[72:75], v[44:47], v[132:135]
    v_mfma_f32_16x16x32_bf16 v[168:171], v[72:75], v[48:51], v[168:171]
    s_waitcnt vmcnt(9)
    s_barrier
    ds_read_b64_tr_b16 v[68:69], v15 offset:192
    ds_read_b64_tr_b16 v[70:71], v15 offset:2496
    s_waitcnt lgkmcnt(12)
    v_mfma_f32_16x16x32_bf16 v[100:103], v[76:79], v[52:55], v[100:103]
    v_mfma_f32_16x16x32_bf16 v[136:139], v[76:79], v[56:59], v[136:139]
    ds_read_b64_tr_b16 v[72:73], v15 offset:224
    ds_read_b64_tr_b16 v[74:75], v15 offset:2528
    s_waitcnt lgkmcnt(12)
    v_mfma_f32_16x16x32_bf16 v[104:107], v[80:83], v[52:55], v[104:107]
    v_mfma_f32_16x16x32_bf16 v[140:143], v[80:83], v[56:59], v[140:143]
    s_lshl_b32 s51, s50, 18
    s_add_u32 s50, s50, 1
    s_cmp_ge_u32 s50, 9
    s_cselect_b32 s50, 0, s50
    s_add_u32 s52, s47, s51
    buffer_load_dwordx4 v[36:39], v12, s[28:31], s52 offen
    ds_read_b64_tr_b16 v[76:77], v15 offset:256
    ds_read_b64_tr_b16 v[78:79], v15 offset:2560
    s_waitcnt lgkmcnt(12)
    v_mfma_f32_16x16x32_bf16 v[108:111], v[84:87], v[52:55], v[108:111]
    v_mfma_f32_16x16x32_bf16 v[144:147], v[84:87], v[56:59], v[144:147]
    s_add_u32 s52, s48, s51
    buffer_load_dwordx4 v[40:43], v12, s[28:31], s52 offen
    ds_read_b64_tr_b16 v[80:81], v15 offset:9216
    ds_read_b64_tr_b16 v[82:83], v15 offset:11520
    s_waitcnt lgkmcnt(12)
    v_mfma_f32_16x16x32_bf16 v[112:115], v[88:91], v[52:55], v[112:115]
    v_mfma_f32_16x16x32_bf16 v[148:151], v[88:91], v[56:59], v[148:151]
    ds_read_b64_tr_b16 v[84:85], v15 offset:9248
    ds_read_b64_tr_b16 v[86:87], v15 offset:11552
    s_waitcnt lgkmcnt(12)
    v_mfma_f32_16x16x32_bf16 v[116:119], v[92:95], v[52:55], v[116:119]
    v_mfma_f32_16x16x32_bf16 v[152:155], v[92:95], v[56:59], v[152:155]
    s_add_u32 s52, s47, s51
    s_add_u32 s52, s52, 131072
    buffer_load_dwordx4 v[44:47], v12, s[28:31], s52 offen
    ds_read_b64_tr_b16 v[88:89], v15 offset:9280
    ds_read_b64_tr_b16 v[90:91], v15 offset:11584
    s_waitcnt lgkmcnt(12)
    v_mfma_f32_16x16x32_bf16 v[120:123], v[96:99], v[52:55], v[120:123]
    v_mfma_f32_16x16x32_bf16 v[156:159], v[96:99], v[56:59], v[156:159]
    ds_read_b64_tr_b16 v[92:93], v15 offset:9312
    ds_read_b64_tr_b16 v[94:95], v15 offset:11616
    s_waitcnt lgkmcnt(12)
    v_mfma_f32_16x16x32_bf16 v[124:127], v[68:71], v[52:55], v[124:127]
    v_mfma_f32_16x16x32_bf16 v[160:163], v[68:71], v[56:59], v[160:163]
    s_add_u32 s52, s48, s51
    s_add_u32 s52, s52, 131072
    buffer_load_dwordx4 v[48:51], v12, s[28:31], s52 offen
    ds_read_b64_tr_b16 v[96:97], v15 offset:9344
    ds_read_b64_tr_b16 v[98:99], v15 offset:11648
    s_waitcnt lgkmcnt(12)
    v_mfma_f32_16x16x32_bf16 v[128:131], v[72:75], v[52:55], v[128:131]
    v_mfma_f32_16x16x32_bf16 v[164:167], v[72:75], v[56:59], v[164:167]
    s_mul_i32 s83, s82, 73728
    s_add_u32 s83, s83, s81
    s_add_u32 s82, s82, 1
    s_cmp_ge_u32 s82, 9
    s_cselect_b32 s82, 0, s82
    s_add_u32 m0, s80, 36992
    s_nop 0
    buffer_load_dwordx4 v7, s[16:19], s83 offen lds
    ds_read_b64_tr_b16 v[68:69], v15 offset:9376
    ds_read_b64_tr_b16 v[70:71], v15 offset:11680
    s_waitcnt lgkmcnt(12)
    v_mfma_f32_16x16x32_bf16 v[132:135], v[76:79], v[52:55], v[132:135]
    v_mfma_f32_16x16x32_bf16 v[168:171], v[76:79], v[56:59], v[168:171]
    ds_read_b64_tr_b16 v[72:73], v15 offset:9408
    ds_read_b64_tr_b16 v[74:75], v15 offset:11712
    s_waitcnt lgkmcnt(12)
    v_mfma_f32_16x16x32_bf16 v[100:103], v[80:83], v[60:63], v[100:103]
    v_mfma_f32_16x16x32_bf16 v[136:139], v[80:83], v[64:67], v[136:139]
    s_add_u32 m0, s80, 38016
    s_nop 0
    buffer_load_dwordx4 v8, s[16:19], s83 offen lds
    ds_read_b64_tr_b16 v[76:77], v15 offset:9440
    ds_read_b64_tr_b16 v[78:79], v15 offset:11744
    s_waitcnt lgkmcnt(12)
    v_mfma_f32_16x16x32_bf16 v[104:107], v[84:87], v[60:63], v[104:107]
    v_mfma_f32_16x16x32_bf16 v[140:143], v[84:87], v[64:67], v[140:143]
    ds_read_b64_tr_b16 v[80:81], v15 offset:9472
    ds_read_b64_tr_b16 v[82:83], v15 offset:11776
    s_waitcnt lgkmcnt(12)
    v_mfma_f32_16x16x32_bf16 v[108:111], v[88:91], v[60:63], v[108:111]
    v_mfma_f32_16x16x32_bf16 v[144:147], v[88:91], v[64:67], v[144:147]
    s_add_u32 m0, s80, 39040
    s_nop 0
    buffer_load_dwordx4 v9, s[16:19], s83 offen lds
    ds_read_b64_tr_b16 v[84:85], v16 offset:0
    ds_read_b64_tr_b16 v[86:87], v16 offset:2304
    s_waitcnt lgkmcnt(12)
    v_mfma_f32_16x16x32_bf16 v[112:115], v[92:95], v[60:63], v[112:115]
    v_mfma_f32_16x16x32_bf16 v[148:151], v[92:95], v[64:67], v[148:151]
    s_add_u32 m0, s80, 40064
    s_nop 0
    buffer_load_dwordx4 v10, s[16:19], s83 offen lds
    ds_read_b64_tr_b16 v[88:89], v16 offset:32
    ds_read_b64_tr_b16 v[90:91], v16 offset:2336
    s_waitcnt lgkmcnt(12)
    v_mfma_f32_16x16x32_bf16 v[116:119], v[96:99], v[60:63], v[116:119]
    v_mfma_f32_16x16x32_bf16 v[152:155], v[96:99], v[64:67], v[152:155]
    ds_read_b64_tr_b16 v[92:93], v16 offset:64
    ds_read_b64_tr_b16 v[94:95], v16 offset:2368
    s_waitcnt lgkmcnt(12)
    v_mfma_f32_16x16x32_bf16 v[120:123], v[68:71], v[60:63], v[120:123]
    v_mfma_f32_16x16x32_bf16 v[156:159], v[68:71], v[64:67], v[156:159]
    s_add_u32 m0, s80, 41088
    s_mov_b64 exec, 0xffffffff
    buffer_load_dwordx4 v11, s[16:19], s83 offen lds
    s_mov_b64 exec, -1
    ds_read_b64_tr_b16 v[96:97], v16 offset:96
    ds_read_b64_tr_b16 v[98:99], v16 offset:2400
    s_waitcnt lgkmcnt(12)
    v_mfma_f32_16x16x32_bf16 v[124:127], v[72:75], v[60:63], v[124:127]
    v_mfma_f32_16x16x32_bf16 v[160:163], v[72:75], v[64:67], v[160:163]
    ds_read_b64_tr_b16 v[68:69], v16 offset:128
    ds_read_b64_tr_b16 v[70:71], v16 offset:2432
    s_waitcnt lgkmcnt(12)
    v_mfma_f32_16x16x32_bf16 v[128:131], v[76:79], v[60:63], v[128:131]
    v_mfma_f32_16x16x32_bf16 v[164:167], v[76:79], v[64:67], v[164:167]
    ds_read_b64_tr_b16 v[72:73], v16 offset:160
    ds_read_b64_tr_b16 v[74:75], v16 offset:2464
    s_waitcnt lgkmcnt(12)
    v_mfma_f32_16x16x32_bf16 v[132:135], v[80:83], v[60:63], v[132:135]
    v_mfma_f32_16x16x32_bf16 v[168:171], v[80:83], v[64:67], v[168:171]
    s_waitcnt vmcnt(9)
    s_barrier
    ds_read_b64_tr_b16 v[76:77], v16 offset:192
    ds_read_b64_tr_b16 v[78:79], v16 offset:2496
    s_waitcnt lgkmcnt(12)
    v_mfma_f32_16x16x32_bf16 v[100:103], v[84:87], v[20:23], v[100:103]
    v_mfma_f32_16x16x32_bf16 v[136:139], v[84:87], v[24:27], v[136:139]
    ds_read_b64_tr_b16 v[80:81], v16 offset:224
    ds_read_b64_tr_b16 v[82:83], v16 offset:2528
    s_waitcnt lgkmcnt(12)
    v_mfma_f32_16x16x32_bf16 v[104:107], v[88:91], v[20:23], v[104:107]
    v_mfma_f32_16x16x32_bf16 v[140:143], v[88:91], v[24:27], v[140:143]
    s_lshl_b32 s51, s50, 18
    s_add_u32 s50, s50, 1
    s_cmp_ge_u32 s50, 9
    s_cselect_b32 s50, 0, s50
    s_add_u32 s52, s47, s51
    buffer_load_dwordx4 v[52:55], v12, s[28:31], s52 offen
    ds_read_b64_tr_b16 v[84:85], v16 offset:256
    ds_read_b64_tr_b16 v[86:87], v16 offset:2560
    s_waitcnt lgkmcnt(12)
    v_mfma_f32_16x16x32_bf16 v[108:111], v[92:95], v[20:23], v[108:111]
    v_mfma_f32_16x16x32_bf16 v[144:147], v[92:95], v[24:27], v[144:147]
    ds_read_b64_tr_b16 v[88:89], v16 offset:9216
    ds_read_b64_tr_b16 v[90:91], v16 offset:11520
    s_waitcnt lgkmcnt(12)
    v_mfma_f32_16x16x32_bf16 v[112:115], v[96:99], v[20:23], v[112:115]
    v_mfma_f32_16x16x32_bf16 v[148:151], v[96:99], v[24:27], v[148:151]
    ds_read_b64_tr_b16 v[92:93], v16 offset:9248
    ds_read_b64_tr_b16 v[94:95], v16 offset:11552
    s_waitcnt lgkmcnt(12)
    v_mfma_f32_16x16x32_bf16 v[116:119], v[68:71], v[20:23], v[116:119]
    v_mfma_f32_16x16x32_bf16 v[152:155], v[68:71], v[24:27], v[152:155]
    s_add_u32 s52, s48, s51
    buffer_load_dwordx4 v[56:59], v12, s[28:31], s52 offen
    ds_read_b64_tr_b16 v[96:97], v16 offset:9280
    ds_read_b64_tr_b16 v[98:99], v16 offset:11584
    s_waitcnt lgkmcnt(12)
    v_mfma_f32_16x16x32_bf16 v[120:123], v[72:75], v[20:23], v[120:123]
    v_mfma_f32_16x16x32_bf16 v[156:159], v[72:75], v[24:27], v[156:159]
    ds_read_b64_tr_b16 v[68:69], v16 offset:9312
    ds_read_b64_tr_b16 v[70:71], v16 offset:11616
    s_waitcnt lgkmcnt(12)
    v_mfma_f32_16x16x32_bf16 v[124:127], v[76:79], v[20:23], v[124:127]
    v_mfma_f32_16x16x32_bf16 v[160:163], v[76:79], v[24:27], v[160:163]
    ds_read_b64_tr_b16 v[72:73], v16 offset:9344
    ds_read_b64_tr_b16 v[74:75], v16 offset:11648
    s_waitcnt lgkmcnt(12)
    v_mfma_f32_16x16x32_bf16 v[128:131], v[80:83], v[20:23], v[128:131]
    v_mfma_f32_16x16x32_bf16 v[164:167], v[80:83], v[24:27], v[164:167]
    ds_read_b64_tr_b16 v[76:77], v16 offset:9376
    ds_read_b64_tr_b16 v[78:79], v16 offset:11680
    s_waitcnt lgkmcnt(12)
    v_mfma_f32_16x16x32_bf16 v[132:135], v[84:87], v[20:23], v[132:135]
    v_mfma_f32_16x16x32_bf16 v[168:171], v[84:87], v[24:27], v[168:171]
    s_add_u32 s52, s47, s51
    s_add_u32 s52, s52, 131072
    buffer_load_dwordx4 v[60:63], v12, s[28:31], s52 offen
    ds_read_b64_tr_b16 v[80:81], v16 offset:9408
    ds_read_b64_tr_b16 v[82:83], v16 offset:11712
    s_waitcnt lgkmcnt(12)
    v_mfma_f32_16x16x32_bf16 v[100:103], v[88:91], v[28:31], v[100:103]
    v_mfma_f32_16x16x32_bf16 v[136:139], v[88:91], v[32:35], v[136:139]
    ds_read_b64_tr_b16 v[84:85], v16 offset:9440
    ds_read_b64_tr_b16 v[86:87], v16 offset:11744
    s_waitcnt lgkmcnt(12)
    v_mfma_f32_16x16x32_bf16 v[104:107], v[92:95], v[28:31], v[104:107]
    v_mfma_f32_16x16x32_bf16 v[140:143], v[92:95], v[32:35], v[140:143]
    ds_read_b64_tr_b16 v[88:89], v16 offset:9472
    ds_read_b64_tr_b16 v[90:91], v16 offset:11776
    s_waitcnt lgkmcnt(12)
    v_mfma_f32_16x16x32_bf16 v[108:111], v[96:99], v[28:31], v[108:111]
    v_mfma_f32_16x16x32_bf16 v[144:147], v[96:99], v[32:35], v[144:147]
    ds_read_b64_tr_b16 v[92:93], v13 offset:0
    ds_read_b64_tr_b16 v[94:95], v13 offset:2304
    s_waitcnt lgkmcnt(12)
    v_mfma_f32_16x16x32_bf16 v[112:115], v[68:71], v[28:31], v[112:115]
    v_mfma_f32_16x16x32_bf16 v[148:151], v[68:71], v[32:35], v[148:151]
    s_add_u32 s52, s48, s51
    s_add_u32 s52, s52, 131072
    buffer_load_dwordx4 v[64:67], v12, s[28:31], s52 offen
    ds_read_b64_tr_b16 v[96:97], v13 offset:32
    ds_read_b64_tr_b16 v[98:99], v13 offset:2336
    s_waitcnt lgkmcnt(12)
    v_mfma_f32_16x16x32_bf16 v[116:119], v[72:75], v[28:31], v[116:119]
    v_mfma_f32_16x16x32_bf16 v[152:155], v[72:75], v[32:35], v[152:155]
    ds_read_b64_tr_b16 v[68:69], v13 offset:64
    ds_read_b64_tr_b16 v[70:71], v13 offset:2368
    s_waitcnt lgkmcnt(12)
    v_mfma_f32_16x16x32_bf16 v[120:123], v[76:79], v[28:31], v[120:123]
    v_mfma_f32_16x16x32_bf16 v[156:159], v[76:79], v[32:35], v[156:159]
    ds_read_b64_tr_b16 v[72:73], v13 offset:96
    ds_read_b64_tr_b16 v[74:75], v13 offset:2400
    s_waitcnt lgkmcnt(12)
    v_mfma_f32_16x16x32_bf16 v[124:127], v[80:83], v[28:31], v[124:127]
    v_mfma_f32_16x16x32_bf16 v[160:163], v[80:83], v[32:35], v[160:163]
    ds_read_b64_tr_b16 v[76:77], v13 offset:128
    ds_read_b64_tr_b16 v[78:79], v13 offset:2432
    s_waitcnt lgkmcnt(12)
    v_mfma_f32_16x16x32_bf16 v[128:131], v[84:87], v[28:31], v[128:131]
    v_mfma_f32_16x16x32_bf16 v[164:167], v[84:87], v[32:35], v[164:167]
    ds_read_b64_tr_b16 v[80:81], v13 offset:160
    ds_read_b64_tr_b16 v[82:83], v13 offset:2464
    s_waitcnt lgkmcnt(12)
    v_mfma_f32_16x16x32_bf16 v[132:135], v[88:91], v[28:31], v[132:135]
    v_mfma_f32_16x16x32_bf16 v[168:171], v[88:91], v[32:35], v[168:171]
    s_waitcnt vmcnt(4)
    s_barrier
    ds_read_b64_tr_b16 v[84:85], v13 offset:192
    ds_read_b64_tr_b16 v[86:87], v13 offset:2496
    s_waitcnt lgkmcnt(12)
    v_mfma_f32_16x16x32_bf16 v[100:103], v[92:95], v[36:39], v[100:103]
    v_mfma_f32_16x16x32_bf16 v[136:139], v[92:95], v[40:43], v[136:139]
    ds_read_b64_tr_b16 v[88:89], v13 offset:224
    ds_read_b64_tr_b16 v[90:91], v13 offset:2528
    s_waitcnt lgkmcnt(12)
    v_mfma_f32_16x16x32_bf16 v[104:107], v[96:99], v[36:39], v[104:107]
    v_mfma_f32_16x16x32_bf16 v[140:143], v[96:99], v[40:43], v[140:143]
    ds_read_b64_tr_b16 v[92:93], v13 offset:256
    ds_read_b64_tr_b16 v[94:95], v13 offset:2560
    s_waitcnt lgkmcnt(12)
    v_mfma_f32_16x16x32_bf16 v[108:111], v[68:71], v[36:39], v[108:111]
    v_mfma_f32_16x16x32_bf16 v[144:147], v[68:71], v[40:43], v[144:147]
    ds_read_b64_tr_b16 v[96:97], v13 offset:9216
    ds_read_b64_tr_b16 v[98:99], v13 offset:11520
    s_waitcnt lgkmcnt(12)
    v_mfma_f32_16x16x32_bf16 v[112:115], v[72:75], v[36:39], v[112:115]
    v_mfma_f32_16x16x32_bf16 v[148:151], v[72:75], v[40:43], v[148:151]
    ds_read_b64_tr_b16 v[68:69], v13 offset:9248
    ds_read_b64_tr_b16 v[70:71], v13 offset:11552
    s_waitcnt lgkmcnt(12)
    v_mfma_f32_16x16x32_bf16 v[116:119], v[76:79], v[36:39], v[116:119]
    v_mfma_f32_16x16x32_bf16 v[152:155], v[76:79], v[40:43], v[152:155]
    ds_read_b64_tr_b16 v[72:73], v13 offset:9280
    ds_read_b64_tr_b16 v[74:75], v13 offset:11584
    s_waitcnt lgkmcnt(12)
    v_mfma_f32_16x16x32_bf16 v[120:123], v[80:83], v[36:39], v[120:123]
    v_mfma_f32_16x16x32_bf16 v[156:159], v[80:83], v[40:43], v[156:159]
    ds_read_b64_tr_b16 v[76:77], v13 offset:9312
    ds_read_b64_tr_b16 v[78:79], v13 offset:11616
    s_waitcnt lgkmcnt(12)
    v_mfma_f32_16x16x32_bf16 v[124:127], v[84:87], v[36:39], v[124:127]
    v_mfma_f32_16x16x32_bf16 v[160:163], v[84:87], v[40:43], v[160:163]
    ds_read_b64_tr_b16 v[80:81], v13 offset:9344
    ds_read_b64_tr_b16 v[82:83], v13 offset:11648
    s_waitcnt lgkmcnt(12)
    v_mfma_f32_16x16x32_bf16 v[128:131], v[88:91], v[36:39], v[128:131]
    v_mfma_f32_16x16x32_bf16 v[164:167], v[88:91], v[40:43], v[164:167]
    ds_read_b64_tr_b16 v[84:85], v13 offset:9376
    ds_read_b64_tr_b16 v[86:87], v13 offset:11680
    s_waitcnt lgkmcnt(12)
    v_mfma_f32_16x16x32_bf16 v[132:135], v[92:95], v[36:39], v[132:135]
    v_mfma_f32_16x16x32_bf16 v[168:171], v[92:95], v[40:43], v[168:171]
    ds_read_b64_tr_b16 v[88:89], v13 offset:9408
    ds_read_b64_tr_b16 v[90:91], v13 offset:11712
    s_waitcnt lgkmcnt(12)
    v_mfma_f32_16x16x32_bf16 v[100:103], v[96:99], v[44:47], v[100:103]
    v_mfma_f32_16x16x32_bf16 v[136:139], v[96:99], v[48:51], v[136:139]
    ds_read_b64_tr_b16 v[92:93], v13 offset:9440
    ds_read_b64_tr_b16 v[94:95], v13 offset:11744
    s_waitcnt lgkmcnt(12)
    v_mfma_f32_16x16x32_bf16 v[104:107], v[68:71], v[44:47], v[104:107]
    v_mfma_f32_16x16x32_bf16 v[140:143], v[68:71], v[48:51], v[140:143]
    ds_read_b64_tr_b16 v[96:97], v13 offset:9472
    ds_read_b64_tr_b16 v[98:99], v13 offset:11776
    s_waitcnt lgkmcnt(12)
    v_mfma_f32_16x16x32_bf16 v[108:111], v[72:75], v[44:47], v[108:111]
    v_mfma_f32_16x16x32_bf16 v[144:147], v[72:75], v[48:51], v[144:147]
    ds_read_b64_tr_b16 v[68:69], v14 offset:0
    ds_read_b64_tr_b16 v[70:71], v14 offset:2304
    s_waitcnt lgkmcnt(12)
    v_mfma_f32_16x16x32_bf16 v[112:115], v[76:79], v[44:47], v[112:115]
    v_mfma_f32_16x16x32_bf16 v[148:151], v[76:79], v[48:51], v[148:151]
    ds_read_b64_tr_b16 v[72:73], v14 offset:32
    ds_read_b64_tr_b16 v[74:75], v14 offset:2336
    s_waitcnt lgkmcnt(12)
    v_mfma_f32_16x16x32_bf16 v[116:119], v[80:83], v[44:47], v[116:119]
    v_mfma_f32_16x16x32_bf16 v[152:155], v[80:83], v[48:51], v[152:155]
    ds_read_b64_tr_b16 v[76:77], v14 offset:64
    ds_read_b64_tr_b16 v[78:79], v14 offset:2368
    s_waitcnt lgkmcnt(12)
    v_mfma_f32_16x16x32_bf16 v[120:123], v[84:87], v[44:47], v[120:123]
    v_mfma_f32_16x16x32_bf16 v[156:159], v[84:87], v[48:51], v[156:159]
    ds_read_b64_tr_b16 v[80:81], v14 offset:96
    ds_read_b64_tr_b16 v[82:83], v14 offset:2400
    s_waitcnt lgkmcnt(12)
    v_mfma_f32_16x16x32_bf16 v[124:127], v[88:91], v[44:47], v[124:127]
    v_mfma_f32_16x16x32_bf16 v[160:163], v[88:91], v[48:51], v[160:163]
    ds_read_b64_tr_b16 v[84:85], v14 offset:128
    ds_read_b64_tr_b16 v[86:87], v14 offset:2432
    s_waitcnt lgkmcnt(12)
    v_mfma_f32_16x16x32_bf16 v[128:131], v[92:95], v[44:47], v[128:131]
    v_mfma_f32_16x16x32_bf16 v[164:167], v[92:95], v[48:51], v[164:167]
    ds_read_b64_tr_b16 v[88:89], v14 offset:160
    ds_read_b64_tr_b16 v[90:91], v14 offset:2464
    s_waitcnt lgkmcnt(12)
    v_mfma_f32_16x16x32_bf16 v[132:135], v[96:99], v[44:47], v[132:135]
    v_mfma_f32_16x16x32_bf16 v[168:171], v[96:99], v[48:51], v[168:171]
    s_waitcnt vmcnt(0)
    s_barrier
    ds_read_b64_tr_b16 v[92:93], v14 offset:192
    ds_read_b64_tr_b16 v[94:95], v14 offset:2496
    s_waitcnt lgkmcnt(12)
    v_mfma_f32_16x16x32_bf16 v[100:103], v[68:71], v[52:55], v[100:103]
    v_mfma_f32_16x16x32_bf16 v[136:139], v[68:71], v[56:59], v[136:139]
    ds_read_b64_tr_b16 v[96:97], v14 offset:224
    ds_read_b64_tr_b16 v[98:99], v14 offset:2528
    s_waitcnt lgkmcnt(12)
    v_mfma_f32_16x16x32_bf16 v[104:107], v[72:75], v[52:55], v[104:107]
    v_mfma_f32_16x16x32_bf16 v[140:143], v[72:75], v[56:59], v[140:143]
    ds_read_b64_tr_b16 v[68:69], v14 offset:256
    ds_read_b64_tr_b16 v[70:71], v14 offset:2560
    s_waitcnt lgkmcnt(12)
    v_mfma_f32_16x16x32_bf16 v[108:111], v[76:79], v[52:55], v[108:111]
    v_mfma_f32_16x16x32_bf16 v[144:147], v[76:79], v[56:59], v[144:147]
    ds_read_b64_tr_b16 v[72:73], v14 offset:9216
    ds_read_b64_tr_b16 v[74:75], v14 offset:11520
    s_waitcnt lgkmcnt(12)
    v_mfma_f32_16x16x32_bf16 v[112:115], v[80:83], v[52:55], v[112:115]
    v_mfma_f32_16x16x32_bf16 v[148:151], v[80:83], v[56:59], v[148:151]
    ds_read_b64_tr_b16 v[76:77], v14 offset:9248
    ds_read_b64_tr_b16 v[78:79], v14 offset:11552
    s_waitcnt lgkmcnt(12)
    v_mfma_f32_16x16x32_bf16 v[116:119], v[84:87], v[52:55], v[116:119]
    v_mfma_f32_16x16x32_bf16 v[152:155], v[84:87], v[56:59], v[152:155]
    ds_read_b64_tr_b16 v[80:81], v14 offset:9280
    ds_read_b64_tr_b16 v[82:83], v14 offset:11584
    s_waitcnt lgkmcnt(12)
    v_mfma_f32_16x16x32_bf16 v[120:123], v[88:91], v[52:55], v[120:123]
    v_mfma_f32_16x16x32_bf16 v[156:159], v[88:91], v[56:59], v[156:159]
    ds_read_b64_tr_b16 v[84:85], v14 offset:9312
    ds_read_b64_tr_b16 v[86:87], v14 offset:11616
    s_waitcnt lgkmcnt(12)
    v_mfma_f32_16x16x32_bf16 v[124:127], v[92:95], v[52:55], v[124:127]
    v_mfma_f32_16x16x32_bf16 v[160:163], v[92:95], v[56:59], v[160:163]
    ds_read_b64_tr_b16 v[88:89], v14 offset:9344
    ds_read_b64_tr_b16 v[90:91], v14 offset:11648
    s_waitcnt lgkmcnt(12)
    v_mfma_f32_16x16x32_bf16 v[128:131], v[96:99], v[52:55], v[128:131]
    v_mfma_f32_16x16x32_bf16 v[164:167], v[96:99], v[56:59], v[164:167]
    ds_read_b64_tr_b16 v[92:93], v14 offset:9376
    ds_read_b64_tr_b16 v[94:95], v14 offset:11680
    s_waitcnt lgkmcnt(12)
    v_mfma_f32_16x16x32_bf16 v[132:135], v[68:71], v[52:55], v[132:135]
    v_mfma_f32_16x16x32_bf16 v[168:171], v[68:71], v[56:59], v[168:171]
    ds_read_b64_tr_b16 v[96:97], v14 offset:9408
    ds_read_b64_tr_b16 v[98:99], v14 offset:11712
    s_waitcnt lgkmcnt(12)
    v_mfma_f32_16x16x32_bf16 v[100:103], v[72:75], v[60:63], v[100:103]
    v_mfma_f32_16x16x32_bf16 v[136:139], v[72:75], v[64:67], v[136:139]
    ds_read_b64_tr_b16 v[68:69], v14 offset:9440
    ds_read_b64_tr_b16 v[70:71], v14 offset:11744
    s_waitcnt lgkmcnt(12)
    v_mfma_f32_16x16x32_bf16 v[104:107], v[76:79], v[60:63], v[104:107]
    v_mfma_f32_16x16x32_bf16 v[140:143], v[76:79], v[64:67], v[140:143]
    ds_read_b64_tr_b16 v[72:73], v14 offset:9472
    ds_read_b64_tr_b16 v[74:75], v14 offset:11776
    s_waitcnt lgkmcnt(12)
    v_mfma_f32_16x16x32_bf16 v[108:111], v[80:83], v[60:63], v[108:111]
    v_mfma_f32_16x16x32_bf16 v[144:147], v[80:83], v[64:67], v[144:147]
    s_waitcnt lgkmcnt(10)
    v_mfma_f32_16x16x32_bf16 v[112:115], v[84:87], v[60:63], v[112:115]
    v_mfma_f32_16x16x32_bf16 v[148:151], v[84:87], v[64:67], v[148:151]
    s_waitcnt lgkmcnt(8)
    v_mfma_f32_16x16x32_bf16 v[116:119], v[88:91], v[60:63], v[116:119]
    v_mfma_f32_16x16x32_bf16 v[152:155], v[88:91], v[64:67], v[152:155]
    s_waitcnt lgkmcnt(6)
    v_mfma_f32_16x16x32_bf16 v[120:123], v[92:95], v[60:63], v[120:123]
    v_mfma_f32_16x16x32_bf16 v[156:159], v[92:95], v[64:67], v[156:159]
    s_waitcnt lgkmcnt(4)
    v_mfma_f32_16x16x32_bf16 v[124:127], v[96:99], v[60:63], v[124:127]
    v_mfma_f32_16x16x32_bf16 v[160:163], v[96:99], v[64:67], v[160:163]
    s_waitcnt lgkmcnt(2)
    v_mfma_f32_16x16x32_bf16 v[128:131], v[68:71], v[60:63], v[128:131]
    v_mfma_f32_16x16x32_bf16 v[164:167], v[68:71], v[64:67], v[164:167]
    s_waitcnt lgkmcnt(0)
    v_mfma_f32_16x16x32_bf16 v[132:135], v[72:75], v[60:63], v[132:135]
    v_mfma_f32_16x16x32_bf16 v[168:171], v[72:75], v[64:67], v[168:171]
    s_lshl_b32 s46, s40, 1
    s_add_u32 s47, s46, s41
    s_xor_b32 s48, s47, 1
    s_mul_i32 s49, s47, 9216
    s_mul_i32 s48, s48, 9216
    s_add_u32 s50, s49, 73984
    s_add_u32 s48, s48, 73984
    v_add_u32 v1, s50, v12
    v_add_u32 v2, s48, v12
    s_nop 3
    ds_write_b128 v1, v[136:139] offset:0
    ds_write_b128 v1, v[140:143] offset:1024
    ds_write_b128 v1, v[144:147] offset:2048
    ds_write_b128 v1, v[148:151] offset:3072
    ds_write_b128 v1, v[152:155] offset:4096
    ds_write_b128 v1, v[156:159] offset:5120
    ds_write_b128 v1, v[160:163] offset:6144
    ds_write_b128 v1, v[164:167] offset:7168
    ds_write_b128 v1, v[168:171] offset:8192
    s_lshl_b32 s46, s37, 2
    s_add_u32 s46, s46, s39
    s_lshl_b32 s50, s46, 2
    s_add_u32 s50, s50, s36
    s_mul_i32 s50, s50, 73728
    s_add_u32 s50, s50, s49
    s_add_u32 s50, s50, 37748736
    s_add_u32 s51, s50, 4096
    s_add_u32 s52, s50, 8192
    s_waitcnt lgkmcnt(0)
    s_barrier
    ds_read_b128 v[136:139], v2 offset:0
    ds_read_b128 v[140:143], v2 offset:1024
    ds_read_b128 v[144:147], v2 offset:2048
    ds_read_b128 v[148:151], v2 offset:3072
    ds_read_b128 v[152:155], v2 offset:4096
    ds_read_b128 v[156:159], v2 offset:5120
    ds_read_b128 v[160:163], v2 offset:6144
    ds_read_b128 v[164:167], v2 offset:7168
    ds_read_b128 v[168:171], v2 offset:8192
    s_cmp_eq_u32 s40, s36
    s_cbranch_scc1 P4OWN_33
    s_waitcnt lgkmcnt(8)
    v_add_f32 v100, v100, v136
    v_add_f32 v101, v101, v137
    v_add_f32 v102, v102, v138
    v_add_f32 v103, v103, v139
    buffer_store_dwordx4 v[100:103], v12, s[28:31], s50 offen offset:0 sc1
    s_waitcnt lgkmcnt(7)
    v_add_f32 v104, v104, v140
    v_add_f32 v105, v105, v141
    v_add_f32 v106, v106, v142
    v_add_f32 v107, v107, v143
    buffer_store_dwordx4 v[104:107], v12, s[28:31], s50 offen offset:1024 sc1
    s_waitcnt lgkmcnt(6)
    v_add_f32 v108, v108, v144
    v_add_f32 v109, v109, v145
    v_add_f32 v110, v110, v146
    v_add_f32 v111, v111, v147
    buffer_store_dwordx4 v[108:111], v12, s[28:31], s50 offen offset:2048 sc1
    s_waitcnt lgkmcnt(5)
    v_add_f32 v112, v112, v148
    v_add_f32 v113, v113, v149
    v_add_f32 v114, v114, v150
    v_add_f32 v115, v115, v151
    buffer_store_dwordx4 v[112:115], v12, s[28:31], s50 offen offset:3072 sc1
    s_waitcnt lgkmcnt(4)
    v_add_f32 v116, v116, v152
    v_add_f32 v117, v117, v153
    v_add_f32 v118, v118, v154
    v_add_f32 v119, v119, v155
    buffer_store_dwordx4 v[116:119], v12, s[28:31], s51 offen offset:0 sc1
    s_waitcnt lgkmcnt(3)
    v_add_f32 v120, v120, v156
    v_add_f32 v121, v121, v157
    v_add_f32 v122, v122, v158
    v_add_f32 v123, v123, v159
    buffer_store_dwordx4 v[120:123], v12, s[28:31], s51 offen offset:1024 sc1
    s_waitcnt lgkmcnt(2)
    v_add_f32 v124, v124, v160
    v_add_f32 v125, v125, v161
    v_add_f32 v126, v126, v162
    v_add_f32 v127, v127, v163
    buffer_store_dwordx4 v[124:127], v12, s[28:31], s51 offen offset:2048 sc1
    s_waitcnt lgkmcnt(1)
    v_add_f32 v128, v128, v164
    v_add_f32 v129, v129, v165
    v_add_f32 v130, v130, v166
    v_add_f32 v131, v131, v167
    buffer_store_dwordx4 v[128:131], v12, s[28:31], s51 offen offset:3072 sc1
    s_waitcnt lgkmcnt(0)
    v_add_f32 v132, v132, v168
    v_add_f32 v133, v133, v169
    v_add_f32 v134, v134, v170
    v_add_f32 v135, v135, v171
    buffer_store_dwordx4 v[132:135], v12, s[28:31], s52 offen offset:0 sc1
    s_branch P4DONE_34
P4OWN_33:
    s_mul_i32 s50, s41, 9216
    v_add_u32 v1, s50, v12
    s_waitcnt lgkmcnt(0)
    v_add_f32 v100, v100, v136
    v_add_f32 v101, v101, v137
    v_add_f32 v102, v102, v138
    v_add_f32 v103, v103, v139
    ds_write_b128 v1, v[100:103] offset:0
    v_add_f32 v104, v104, v140
    v_add_f32 v105, v105, v141
    v_add_f32 v106, v106, v142
    v_add_f32 v107, v107, v143
    ds_write_b128 v1, v[104:107] offset:1024
    v_add_f32 v108, v108, v144
    v_add_f32 v109, v109, v145
    v_add_f32 v110, v110, v146
    v_add_f32 v111, v111, v147
    ds_write_b128 v1, v[108:111] offset:2048
    v_add_f32 v112, v112, v148
    v_add_f32 v113, v113, v149
    v_add_f32 v114, v114, v150
    v_add_f32 v115, v115, v151
    ds_write_b128 v1, v[112:115] offset:3072
    v_add_f32 v116, v116, v152
    v_add_f32 v117, v117, v153
    v_add_f32 v118, v118, v154
    v_add_f32 v119, v119, v155
    ds_write_b128 v1, v[116:119] offset:4096
    v_add_f32 v120, v120, v156
    v_add_f32 v121, v121, v157
    v_add_f32 v122, v122, v158
    v_add_f32 v123, v123, v159
    ds_write_b128 v1, v[120:123] offset:5120
    v_add_f32 v124, v124, v160
    v_add_f32 v125, v125, v161
    v_add_f32 v126, v126, v162
    v_add_f32 v127, v127, v163
    ds_write_b128 v1, v[124:127] offset:6144
    v_add_f32 v128, v128, v164
    v_add_f32 v129, v129, v165
    v_add_f32 v130, v130, v166
    v_add_f32 v131, v131, v167
    ds_write_b128 v1, v[128:131] offset:7168
    v_add_f32 v132, v132, v168
    v_add_f32 v133, v133, v169
    v_add_f32 v134, v134, v170
    v_add_f32 v135, v135, v171
    ds_write_b128 v1, v[132:135] offset:8192
    s_waitcnt lgkmcnt(0)
P4DONE_34:
    s_lshl_b32 s45, s46, 6
    s_add_u32 s45, s45, 10752
    s_waitcnt vmcnt(0)
    s_barrier
    s_cmp_lg_u32 s24, 0
    s_cbranch_scc1 SIG_35
    v_mov_b32 v1, 1
    s_mov_b64 exec, 1
    buffer_atomic_add v1, off, s[28:31], s45 sc1
    s_mov_b64 exec, -1
SIG_35:
    s_bfe_u32 s36, s2, 0x20001
    s_and_b32 s37, s2, 1
    s_lshl_b32 s37, s37, 3
    s_bfe_u32 s38, s2, 0x30003
    s_add_u32 s37, s37, s38
    s_lshr_b32 s39, s2, 6
    s_lshl_b32 s46, s37, 2
    s_add_u32 s46, s46, s39
    v_lshlrev_b32 v7, 4, v0
    s_lshl_b32 s40, s37, 7
    s_lshl_b32 s41, s36, 5
    s_add_u32 s40, s40, s41
    v_and_b32 v1, 15, v0
    v_add_u32 v1, s40, v1
    v_mul_u32_u24 v1, 1152, v1
    v_lshrrev_b32 v11, 4, v0
    v_lshl_add_u32 v1, v11, 3, v1
    v_lshlrev_b32 v11, 4, v11
    s_mul_i32 s41, s39, 288
    s_mov_b32 s53, 8388608
    s_add_u32 s42, s24, 0
    s_cmp_ge_u32 s42, 9
    s_cselect_b32 s43, 1, 0
    s_mul_i32 s44, s43, 9
    s_sub_u32 s44, s42, s44
    s_mul_i32 s47, s43, 18432
    s_lshl_b32 s48, s44, 5
    s_add_u32 s47, s47, s48
    s_add_u32 s47, s47, s41
    s_cmp_ge_u32 s42, 18
    s_cselect_b32 s47, 0x7f000000, s47
    v_add_u32 v8, s47, v1
    buffer_load_dwordx2 v[60:61], v8, s[28:31], s53 offen sc1
    s_lshl_b32 s48, s44, 6
    s_mul_i32 s49, s39, 576
    s_add_u32 s48, s48, s49
    s_add_u32 s48, s48, 27904
    buffer_load_dwordx4 v[68:71], v11, s[28:31], s48 offen sc1
    s_add_u32 s42, s24, 8
    s_cmp_ge_u32 s42, 9
    s_cselect_b32 s43, 1, 0
    s_mul_i32 s44, s43, 9
    s_sub_u32 s44, s42, s44
    s_mul_i32 s47, s43, 18432
    s_lshl_b32 s48, s44, 5
    s_add_u32 s47, s47, s48
    s_add_u32 s47, s47, s41
    s_cmp_ge_u32 s42, 18
    s_cselect_b32 s47, 0x7f000000, s47
    v_add_u32 v9, s47, v1
    buffer_load_dwordx2 v[62:63], v9, s[28:31], s53 offen sc1
    s_lshl_b32 s48, s44, 6
    s_mul_i32 s49, s39, 576
    s_add_u32 s48, s48, s49
    s_add_u32 s48, s48, 27904
    buffer_load_dwordx4 v[72:75], v11, s[28:31], s48 offen sc1
    s_add_u32 s42, s24, 16
    s_cmp_ge_u32 s42, 9
    s_cselect_b32 s43, 1, 0
    s_mul_i32 s44, s43, 9
    s_sub_u32 s44, s42, s44
    s_mul_i32 s47, s43, 18432
    s_lshl_b32 s48, s44, 5
    s_add_u32 s47, s47, s48
    s_add_u32 s47, s47, s41
    s_cmp_ge_u32 s42, 18
    s_cselect_b32 s47, 0x7f000000, s47
    v_add_u32 v10, s47, v1
    buffer_load_dwordx2 v[64:65], v10, s[28:31], s53 offen sc1
    s_lshl_b32 s48, s44, 6
    s_mul_i32 s49, s39, 576
    s_add_u32 s48, s48, s49
    s_add_u32 s48, s48, 27904
    buffer_load_dwordx4 v[76:79], v11, s[28:31], s48 offen sc1
    s_lshl_b32 s45, s46, 6
    s_add_u32 s45, s45, 10752
    s_cmp_lg_u32 s24, 0
    s_cbranch_scc1 WDONE_36
    s_mov_b32 s56, 0
WLOOP_37:
    buffer_load_dword v2, off, s[28:31], s45 sc1
    s_waitcnt vmcnt(0)
    v_readfirstlane_b32 s57, v2
    s_add_u32 s56, s56, 1
    s_cmp_ge_u32 s57, 4
    s_cbranch_scc1 WDONE_36
    s_cmp_gt_u32 s56, 0x400000
    s_cbranch_scc1 WDONE_36
    s_sleep 1
    s_branch WLOOP_37
WDONE_36:
    s_barrier
    s_mul_i32 s50, s46, 294912
    s_mul_i32 s51, s36, 18432
    s_add_u32 s50, s50, s51
    s_lshl_b32 s51, s24, 10
    s_add_u32 s50, s50, s51
    s_add_u32 s50, s50, 37748736
    s_lshl_b32 s51, s24, 10
    v_add_u32 v4, s51, v7
    ds_read_b128 v[24:27], v4 offset:0
    ds_read_b128 v[40:43], v4 offset:8192
    ds_read_b128 v[56:59], v4 offset:16384
    s_add_u32 s54, s36, 1
    s_and_b32 s54, s54, 3
    s_mul_i32 s54, s54, 73728
    s_add_u32 s54, s54, s50
    s_add_u32 s55, s36, 2
    s_and_b32 s55, s55, 3
    s_mul_i32 s55, s55, 73728
    s_add_u32 s55, s55, s50
    s_add_u32 s56, s36, 3
    s_and_b32 s56, s56, 3
    s_mul_i32 s56, s56, 73728
    s_add_u32 s56, s56, s50
    s_add_u32 s51, s54, 0
    buffer_load_dwordx4 v[12:15], v7, s[28:31], s51 offen sc1
    s_add_u32 s51, s55, 0
    buffer_load_dwordx4 v[16:19], v7, s[28:31], s51 offen sc1
    s_add_u32 s51, s56, 0
    buffer_load_dwordx4 v[20:23], v7, s[28:31], s51 offen sc1
    s_add_u32 s51, s54, 8192
    buffer_load_dwordx4 v[28:31], v7, s[28:31], s51 offen sc1
    s_add_u32 s51, s55, 8192
    buffer_load_dwordx4 v[32:35], v7, s[28:31], s51 offen sc1
    s_add_u32 s51, s56, 8192
    buffer_load_dwordx4 v[36:39], v7, s[28:31], s51 offen sc1
    s_add_u32 s51, s54, 16384
    buffer_load_dwordx4 v[44:47], v7, s[28:31], s51 offen sc1
    s_add_u32 s51, s55, 16384
    buffer_load_dwordx4 v[48:51], v7, s[28:31], s51 offen sc1
    s_add_u32 s51, s56, 16384
    buffer_load_dwordx4 v[52:55], v7, s[28:31], s51 offen sc1
    s_waitcnt lgkmcnt(0)
    s_waitcnt vmcnt(6)
    v_add_f32 v12, v12, v16
    v_add_f32 v20, v20, v24
    v_add_f32 v12, v12, v20
    v_add_f32 v13, v13, v17
    v_add_f32 v21, v21, v25
    v_add_f32 v13, v13, v21
    v_add_f32 v14, v14, v18
    v_add_f32 v22, v22, v26
    v_add_f32 v14, v14, v22
    v_add_f32 v15, v15, v19
    v_add_f32 v23, v23, v27
    v_add_f32 v15, v15, v23
    v_lshlrev_b32 v2, 16, v60
    v_and_b32 v3, 0xffff0000, v60
    v_fmac_f32 v2, v68, v12
    v_fmac_f32 v3, v69, v13
    v_cvt_pk_bf16_f32 v60, v2, v3
    v_lshlrev_b32 v2, 16, v61
    v_and_b32 v3, 0xffff0000, v61
    v_fmac_f32 v2, v70, v14
    v_fmac_f32 v3, v71, v15
    v_cvt_pk_bf16_f32 v61, v2, v3
    buffer_store_dwordx2 v[60:61], v8, s[20:23], 0 offen
    s_waitcnt vmcnt(4)
    v_add_f32 v28, v28, v32
    v_add_f32 v36, v36, v40
    v_add_f32 v28, v28, v36
    v_add_f32 v29, v29, v33
    v_add_f32 v37, v37, v41
    v_add_f32 v29, v29, v37
    v_add_f32 v30, v30, v34
    v_add_f32 v38, v38, v42
    v_add_f32 v30, v30, v38
    v_add_f32 v31, v31, v35
    v_add_f32 v39, v39, v43
    v_add_f32 v31, v31, v39
    v_lshlrev_b32 v2, 16, v62
    v_and_b32 v3, 0xffff0000, v62
    v_fmac_f32 v2, v72, v28
    v_fmac_f32 v3, v73, v29
    v_cvt_pk_bf16_f32 v62, v2, v3
    v_lshlrev_b32 v2, 16, v63
    v_and_b32 v3, 0xffff0000, v63
    v_fmac_f32 v2, v74, v30
    v_fmac_f32 v3, v75, v31
    v_cvt_pk_bf16_f32 v63, v2, v3
    buffer_store_dwordx2 v[62:63], v9, s[20:23], 0 offen
    s_waitcnt vmcnt(2)
    v_add_f32 v44, v44, v48
    v_add_f32 v52, v52, v56
    v_add_f32 v44, v44, v52
    v_add_f32 v45, v45, v49
    v_add_f32 v53, v53, v57
    v_add_f32 v45, v45, v53
    v_add_f32 v46, v46, v50
    v_add_f32 v54, v54, v58
    v_add_f32 v46, v46, v54
    v_add_f32 v47, v47, v51
    v_add_f32 v55, v55, v59
    v_add_f32 v47, v47, v55
    v_lshlrev_b32 v2, 16, v64
    v_and_b32 v3, 0xffff0000, v64
    v_fmac_f32 v2, v76, v44
    v_fmac_f32 v3, v77, v45
    v_cvt_pk_bf16_f32 v64, v2, v3
    v_lshlrev_b32 v2, 16, v65
    v_and_b32 v3, 0xffff0000, v65
    v_fmac_f32 v2, v78, v46
    v_fmac_f32 v3, v79, v47
    v_cvt_pk_bf16_f32 v65, v2, v3
    buffer_store_dwordx2 v[64:65], v10, s[20:23], 0 offen
MEGA_END:
    s_endpgm
.section .rodata,"a"
.p2align 6
.amdhsa_kernel pmega_kernel
  .amdhsa_next_free_vgpr 256
  .amdhsa_next_free_sgpr 102
  .amdhsa_accum_offset 256
  .amdhsa_group_segment_fixed_size 0
  .amdhsa_kernarg_size 96
  .amdhsa_user_sgpr_count 2
  .amdhsa_user_sgpr_kernarg_segment_ptr 1
  .amdhsa_system_sgpr_workgroup_id_x 1
.end_amdhsa_kernel
```
